```python
import torch

def _softmax(x, axis=-1):
    return torch.softmax(x, dim=axis)
def _gelu(x):
    return torch.nn.functional.gelu(x, approximate="tanh")
def _silu(x):
    return torch.nn.functional.silu(x)
def _sigmoid(x):
    return torch.sigmoid(x)
def _layernorm(x, axis=-1, eps=1e-5):
    m = x.mean(dim=axis, keepdim=True)
    v = x.var(dim=axis, keepdim=True, unbiased=False)
    return (x - m) / torch.sqrt(v + eps)
def _scatter_add(tgt, idx, src, axis=0):
    return tgt.clone().index_add_(axis, idx, src)
def _segment_sum(src, seg, n):
    out = torch.zeros((n,) + src.shape[1:], dtype=src.dtype)
    return out.index_add_(0, seg, src)
def _pad(x, pw):
    flat = tuple(v for pair in reversed(pw) for v in pair)
    return torch.nn.functional.pad(x, flat)

kernel_name = 'concat_heads__gqa_block_cached__gqa_block_cached__near_ridge'

def setup_inputs():

    _w = (lambda a: (lambda t: t.to(torch.bfloat16) if t.is_floating_point() else t)(torch.as_tensor(a)))
    def _A_setup():
        B, Sq, D = 8, 144, 640
        Hq, Hkv, Sk, Dh = 32, 32, 1024, 128
        assert Hq % Hkv == 0, (Hq, Hkv)
        return {
            "x": _w((lambda *s: torch.randn(*s, dtype=torch.bfloat16) * 0.8)(B, Sq, D)),
            "k_cache": _w((lambda *s: torch.randn(*s, dtype=torch.bfloat16) * 0.8)(B, Hkv, Sk, Dh)),
            "v_cache": _w((lambda *s: torch.randn(*s, dtype=torch.bfloat16) * 0.05)(B, Hkv, Sk, Dh)),
            "wq": _w((lambda *s: torch.randn(*s, dtype=torch.bfloat16) * 0.8)(D, Hq * Dh) * (D ** -0.5)),
            "wo": _w((lambda *s: torch.randn(*s, dtype=torch.bfloat16) * 0.05)(Hq * Dh, D) * ((Hq * Dh) ** -0.5)),
        }
    _A_in = _A_setup()

    def _B_setup():
        B, Sq, D = 8, 144, 640
        Hq, Hkv, Sk, Dh = 32, 32, 1024, 128
        assert Hq % Hkv == 0, (Hq, Hkv)
        return {
            "x": _w((lambda *s: torch.randn(*s, dtype=torch.bfloat16) * 0.8)(B, Sq, D)),
            "k_cache": _w((lambda *s: torch.randn(*s, dtype=torch.bfloat16) * 0.8)(B, Hkv, Sk, Dh)),
            "v_cache": _w((lambda *s: torch.randn(*s, dtype=torch.bfloat16) * 0.05)(B, Hkv, Sk, Dh)),
            "wq": _w((lambda *s: torch.randn(*s, dtype=torch.bfloat16) * 0.8)(D, Hq * Dh) * (D ** -0.5)),
            "wo": _w((lambda *s: torch.randn(*s, dtype=torch.bfloat16) * 0.05)(Hq * Dh, D) * ((Hq * Dh) ** -0.5)),
        }
    _B_in = _B_setup()

    return {
        "A_x": _A_in["x"],
        "A_k_cache": _A_in["k_cache"],
        "A_v_cache": _A_in["v_cache"],
        "A_wq": _A_in["wq"],
        "A_wo": _A_in["wo"],
        "B_x": _B_in["x"],
        "B_k_cache": _B_in["k_cache"],
        "B_v_cache": _B_in["v_cache"],
        "B_wq": _B_in["wq"],
        "B_wo": _B_in["wo"],
    }

def reference(A_x, A_k_cache, A_v_cache, A_wq, A_wo, B_x, B_k_cache, B_v_cache, B_wq, B_wo):
    def _A_ref(x, k_cache, v_cache, wq, wo):
        B, Sq, D = x.shape
        Hq, Dh = 32, 128
        Hkv = k_cache.shape[1]
        rep = Hq // Hkv
        q = (lambda x, *d: x.permute(*d))((x @ wq).reshape(B, Sq, Hq, Dh), 0, 2, 1, 3)
        k = (lambda x, n, axis: torch.repeat_interleave(x, n, dim=axis))(k_cache, rep, axis=1)
        v = (lambda x, n, axis: torch.repeat_interleave(x, n, dim=axis))(v_cache, rep, axis=1)
        scores = torch.einsum("bhqd,bhkd->bhqk", q, k) * (Dh ** -0.5)
        p = _softmax(scores, axis=-1)
        o = torch.einsum("bhqk,bhkd->bhqd", p, v)
        return (lambda x, *d: x.permute(*d))(o, 0, 2, 1, 3).reshape(B, Sq, Hq * Dh) @ wo

    def _B_ref(x, k_cache, v_cache, wq, wo):
        B, Sq, D = x.shape
        Hq, Dh = 32, 128
        Hkv = k_cache.shape[1]
        rep = Hq // Hkv
        q = (lambda x, *d: x.permute(*d))((x @ wq).reshape(B, Sq, Hq, Dh), 0, 2, 1, 3)
        k = (lambda x, n, axis: torch.repeat_interleave(x, n, dim=axis))(k_cache, rep, axis=1)
        v = (lambda x, n, axis: torch.repeat_interleave(x, n, dim=axis))(v_cache, rep, axis=1)
        scores = torch.einsum("bhqd,bhkd->bhqk", q, k) * (Dh ** -0.5)
        p = _softmax(scores, axis=-1)
        o = torch.einsum("bhqk,bhkd->bhqd", p, v)
        return (lambda x, *d: x.permute(*d))(o, 0, 2, 1, 3).reshape(B, Sq, Hq * Dh) @ wo

    a = _A_ref(A_x, A_k_cache, A_v_cache, A_wq, A_wo)
    b = _B_ref(B_x, B_k_cache, B_v_cache, B_wq, B_wo)
    return torch.concatenate([a, b], axis=-1)
```

```asm
; @launch grid=(256,1,1) block=(512,1,1) lds=163840
.amdgcn_target "amdgcn-amd-amdhsa--gfx950"
.text
.globl concat_heads__gqa_block_cached__gqa_block_cached__near_ridge_kernel
.p2align 8
.type concat_heads__gqa_block_cached__gqa_block_cached__near_ridge_kernel,@function
concat_heads__gqa_block_cached__gqa_block_cached__near_ridge_kernel:
    s_cmp_ge_u32 s2, 256
    s_cbranch_scc1 L_end
    s_load_dwordx8 s[56:63], s[0:1], 0
    s_load_dwordx8 s[64:71], s[0:1], 40
    s_load_dwordx2 s[72:73], s[0:1], 96
    s_load_dwordx2 s[84:85], s[0:1], 32
    s_load_dwordx2 s[86:87], s[0:1], 72
    s_load_dwordx4 s[92:95], s[0:1], 80
    s_getpc_b64 s[32:33]
IPF_ref:
    s_sub_u32 s32, s32, IPF_ref-concat_heads__gqa_block_cached__gqa_block_cached__near_ridge_kernel
    s_subb_u32 s33, s33, 0
    s_lshr_b32 s34, s2, 3
    s_lshl_b32 s34, s34, 11
    v_lshlrev_b32 v200, 2, v0
    v_add_u32 v200, s34, v200
    v_min_u32 v200, L_end-concat_heads__gqa_block_cached__gqa_block_cached__near_ridge_kernel, v200
    v_mov_b32 v201, s33
    v_add_co_u32 v200, vcc, s32, v200
    s_nop 1
    v_addc_co_u32 v201, vcc, 0, v201, vcc
    global_load_dword v204, v[200:201], off
    v_lshrrev_b32 v1, 6, v0
    v_and_b32 v0, 63, v0
    v_readfirstlane_b32 s3, v1
    s_and_b32 s32, s2, 7
    s_lshr_b32 s33, s2, 3
    s_lshr_b32 s26, s32, 2
    s_lshr_b32 s25, s33, 2
    s_and_b32 s24, s32, 3
    s_lshl_b32 s24, s24, 2
    s_and_b32 s34, s33, 3
    s_add_u32 s15, s34, s25
    s_add_u32 s24, s24, s34
    s_mov_b32 s31, 0x47800000
    s_lshl_b32 s34, s25, 4
    s_add_u32 s34, s34, s24
    s_lshl_b32 s35, s34, 19
    s_cmp_ge_u32 s15, 5
    s_cselect_b32 s32, 5, 0
    s_sub_u32 s15, s15, s32
    s_cmp_ge_u32 s15, 5
    s_cselect_b32 s32, 5, 0
    s_sub_u32 s15, s15, s32
    s_lshl_b32 s32, s26, 7
    s_add_u32 s32, s32, s34
    s_mul_i32 s36, s32, 73728
    s_mov_b32 s14, s35
    v_and_b32 v12, 15, v0
    v_lshrrev_b32 v13, 4, v0
    v_and_b32 v14, 1, v13
    v_lshlrev_b32 v2, 15, v14
    v_lshl_add_u32 v2, v12, 4, v2
    v_lshrrev_b32 v14, 1, v13
    v_lshl_add_u32 v2, v14, 17, v2
    s_and_b32 s32, s3, 3
    s_lshr_b32 s33, s3, 2
    s_lshl_b32 s34, s32, 1
    s_mul_i32 s48, s34, 1056
    s_mul_i32 s35, s33, 8448
    s_add_u32 s48, s48, s35
    s_and_b32 s34, s34, 3
    s_lshr_b32 s35, s32, 1
    s_lshl_b32 s35, s35, 3
    s_add_u32 s34, s34, s35
    s_lshl_b32 s34, s34, 13
    v_add_u32 v2, s34, v2
    s_lshl_b32 s44, s24, 9
    s_lshl_b32 s34, s33, 8
    s_add_u32 s44, s44, s34
    s_lshl_b32 s34, s15, 20
    s_add_u32 s44, s44, s34
    s_lshl_b32 s45, s15, 8
    s_mov_b32 s46, 129792
    v_lshrrev_b32 v14, 3, v0
    v_mul_u32_u24 v14, 1280, v14
    v_and_b32 v10, 7, v0
    v_xor_b32 v10, v10, v13
    s_and_b32 s34, s3, 1
    s_lshl_b32 s34, s34, 2
    v_xor_b32 v10, s34, v10
    v_lshl_add_u32 v3, v10, 4, v14
    v_xor_b32 v10, 4, v10
    v_lshl_add_u32 v4, v10, 4, v14
    s_mul_i32 s49, s3, 30720
    s_mul_i32 s50, s3, 3072
    s_add_u32 s50, s50, 42240
    s_mul_i32 s32, s25, 184320
    s_waitcnt lgkmcnt(0)
    s_cmp_eq_u32 s26, 0
    s_cselect_b32 s56, s56, s64
    s_cselect_b32 s57, s57, s65
    s_cselect_b32 s62, s62, s70
    s_cselect_b32 s63, s63, s71
    s_add_u32 s56, s56, s32
    s_addc_u32 s57, s57, 0
    s_mov_b32 s16, s62
    s_and_b32 s17, s63, 0xffff
    s_mov_b32 s18, 5242880
    s_mov_b32 s19, 0x20000
    s_mov_b32 s4, s56
    s_and_b32 s5, s57, 0xffff
    s_mov_b32 s6, 184320
    s_mov_b32 s7, 0x20000
    s_add_u32 m0, s46, s48
    s_add_u32 s32, s44, 8192
    buffer_load_dwordx4 v2, s[16:19], s44 offen nt lds
    s_add_u32 m0, m0, 1056
    s_add_u32 s44, s44, 262144
    buffer_load_dwordx4 v2, s[16:19], s32 offen nt lds
    s_cmp_ge_u32 s44, 5242880
    s_cselect_b32 s32, 5242880, 0
    s_sub_u32 s44, s44, s32
    s_add_u32 s46, s46, 16896
    s_cmp_eq_u32 s46, 163584
    s_cselect_b32 s46, 79104, s46
    s_cmp_ge_u32 s3, 6
    s_cbranch_scc1 Pc_1
    s_add_u32 s32, s45, s49
    s_add_u32 m0, s50, 0
    s_nop 0
    buffer_load_dwordx4 v3, s[4:7], s32 offen lds
    s_add_u32 m0, s50, 1024
    s_add_u32 s32, s32, 10240
    buffer_load_dwordx4 v4, s[4:7], s32 offen lds
    s_add_u32 m0, s50, 2048
    s_add_u32 s32, s32, 10240
    buffer_load_dwordx4 v3, s[4:7], s32 offen lds
    s_add_u32 s45, s45, 128
    s_cmp_eq_u32 s45, 1280
    s_cselect_b32 s45, 0, s45
    s_branch Pc_2
Pc_1:
Pc_2:
    s_add_u32 m0, s46, s48
    s_add_u32 s32, s44, 8192
    buffer_load_dwordx4 v2, s[16:19], s44 offen nt lds
    s_add_u32 m0, m0, 1056
    s_add_u32 s44, s44, 262144
    buffer_load_dwordx4 v2, s[16:19], s32 offen nt lds
    s_cmp_ge_u32 s44, 5242880
    s_cselect_b32 s32, 5242880, 0
    s_sub_u32 s44, s44, s32
    s_add_u32 s46, s46, 16896
    s_cmp_eq_u32 s46, 163584
    s_cselect_b32 s46, 79104, s46
    s_cmp_eq_u32 s26, 0
    s_cselect_b32 s58, s58, s66
    s_cselect_b32 s59, s59, s67
    s_cselect_b32 s60, s60, s68
    s_cselect_b32 s61, s61, s69
    s_cselect_b32 s84, s84, s86
    s_cselect_b32 s85, s85, s87
    s_cmp_ge_u32 s3, 6
    s_cselect_b32 s58, s58, s60
    s_cselect_b32 s59, s59, s61
    s_add_u32 s58, s58, s14
    s_addc_u32 s59, s59, 0
    s_mov_b32 s8, s58
    s_and_b32 s9, s59, 0xffff
    s_mov_b32 s10, 524288
    s_mov_b32 s11, 0x20000
    s_mov_b32 s80, s84
    s_and_b32 s81, s85, 0xffff
    s_mov_b32 s82, 5242880
    s_mov_b32 s83, 0x20000
    s_mov_b32 s20, s72
    s_and_b32 s21, s73, 0xffff
    s_mov_b32 s22, 24838144
    s_mov_b32 s23, 0x20000
    s_mov_b32 s76, s92
    s_and_b32 s77, s93, 0xffff
    s_mov_b32 s78, 2949120
    s_mov_b32 s79, 0x20000
    s_mov_b32 s64, s94
    s_and_b32 s65, s95, 0xffff
    s_mov_b32 s66, 256
    s_mov_b32 s67, 0x20000
    s_lshr_b32 s33, s2, 3
    s_mul_i32 s56, s33, 52
    s_lshr_b32 s56, s56, 8
    s_mul_i32 s32, s56, 5
    s_sub_u32 s69, s33, s32
    s_and_b32 s32, s2, 1
    s_mul_i32 s32, s32, 6
    s_add_u32 s70, s32, s56
    s_lshr_b32 s71, s2, 1
    s_and_b32 s71, s71, 1
    s_lshl_b32 s57, s26, 3
    s_add_u32 s57, s57, s25
    s_lshl_b32 s57, s57, 9
    s_lshl_b32 s32, s24, 2
    s_add_u32 s57, s57, s32
    s_add_u32 s57, s57, 18874368
    s_mov_b32 s28, 0
    s_mov_b32 s29, 129792
    s_and_b32 s34, s3, 1
    s_cmp_ge_u32 s3, 6
    s_cselect_b32 s42, 1056, 0
    s_cselect_b32 s43, 512, 0
    s_cselect_b32 s32, 4224, 0
    s_cselect_b32 s40, 0, 0
    s_cselect_b32 s35, 0, 8448
    s_cbranch_scc1 LS_k
    s_mov_b32 s42, 2112
    s_mov_b32 s43, 256
    s_mov_b32 s32, 1056
    s_mov_b32 s40, 121344
LS_k:
    s_mul_i32 s32, s32, s34
    s_add_u32 s40, s40, s32
    s_add_u32 s41, s40, 42240
    s_add_u32 s39, s40, s35
    s_mov_b32 s37, 0
    s_lshl_b32 s32, s2, 2
    s_add_u32 s32, s32, s33
    s_and_b32 s32, s32, 31
    s_lshl_b32 s38, s32, 13
    v_bfe_u32 v12, v0, 4, 1
    v_lshrrev_b32 v13, 5, v0
    v_lshlrev_b32 v15, 8, v12
    v_lshl_add_u32 v15, v13, 12, v15
    v_and_b32 v13, 15, v0
    v_xor_b32 v12, v12, v13
    v_lshl_add_u32 v15, v12, 4, v15
    v_lshrrev_b32 v12, 4, v0
    v_lshlrev_b32 v12, 11, v12
    v_lshl_add_u32 v12, v13, 4, v12
    s_mul_i32 s32, s43, s34
    s_lshl_b32 s32, s32, 2
    s_cmp_ge_u32 s3, 6
    s_cselect_b64 vcc, -1, 0
    v_cndmask_b32 v15, v12, v15, vcc
    v_add_u32 v15, s32, v15
    v_bfe_u32 v5, v0, 2, 2
    v_bfe_u32 v12, v0, 4, 1
    v_lshl_add_u32 v5, v12, 2, v5
    v_mul_u32_u24 v5, 1056, v5
    v_lshrrev_b32 v12, 5, v0
    v_lshl_add_u32 v5, v12, 9, v5
    v_and_b32 v12, 3, v0
    v_lshl_add_u32 v5, v12, 3, v5
    s_and_b32 s32, s3, 1
    s_lshl_b32 s32, s32, 7
    s_bfe_u32 s33, s3, 0x10001
    s_mul_i32 s34, s33, 8448
    s_add_u32 s34, s34, s32
    v_add_u32 v5, s34, v5
    s_lshr_b32 s35, s3, 2
    s_mul_i32 s34, s35, 10240
    s_add_u32 s34, s34, 42240
    v_and_b32 v12, 15, v0
    v_lshrrev_b32 v13, 1, v12
    v_lshrrev_b32 v14, 4, v0
    v_xor_b32 v13, v13, v14
    v_lshlrev_b32 v7, 7, v12
    v_add_u32 v7, s34, v7
    v_xor_b32 v8, 4, v13
    v_lshl_add_u32 v8, v8, 4, v7
    v_lshl_add_u32 v7, v13, 4, v7
    v_mul_u32_u24 v9, 272, v12
    v_lshl_add_u32 v9, v14, 3, v9
    s_mul_i32 s33, s33, 39168
    s_add_u32 s32, s32, s33
    s_mul_i32 s35, s35, 21760
    s_add_u32 s32, s32, s35
    s_add_u32 s32, s32, 42240
    v_add_u32 v9, s32, v9
    s_mov_b32 s47, 129792
    s_cmp_lg_u32 s2, 0
    s_cbranch_scc1 P_nn
    s_cmp_lg_u32 s3, 3
    s_cbranch_scc1 P_nn
    s_memrealtime s[32:33]
    v_mov_b32 v13, 0
    s_waitcnt lgkmcnt(0)
    s_or_b32 s34, s32, 1
    v_mov_b32 v12, s34
    s_mov_b64 exec, 1
    buffer_store_dword v12, v13, s[64:67], 0 offen sc1
    s_mov_b64 exec, -1
P_nn:
    v_mov_b32 v16, 0
    v_mov_b32 v17, 0
    v_mov_b32 v18, 0
    v_mov_b32 v19, 0
    v_mov_b32 v20, 0
    v_mov_b32 v21, 0
    v_mov_b32 v22, 0
    v_mov_b32 v23, 0
    v_mov_b32 v24, 0
    v_mov_b32 v25, 0
    v_mov_b32 v26, 0
    v_mov_b32 v27, 0
    v_mov_b32 v28, 0
    v_mov_b32 v29, 0
    v_mov_b32 v30, 0
    v_mov_b32 v31, 0
    v_mov_b32 v32, 0
    v_mov_b32 v33, 0
    v_mov_b32 v34, 0
    v_mov_b32 v35, 0
    v_mov_b32 v36, 0
    v_mov_b32 v37, 0
    v_mov_b32 v38, 0
    v_mov_b32 v39, 0
    v_mov_b32 v40, 0
    v_mov_b32 v41, 0
    v_mov_b32 v42, 0
    v_mov_b32 v43, 0
    v_mov_b32 v44, 0
    v_mov_b32 v45, 0
    v_mov_b32 v46, 0
    v_mov_b32 v47, 0
    v_mov_b32 v48, 0
    v_mov_b32 v49, 0
    v_mov_b32 v50, 0
    v_mov_b32 v51, 0
    v_mov_b32 v52, 0
    v_mov_b32 v53, 0
    v_mov_b32 v54, 0
    v_mov_b32 v55, 0
    v_mov_b32 v56, 0
    v_mov_b32 v57, 0
    v_mov_b32 v58, 0
    v_mov_b32 v59, 0
    v_mov_b32 v60, 0
    v_mov_b32 v61, 0
    v_mov_b32 v62, 0
    v_mov_b32 v63, 0
    v_mov_b32 v64, 0
    v_mov_b32 v65, 0
    v_mov_b32 v66, 0
    v_mov_b32 v67, 0
    v_mov_b32 v68, 0
    v_mov_b32 v69, 0
    v_mov_b32 v70, 0
    v_mov_b32 v71, 0
    v_mov_b32 v72, 0
    v_mov_b32 v73, 0
    v_mov_b32 v74, 0
    v_mov_b32 v75, 0
    v_mov_b32 v76, 0
    v_mov_b32 v77, 0
    v_mov_b32 v78, 0
    v_mov_b32 v79, 0
    v_mov_b32 v80, 0
    v_mov_b32 v81, 0
    v_mov_b32 v82, 0
    v_mov_b32 v83, 0
    v_mov_b32 v84, 0
    v_mov_b32 v85, 0
    v_mov_b32 v86, 0
    v_mov_b32 v87, 0
    v_mov_b32 v88, 0
    v_mov_b32 v89, 0
    v_mov_b32 v90, 0
    v_mov_b32 v91, 0
    v_mov_b32 v92, 0
    v_mov_b32 v93, 0
    v_mov_b32 v94, 0
    v_mov_b32 v95, 0
    s_add_u32 m0, s46, s48
    s_add_u32 s32, s44, 8192
    buffer_load_dwordx4 v2, s[16:19], s44 offen nt lds
    s_add_u32 m0, m0, 1056
    s_add_u32 s44, s44, 262144
    buffer_load_dwordx4 v2, s[16:19], s32 offen nt lds
    s_cmp_ge_u32 s44, 5242880
    s_cselect_b32 s32, 5242880, 0
    s_sub_u32 s44, s44, s32
    s_add_u32 s46, s46, 16896
    s_cmp_eq_u32 s46, 163584
    s_cselect_b32 s46, 79104, s46
    s_cmp_ge_u32 s3, 6
    s_cbranch_scc1 Pc_3
    s_add_u32 s32, s45, s49
    s_add_u32 m0, s50, 18432
    s_nop 0
    buffer_load_dwordx4 v3, s[4:7], s32 offen lds
    s_add_u32 m0, s50, 19456
    s_add_u32 s32, s32, 10240
    buffer_load_dwordx4 v4, s[4:7], s32 offen lds
    s_add_u32 m0, s50, 20480
    s_add_u32 s32, s32, 10240
    buffer_load_dwordx4 v3, s[4:7], s32 offen lds
    s_add_u32 s45, s45, 128
    s_cmp_eq_u32 s45, 1280
    s_cselect_b32 s45, 0, s45
    s_branch Pc_4
Pc_3:
Pc_4:
    s_cmp_ge_u32 s3, 6
    s_cbranch_scc1 Pc_5
    s_waitcnt vmcnt(7)
    s_branch Pc_6
Pc_5:
    s_waitcnt vmcnt(4)
Pc_6:
    s_barrier
    s_cmp_ge_u32 s3, 6
    s_cbranch_scc1 PG_c
    s_cmp_ge_u32 s3, 4
    s_cbranch_scc1 PG_b
    v_add_u32 v6, s47, v5
    ds_read_b64_tr_b16 v[96:97], v6 offset:0
    ds_read_b64_tr_b16 v[98:99], v6 offset:256
    ds_read_b64_tr_b16 v[100:101], v6 offset:32
    ds_read_b64_tr_b16 v[102:103], v6 offset:288
    ds_read_b64_tr_b16 v[104:105], v6 offset:64
    ds_read_b64_tr_b16 v[106:107], v6 offset:320
    ds_read_b64_tr_b16 v[108:109], v6 offset:96
    ds_read_b64_tr_b16 v[110:111], v6 offset:352
    s_add_u32 s47, s47, 16896
    s_cmp_eq_u32 s47, 163584
    s_cselect_b32 s47, 79104, s47
    ds_read_b128 v[128:131], v7 offset:0
    ds_read_b128 v[132:135], v7 offset:2048
    ds_read_b128 v[136:139], v7 offset:4096
    ds_read_b128 v[140:143], v7 offset:6144
    ds_read_b128 v[144:147], v7 offset:8192
    ds_read_b128 v[148:151], v8 offset:0
    ds_read_b128 v[152:155], v8 offset:2048
    ds_read_b128 v[156:159], v8 offset:4096
    ds_read_b128 v[160:163], v8 offset:6144
    ds_read_b128 v[164:167], v8 offset:8192
    s_add_u32 m0, s46, s48
    s_add_u32 s32, s44, 8192
    buffer_load_dwordx4 v2, s[16:19], s44 offen nt lds
    s_add_u32 m0, m0, 1056
    s_add_u32 s44, s44, 262144
    buffer_load_dwordx4 v2, s[16:19], s32 offen nt lds
    s_cmp_ge_u32 s44, 5242880
    s_cselect_b32 s32, 5242880, 0
    s_sub_u32 s44, s44, s32
    s_add_u32 s46, s46, 16896
    s_cmp_eq_u32 s46, 163584
    s_cselect_b32 s46, 79104, s46
    s_add_u32 m0, s46, s48
    s_add_u32 s32, s44, 8192
    buffer_load_dwordx4 v2, s[16:19], s44 offen nt lds
    s_add_u32 m0, m0, 1056
    s_add_u32 s44, s44, 262144
    buffer_load_dwordx4 v2, s[16:19], s32 offen nt lds
    s_cmp_ge_u32 s44, 5242880
    s_cselect_b32 s32, 5242880, 0
    s_sub_u32 s44, s44, s32
    s_add_u32 s46, s46, 16896
    s_cmp_eq_u32 s46, 163584
    s_cselect_b32 s46, 79104, s46
    s_waitcnt lgkmcnt(0)
    s_waitcnt vmcnt(9)
    s_barrier
    s_mov_b32 s30, 3
PG_a_loop:
    v_mfma_f32_16x16x32_bf16 v[16:19], v[96:99], v[128:131], v[16:19]
    v_add_u32 v6, s47, v5
    ds_read_b64_tr_b16 v[112:113], v6 offset:0
    v_mfma_f32_16x16x32_bf16 v[20:23], v[100:103], v[128:131], v[20:23]
    ds_read_b64_tr_b16 v[114:115], v6 offset:256
    ds_read_b64_tr_b16 v[116:117], v6 offset:32
    v_mfma_f32_16x16x32_bf16 v[24:27], v[104:107], v[128:131], v[24:27]
    ds_read_b64_tr_b16 v[118:119], v6 offset:288
    ds_read_b64_tr_b16 v[120:121], v6 offset:64
    v_mfma_f32_16x16x32_bf16 v[28:31], v[108:111], v[128:131], v[28:31]
    ds_read_b64_tr_b16 v[122:123], v6 offset:320
    v_mfma_f32_16x16x32_bf16 v[32:35], v[96:99], v[132:135], v[32:35]
    ds_read_b64_tr_b16 v[124:125], v6 offset:96
    ds_read_b64_tr_b16 v[126:127], v6 offset:352
    v_mfma_f32_16x16x32_bf16 v[36:39], v[100:103], v[132:135], v[36:39]
    s_add_u32 s47, s47, 16896
    s_cmp_eq_u32 s47, 163584
    v_mfma_f32_16x16x32_bf16 v[40:43], v[104:107], v[132:135], v[40:43]
    s_cselect_b32 s47, 79104, s47
    s_add_u32 s32, s45, s49
    v_mfma_f32_16x16x32_bf16 v[44:47], v[108:111], v[132:135], v[44:47]
    s_add_u32 m0, s50, 0
    s_nop 0
    v_mfma_f32_16x16x32_bf16 v[48:51], v[96:99], v[136:139], v[48:51]
    buffer_load_dwordx4 v3, s[4:7], s32 offen lds
    s_add_u32 m0, s50, 1024
    v_mfma_f32_16x16x32_bf16 v[52:55], v[100:103], v[136:139], v[52:55]
    s_add_u32 s32, s32, 10240
    buffer_load_dwordx4 v4, s[4:7], s32 offen lds
    v_mfma_f32_16x16x32_bf16 v[56:59], v[104:107], v[136:139], v[56:59]
    s_add_u32 m0, s50, 2048
    v_mfma_f32_16x16x32_bf16 v[60:63], v[108:111], v[136:139], v[60:63]
    s_add_u32 s32, s32, 10240
    buffer_load_dwordx4 v3, s[4:7], s32 offen lds
    v_mfma_f32_16x16x32_bf16 v[64:67], v[96:99], v[140:143], v[64:67]
    s_add_u32 s45, s45, 128
    s_cmp_eq_u32 s45, 1280
    v_mfma_f32_16x16x32_bf16 v[68:71], v[100:103], v[140:143], v[68:71]
    s_cselect_b32 s45, 0, s45
    s_add_u32 m0, s46, s48
    v_mfma_f32_16x16x32_bf16 v[72:75], v[104:107], v[140:143], v[72:75]
    s_add_u32 s32, s44, 8192
    buffer_load_dwordx4 v2, s[16:19], s44 offen nt lds
    v_mfma_f32_16x16x32_bf16 v[76:79], v[108:111], v[140:143], v[76:79]
    s_add_u32 m0, m0, 1056
    s_add_u32 s44, s44, 262144
    v_mfma_f32_16x16x32_bf16 v[80:83], v[96:99], v[144:147], v[80:83]
    buffer_load_dwordx4 v2, s[16:19], s32 offen nt lds
    v_mfma_f32_16x16x32_bf16 v[84:87], v[100:103], v[144:147], v[84:87]
    s_cmp_ge_u32 s44, 5242880
    s_cselect_b32 s32, 5242880, 0
    v_mfma_f32_16x16x32_bf16 v[88:91], v[104:107], v[144:147], v[88:91]
    s_sub_u32 s44, s44, s32
    s_add_u32 s46, s46, 16896
    v_mfma_f32_16x16x32_bf16 v[92:95], v[108:111], v[144:147], v[92:95]
    s_cmp_eq_u32 s46, 163584
    s_cselect_b32 s46, 79104, s46
    s_waitcnt lgkmcnt(0)
    s_waitcnt vmcnt(9)
    s_barrier
    v_mfma_f32_16x16x32_bf16 v[16:19], v[112:115], v[148:151], v[16:19]
    ds_read_b128 v[128:131], v7 offset:18432
    ds_read_b128 v[132:135], v7 offset:20480
    v_mfma_f32_16x16x32_bf16 v[20:23], v[116:119], v[148:151], v[20:23]
    ds_read_b128 v[136:139], v7 offset:22528
    v_mfma_f32_16x16x32_bf16 v[24:27], v[120:123], v[148:151], v[24:27]
    ds_read_b128 v[140:143], v7 offset:24576
    ds_read_b128 v[144:147], v7 offset:26624
    v_mfma_f32_16x16x32_bf16 v[28:31], v[124:127], v[148:151], v[28:31]
    ds_read_b128 v[148:151], v8 offset:18432
    v_add_u32 v6, s47, v5
    v_mfma_f32_16x16x32_bf16 v[32:35], v[112:115], v[152:155], v[32:35]
    ds_read_b64_tr_b16 v[96:97], v6 offset:0
    ds_read_b64_tr_b16 v[98:99], v6 offset:256
    v_mfma_f32_16x16x32_bf16 v[36:39], v[116:119], v[152:155], v[36:39]
    ds_read_b64_tr_b16 v[100:101], v6 offset:32
    v_mfma_f32_16x16x32_bf16 v[40:43], v[120:123], v[152:155], v[40:43]
    ds_read_b64_tr_b16 v[102:103], v6 offset:288
    ds_read_b64_tr_b16 v[104:105], v6 offset:64
    v_mfma_f32_16x16x32_bf16 v[44:47], v[124:127], v[152:155], v[44:47]
    ds_read_b128 v[152:155], v8 offset:20480
    ds_read_b64_tr_b16 v[106:107], v6 offset:320
    v_mfma_f32_16x16x32_bf16 v[48:51], v[112:115], v[156:159], v[48:51]
    ds_read_b64_tr_b16 v[108:109], v6 offset:96
    v_mfma_f32_16x16x32_bf16 v[52:55], v[116:119], v[156:159], v[52:55]
    ds_read_b64_tr_b16 v[110:111], v6 offset:352
    s_add_u32 s47, s47, 16896
    v_mfma_f32_16x16x32_bf16 v[56:59], v[120:123], v[156:159], v[56:59]
    s_cmp_eq_u32 s47, 163584
    s_cselect_b32 s47, 79104, s47
    v_mfma_f32_16x16x32_bf16 v[60:63], v[124:127], v[156:159], v[60:63]
    ds_read_b128 v[156:159], v8 offset:22528
    v_mfma_f32_16x16x32_bf16 v[64:67], v[112:115], v[160:163], v[64:67]
    s_add_u32 m0, s46, s48
    s_add_u32 s32, s44, 8192
    v_mfma_f32_16x16x32_bf16 v[68:71], v[116:119], v[160:163], v[68:71]
    buffer_load_dwordx4 v2, s[16:19], s44 offen nt lds
    s_add_u32 m0, m0, 1056
    v_mfma_f32_16x16x32_bf16 v[72:75], v[120:123], v[160:163], v[72:75]
    s_add_u32 s44, s44, 262144
    buffer_load_dwordx4 v2, s[16:19], s32 offen nt lds
    v_mfma_f32_16x16x32_bf16 v[76:79], v[124:127], v[160:163], v[76:79]
    ds_read_b128 v[160:163], v8 offset:24576
    v_mfma_f32_16x16x32_bf16 v[80:83], v[112:115], v[164:167], v[80:83]
    s_cmp_ge_u32 s44, 5242880
    s_cselect_b32 s32, 5242880, 0
    v_mfma_f32_16x16x32_bf16 v[84:87], v[116:119], v[164:167], v[84:87]
    s_sub_u32 s44, s44, s32
    s_add_u32 s46, s46, 16896
    v_mfma_f32_16x16x32_bf16 v[88:91], v[120:123], v[164:167], v[88:91]
    s_cmp_eq_u32 s46, 163584
    v_mfma_f32_16x16x32_bf16 v[92:95], v[124:127], v[164:167], v[92:95]
    ds_read_b128 v[164:167], v8 offset:26624
    s_cselect_b32 s46, 79104, s46
    s_waitcnt lgkmcnt(0)
    s_waitcnt vmcnt(9)
    s_barrier
    v_mfma_f32_16x16x32_bf16 v[16:19], v[96:99], v[128:131], v[16:19]
    v_add_u32 v6, s47, v5
    ds_read_b64_tr_b16 v[112:113], v6 offset:0
    v_mfma_f32_16x16x32_bf16 v[20:23], v[100:103], v[128:131], v[20:23]
    ds_read_b64_tr_b16 v[114:115], v6 offset:256
    ds_read_b64_tr_b16 v[116:117], v6 offset:32
    v_mfma_f32_16x16x32_bf16 v[24:27], v[104:107], v[128:131], v[24:27]
    ds_read_b64_tr_b16 v[118:119], v6 offset:288
    ds_read_b64_tr_b16 v[120:121], v6 offset:64
    v_mfma_f32_16x16x32_bf16 v[28:31], v[108:111], v[128:131], v[28:31]
    ds_read_b64_tr_b16 v[122:123], v6 offset:320
    v_mfma_f32_16x16x32_bf16 v[32:35], v[96:99], v[132:135], v[32:35]
    ds_read_b64_tr_b16 v[124:125], v6 offset:96
    ds_read_b64_tr_b16 v[126:127], v6 offset:352
    v_mfma_f32_16x16x32_bf16 v[36:39], v[100:103], v[132:135], v[36:39]
    s_add_u32 s47, s47, 16896
    s_cmp_eq_u32 s47, 163584
    v_mfma_f32_16x16x32_bf16 v[40:43], v[104:107], v[132:135], v[40:43]
    s_cselect_b32 s47, 79104, s47
    s_add_u32 s32, s45, s49
    v_mfma_f32_16x16x32_bf16 v[44:47], v[108:111], v[132:135], v[44:47]
    s_add_u32 m0, s50, 18432
    s_nop 0
    v_mfma_f32_16x16x32_bf16 v[48:51], v[96:99], v[136:139], v[48:51]
    buffer_load_dwordx4 v3, s[4:7], s32 offen lds
    s_add_u32 m0, s50, 19456
    v_mfma_f32_16x16x32_bf16 v[52:55], v[100:103], v[136:139], v[52:55]
    s_add_u32 s32, s32, 10240
    buffer_load_dwordx4 v4, s[4:7], s32 offen lds
    v_mfma_f32_16x16x32_bf16 v[56:59], v[104:107], v[136:139], v[56:59]
    s_add_u32 m0, s50, 20480
    v_mfma_f32_16x16x32_bf16 v[60:63], v[108:111], v[136:139], v[60:63]
    s_add_u32 s32, s32, 10240
    buffer_load_dwordx4 v3, s[4:7], s32 offen lds
    v_mfma_f32_16x16x32_bf16 v[64:67], v[96:99], v[140:143], v[64:67]
    s_add_u32 s45, s45, 128
    s_cmp_eq_u32 s45, 1280
    v_mfma_f32_16x16x32_bf16 v[68:71], v[100:103], v[140:143], v[68:71]
    s_cselect_b32 s45, 0, s45
    s_add_u32 m0, s46, s48
    v_mfma_f32_16x16x32_bf16 v[72:75], v[104:107], v[140:143], v[72:75]
    s_add_u32 s32, s44, 8192
    buffer_load_dwordx4 v2, s[16:19], s44 offen nt lds
    v_mfma_f32_16x16x32_bf16 v[76:79], v[108:111], v[140:143], v[76:79]
    s_add_u32 m0, m0, 1056
    s_add_u32 s44, s44, 262144
    v_mfma_f32_16x16x32_bf16 v[80:83], v[96:99], v[144:147], v[80:83]
    buffer_load_dwordx4 v2, s[16:19], s32 offen nt lds
    v_mfma_f32_16x16x32_bf16 v[84:87], v[100:103], v[144:147], v[84:87]
    s_cmp_ge_u32 s44, 5242880
    s_cselect_b32 s32, 5242880, 0
    v_mfma_f32_16x16x32_bf16 v[88:91], v[104:107], v[144:147], v[88:91]
    s_sub_u32 s44, s44, s32
    s_add_u32 s46, s46, 16896
    v_mfma_f32_16x16x32_bf16 v[92:95], v[108:111], v[144:147], v[92:95]
    s_cmp_eq_u32 s46, 163584
    s_cselect_b32 s46, 79104, s46
    s_waitcnt lgkmcnt(0)
    s_waitcnt vmcnt(9)
    s_barrier
    v_mfma_f32_16x16x32_bf16 v[16:19], v[112:115], v[148:151], v[16:19]
    ds_read_b128 v[128:131], v7 offset:0
    ds_read_b128 v[132:135], v7 offset:2048
    v_mfma_f32_16x16x32_bf16 v[20:23], v[116:119], v[148:151], v[20:23]
    ds_read_b128 v[136:139], v7 offset:4096
    v_mfma_f32_16x16x32_bf16 v[24:27], v[120:123], v[148:151], v[24:27]
    ds_read_b128 v[140:143], v7 offset:6144
    ds_read_b128 v[144:147], v7 offset:8192
    v_mfma_f32_16x16x32_bf16 v[28:31], v[124:127], v[148:151], v[28:31]
    ds_read_b128 v[148:151], v8 offset:0
    v_add_u32 v6, s47, v5
    v_mfma_f32_16x16x32_bf16 v[32:35], v[112:115], v[152:155], v[32:35]
    ds_read_b64_tr_b16 v[96:97], v6 offset:0
    ds_read_b64_tr_b16 v[98:99], v6 offset:256
    v_mfma_f32_16x16x32_bf16 v[36:39], v[116:119], v[152:155], v[36:39]
    ds_read_b64_tr_b16 v[100:101], v6 offset:32
    v_mfma_f32_16x16x32_bf16 v[40:43], v[120:123], v[152:155], v[40:43]
    ds_read_b64_tr_b16 v[102:103], v6 offset:288
    ds_read_b64_tr_b16 v[104:105], v6 offset:64
    v_mfma_f32_16x16x32_bf16 v[44:47], v[124:127], v[152:155], v[44:47]
    ds_read_b128 v[152:155], v8 offset:2048
    ds_read_b64_tr_b16 v[106:107], v6 offset:320
    v_mfma_f32_16x16x32_bf16 v[48:51], v[112:115], v[156:159], v[48:51]
    ds_read_b64_tr_b16 v[108:109], v6 offset:96
    v_mfma_f32_16x16x32_bf16 v[52:55], v[116:119], v[156:159], v[52:55]
    ds_read_b64_tr_b16 v[110:111], v6 offset:352
    s_add_u32 s47, s47, 16896
    v_mfma_f32_16x16x32_bf16 v[56:59], v[120:123], v[156:159], v[56:59]
    s_cmp_eq_u32 s47, 163584
    s_cselect_b32 s47, 79104, s47
    v_mfma_f32_16x16x32_bf16 v[60:63], v[124:127], v[156:159], v[60:63]
    ds_read_b128 v[156:159], v8 offset:4096
    v_mfma_f32_16x16x32_bf16 v[64:67], v[112:115], v[160:163], v[64:67]
    s_add_u32 m0, s46, s48
    s_add_u32 s32, s44, 8192
    v_mfma_f32_16x16x32_bf16 v[68:71], v[116:119], v[160:163], v[68:71]
    buffer_load_dwordx4 v2, s[16:19], s44 offen nt lds
    s_add_u32 m0, m0, 1056
    v_mfma_f32_16x16x32_bf16 v[72:75], v[120:123], v[160:163], v[72:75]
    s_add_u32 s44, s44, 262144
    buffer_load_dwordx4 v2, s[16:19], s32 offen nt lds
    v_mfma_f32_16x16x32_bf16 v[76:79], v[124:127], v[160:163], v[76:79]
    ds_read_b128 v[160:163], v8 offset:6144
    v_mfma_f32_16x16x32_bf16 v[80:83], v[112:115], v[164:167], v[80:83]
    s_cmp_ge_u32 s44, 5242880
    s_cselect_b32 s32, 5242880, 0
    v_mfma_f32_16x16x32_bf16 v[84:87], v[116:119], v[164:167], v[84:87]
    s_sub_u32 s44, s44, s32
    s_add_u32 s46, s46, 16896
    v_mfma_f32_16x16x32_bf16 v[88:91], v[120:123], v[164:167], v[88:91]
    s_cmp_eq_u32 s46, 163584
    v_mfma_f32_16x16x32_bf16 v[92:95], v[124:127], v[164:167], v[92:95]
    ds_read_b128 v[164:167], v8 offset:8192
    s_cselect_b32 s46, 79104, s46
    s_waitcnt lgkmcnt(0)
    s_waitcnt vmcnt(9)
    s_sub_u32 s30, s30, 1
    s_cmp_lg_u32 s30, 0
    s_barrier
    s_cbranch_scc1 PG_a_loop
    v_mfma_f32_16x16x32_bf16 v[16:19], v[96:99], v[128:131], v[16:19]
    v_add_u32 v6, s47, v5
    ds_read_b64_tr_b16 v[112:113], v6 offset:0
    v_mfma_f32_16x16x32_bf16 v[20:23], v[100:103], v[128:131], v[20:23]
    ds_read_b64_tr_b16 v[114:115], v6 offset:256
    ds_read_b64_tr_b16 v[116:117], v6 offset:32
    v_mfma_f32_16x16x32_bf16 v[24:27], v[104:107], v[128:131], v[24:27]
    ds_read_b64_tr_b16 v[118:119], v6 offset:288
    ds_read_b64_tr_b16 v[120:121], v6 offset:64
    v_mfma_f32_16x16x32_bf16 v[28:31], v[108:111], v[128:131], v[28:31]
    ds_read_b64_tr_b16 v[122:123], v6 offset:320
    v_mfma_f32_16x16x32_bf16 v[32:35], v[96:99], v[132:135], v[32:35]
    ds_read_b64_tr_b16 v[124:125], v6 offset:96
    ds_read_b64_tr_b16 v[126:127], v6 offset:352
    v_mfma_f32_16x16x32_bf16 v[36:39], v[100:103], v[132:135], v[36:39]
    s_add_u32 s47, s47, 16896
    s_cmp_eq_u32 s47, 163584
    v_mfma_f32_16x16x32_bf16 v[40:43], v[104:107], v[132:135], v[40:43]
    s_cselect_b32 s47, 79104, s47
    s_add_u32 s32, s45, s49
    v_mfma_f32_16x16x32_bf16 v[44:47], v[108:111], v[132:135], v[44:47]
    s_add_u32 m0, s50, 0
    s_nop 0
    v_mfma_f32_16x16x32_bf16 v[48:51], v[96:99], v[136:139], v[48:51]
    buffer_load_dwordx4 v3, s[4:7], s32 offen lds
    s_add_u32 m0, s50, 1024
    v_mfma_f32_16x16x32_bf16 v[52:55], v[100:103], v[136:139], v[52:55]
    s_add_u32 s32, s32, 10240
    buffer_load_dwordx4 v4, s[4:7], s32 offen lds
    v_mfma_f32_16x16x32_bf16 v[56:59], v[104:107], v[136:139], v[56:59]
    s_add_u32 m0, s50, 2048
    v_mfma_f32_16x16x32_bf16 v[60:63], v[108:111], v[136:139], v[60:63]
    s_add_u32 s32, s32, 10240
    buffer_load_dwordx4 v3, s[4:7], s32 offen lds
    v_mfma_f32_16x16x32_bf16 v[64:67], v[96:99], v[140:143], v[64:67]
    s_add_u32 s45, s45, 128
    s_cmp_eq_u32 s45, 1280
    v_mfma_f32_16x16x32_bf16 v[68:71], v[100:103], v[140:143], v[68:71]
    s_cselect_b32 s45, 0, s45
    s_add_u32 m0, s46, s48
    v_mfma_f32_16x16x32_bf16 v[72:75], v[104:107], v[140:143], v[72:75]
    s_add_u32 s32, s44, 8192
    buffer_load_dwordx4 v2, s[16:19], s44 offen nt lds
    v_mfma_f32_16x16x32_bf16 v[76:79], v[108:111], v[140:143], v[76:79]
    s_add_u32 m0, m0, 1056
    s_add_u32 s44, s44, 262144
    v_mfma_f32_16x16x32_bf16 v[80:83], v[96:99], v[144:147], v[80:83]
    buffer_load_dwordx4 v2, s[16:19], s32 offen nt lds
    v_mfma_f32_16x16x32_bf16 v[84:87], v[100:103], v[144:147], v[84:87]
    s_cmp_ge_u32 s44, 5242880
    s_cselect_b32 s32, 5242880, 0
    v_mfma_f32_16x16x32_bf16 v[88:91], v[104:107], v[144:147], v[88:91]
    s_sub_u32 s44, s44, s32
    s_add_u32 s46, s46, 16896
    v_mfma_f32_16x16x32_bf16 v[92:95], v[108:111], v[144:147], v[92:95]
    s_cmp_eq_u32 s46, 163584
    s_cselect_b32 s46, 79104, s46
    s_waitcnt lgkmcnt(0)
    s_waitcnt vmcnt(9)
    s_barrier
    v_mfma_f32_16x16x32_bf16 v[16:19], v[112:115], v[148:151], v[16:19]
    ds_read_b128 v[128:131], v7 offset:18432
    ds_read_b128 v[132:135], v7 offset:20480
    v_mfma_f32_16x16x32_bf16 v[20:23], v[116:119], v[148:151], v[20:23]
    ds_read_b128 v[136:139], v7 offset:22528
    v_mfma_f32_16x16x32_bf16 v[24:27], v[120:123], v[148:151], v[24:27]
    ds_read_b128 v[140:143], v7 offset:24576
    ds_read_b128 v[144:147], v7 offset:26624
    v_mfma_f32_16x16x32_bf16 v[28:31], v[124:127], v[148:151], v[28:31]
    ds_read_b128 v[148:151], v8 offset:18432
    v_add_u32 v6, s47, v5
    v_mfma_f32_16x16x32_bf16 v[32:35], v[112:115], v[152:155], v[32:35]
    ds_read_b64_tr_b16 v[96:97], v6 offset:0
    ds_read_b64_tr_b16 v[98:99], v6 offset:256
    v_mfma_f32_16x16x32_bf16 v[36:39], v[116:119], v[152:155], v[36:39]
    ds_read_b64_tr_b16 v[100:101], v6 offset:32
    v_mfma_f32_16x16x32_bf16 v[40:43], v[120:123], v[152:155], v[40:43]
    ds_read_b64_tr_b16 v[102:103], v6 offset:288
    ds_read_b64_tr_b16 v[104:105], v6 offset:64
    v_mfma_f32_16x16x32_bf16 v[44:47], v[124:127], v[152:155], v[44:47]
    ds_read_b128 v[152:155], v8 offset:20480
    ds_read_b64_tr_b16 v[106:107], v6 offset:320
    v_mfma_f32_16x16x32_bf16 v[48:51], v[112:115], v[156:159], v[48:51]
    ds_read_b64_tr_b16 v[108:109], v6 offset:96
    v_mfma_f32_16x16x32_bf16 v[52:55], v[116:119], v[156:159], v[52:55]
    ds_read_b64_tr_b16 v[110:111], v6 offset:352
    s_add_u32 s47, s47, 16896
    v_mfma_f32_16x16x32_bf16 v[56:59], v[120:123], v[156:159], v[56:59]
    s_cmp_eq_u32 s47, 163584
    s_cselect_b32 s47, 79104, s47
    v_mfma_f32_16x16x32_bf16 v[60:63], v[124:127], v[156:159], v[60:63]
    ds_read_b128 v[156:159], v8 offset:22528
    v_mfma_f32_16x16x32_bf16 v[64:67], v[112:115], v[160:163], v[64:67]
    s_add_u32 m0, s46, s48
    s_add_u32 s32, s44, 8192
    v_mfma_f32_16x16x32_bf16 v[68:71], v[116:119], v[160:163], v[68:71]
    buffer_load_dwordx4 v2, s[16:19], s44 offen nt lds
    s_add_u32 m0, m0, 1056
    v_mfma_f32_16x16x32_bf16 v[72:75], v[120:123], v[160:163], v[72:75]
    s_add_u32 s44, s44, 262144
    buffer_load_dwordx4 v2, s[16:19], s32 offen nt lds
    v_mfma_f32_16x16x32_bf16 v[76:79], v[124:127], v[160:163], v[76:79]
    ds_read_b128 v[160:163], v8 offset:24576
    v_mfma_f32_16x16x32_bf16 v[80:83], v[112:115], v[164:167], v[80:83]
    s_cmp_ge_u32 s44, 5242880
    s_cselect_b32 s32, 5242880, 0
    v_mfma_f32_16x16x32_bf16 v[84:87], v[116:119], v[164:167], v[84:87]
    s_sub_u32 s44, s44, s32
    s_add_u32 s46, s46, 16896
    v_mfma_f32_16x16x32_bf16 v[88:91], v[120:123], v[164:167], v[88:91]
    s_cmp_eq_u32 s46, 163584
    v_mfma_f32_16x16x32_bf16 v[92:95], v[124:127], v[164:167], v[92:95]
    ds_read_b128 v[164:167], v8 offset:26624
    s_cselect_b32 s46, 79104, s46
    s_waitcnt lgkmcnt(0)
    s_waitcnt vmcnt(9)
    s_barrier
    v_mfma_f32_16x16x32_bf16 v[16:19], v[96:99], v[128:131], v[16:19]
    v_add_u32 v6, s47, v5
    ds_read_b64_tr_b16 v[112:113], v6 offset:0
    v_mfma_f32_16x16x32_bf16 v[20:23], v[100:103], v[128:131], v[20:23]
    ds_read_b64_tr_b16 v[114:115], v6 offset:256
    ds_read_b64_tr_b16 v[116:117], v6 offset:32
    v_mfma_f32_16x16x32_bf16 v[24:27], v[104:107], v[128:131], v[24:27]
    ds_read_b64_tr_b16 v[118:119], v6 offset:288
    ds_read_b64_tr_b16 v[120:121], v6 offset:64
    v_mfma_f32_16x16x32_bf16 v[28:31], v[108:111], v[128:131], v[28:31]
    ds_read_b64_tr_b16 v[122:123], v6 offset:320
    v_mfma_f32_16x16x32_bf16 v[32:35], v[96:99], v[132:135], v[32:35]
    ds_read_b64_tr_b16 v[124:125], v6 offset:96
    ds_read_b64_tr_b16 v[126:127], v6 offset:352
    v_mfma_f32_16x16x32_bf16 v[36:39], v[100:103], v[132:135], v[36:39]
    s_add_u32 s47, s47, 16896
    s_cmp_eq_u32 s47, 163584
    v_mfma_f32_16x16x32_bf16 v[40:43], v[104:107], v[132:135], v[40:43]
    s_cselect_b32 s47, 79104, s47
    s_add_u32 s32, s45, s49
    v_mfma_f32_16x16x32_bf16 v[44:47], v[108:111], v[132:135], v[44:47]
    s_add_u32 m0, s50, 18432
    s_nop 0
    v_mfma_f32_16x16x32_bf16 v[48:51], v[96:99], v[136:139], v[48:51]
    buffer_load_dwordx4 v3, s[4:7], s32 offen lds
    s_add_u32 m0, s50, 19456
    v_mfma_f32_16x16x32_bf16 v[52:55], v[100:103], v[136:139], v[52:55]
    s_add_u32 s32, s32, 10240
    buffer_load_dwordx4 v4, s[4:7], s32 offen lds
    v_mfma_f32_16x16x32_bf16 v[56:59], v[104:107], v[136:139], v[56:59]
    s_add_u32 m0, s50, 20480
    v_mfma_f32_16x16x32_bf16 v[60:63], v[108:111], v[136:139], v[60:63]
    s_add_u32 s32, s32, 10240
    buffer_load_dwordx4 v3, s[4:7], s32 offen lds
    v_mfma_f32_16x16x32_bf16 v[64:67], v[96:99], v[140:143], v[64:67]
    s_add_u32 s45, s45, 128
    s_cmp_eq_u32 s45, 1280
    v_mfma_f32_16x16x32_bf16 v[68:71], v[100:103], v[140:143], v[68:71]
    s_cselect_b32 s45, 0, s45
    s_add_u32 m0, s46, s48
    v_mfma_f32_16x16x32_bf16 v[72:75], v[104:107], v[140:143], v[72:75]
    s_add_u32 s32, s44, 8192
    buffer_load_dwordx4 v2, s[16:19], s44 offen nt lds
    v_mfma_f32_16x16x32_bf16 v[76:79], v[108:111], v[140:143], v[76:79]
    s_add_u32 m0, m0, 1056
    s_add_u32 s44, s44, 262144
    v_mfma_f32_16x16x32_bf16 v[80:83], v[96:99], v[144:147], v[80:83]
    buffer_load_dwordx4 v2, s[16:19], s32 offen nt lds
    v_mfma_f32_16x16x32_bf16 v[84:87], v[100:103], v[144:147], v[84:87]
    s_cmp_ge_u32 s44, 5242880
    s_cselect_b32 s32, 5242880, 0
    v_mfma_f32_16x16x32_bf16 v[88:91], v[104:107], v[144:147], v[88:91]
    s_sub_u32 s44, s44, s32
    s_add_u32 s46, s46, 16896
    v_mfma_f32_16x16x32_bf16 v[92:95], v[108:111], v[144:147], v[92:95]
    s_cmp_eq_u32 s46, 163584
    s_cselect_b32 s46, 79104, s46
    s_waitcnt lgkmcnt(0)
    s_waitcnt vmcnt(9)
    s_barrier
    v_mfma_f32_16x16x32_bf16 v[16:19], v[112:115], v[148:151], v[16:19]
    ds_read_b128 v[128:131], v7 offset:0
    v_mfma_f32_16x16x32_bf16 v[20:23], v[116:119], v[148:151], v[20:23]
    ds_read_b128 v[132:135], v7 offset:2048
    v_mfma_f32_16x16x32_bf16 v[24:27], v[120:123], v[148:151], v[24:27]
    ds_read_b128 v[136:139], v7 offset:4096
    v_mfma_f32_16x16x32_bf16 v[28:31], v[124:127], v[148:151], v[28:31]
    ds_read_b128 v[148:151], v8 offset:0
    v_mfma_f32_16x16x32_bf16 v[32:35], v[112:115], v[152:155], v[32:35]
    ds_read_b128 v[140:143], v7 offset:6144
    ds_read_b128 v[144:147], v7 offset:8192
    v_mfma_f32_16x16x32_bf16 v[36:39], v[116:119], v[152:155], v[36:39]
    v_add_u32 v6, s47, v5
    v_mfma_f32_16x16x32_bf16 v[40:43], v[120:123], v[152:155], v[40:43]
    ds_read_b64_tr_b16 v[96:97], v6 offset:0
    v_mfma_f32_16x16x32_bf16 v[44:47], v[124:127], v[152:155], v[44:47]
    ds_read_b128 v[152:155], v8 offset:2048
    v_mfma_f32_16x16x32_bf16 v[48:51], v[112:115], v[156:159], v[48:51]
    ds_read_b64_tr_b16 v[98:99], v6 offset:256
    v_mfma_f32_16x16x32_bf16 v[52:55], v[116:119], v[156:159], v[52:55]
    ds_read_b64_tr_b16 v[100:101], v6 offset:32
    v_mfma_f32_16x16x32_bf16 v[56:59], v[120:123], v[156:159], v[56:59]
    ds_read_b64_tr_b16 v[102:103], v6 offset:288
    v_mfma_f32_16x16x32_bf16 v[60:63], v[124:127], v[156:159], v[60:63]
    ds_read_b128 v[156:159], v8 offset:4096
    v_mfma_f32_16x16x32_bf16 v[64:67], v[112:115], v[160:163], v[64:67]
    ds_read_b64_tr_b16 v[104:105], v6 offset:64
    v_mfma_f32_16x16x32_bf16 v[68:71], v[116:119], v[160:163], v[68:71]
    ds_read_b64_tr_b16 v[106:107], v6 offset:320
    v_mfma_f32_16x16x32_bf16 v[72:75], v[120:123], v[160:163], v[72:75]
    ds_read_b64_tr_b16 v[108:109], v6 offset:96
    ds_read_b64_tr_b16 v[110:111], v6 offset:352
    v_mfma_f32_16x16x32_bf16 v[76:79], v[124:127], v[160:163], v[76:79]
    ds_read_b128 v[160:163], v8 offset:6144
    v_mfma_f32_16x16x32_bf16 v[80:83], v[112:115], v[164:167], v[80:83]
    s_add_u32 s47, s47, 16896
    v_mfma_f32_16x16x32_bf16 v[84:87], v[116:119], v[164:167], v[84:87]
    s_cmp_eq_u32 s47, 163584
    v_mfma_f32_16x16x32_bf16 v[88:91], v[120:123], v[164:167], v[88:91]
    s_cselect_b32 s47, 79104, s47
    v_mfma_f32_16x16x32_bf16 v[92:95], v[124:127], v[164:167], v[92:95]
    ds_read_b128 v[164:167], v8 offset:8192
    s_waitcnt lgkmcnt(0)
    s_waitcnt vmcnt(7)
    s_barrier
    v_mfma_f32_16x16x32_bf16 v[16:19], v[96:99], v[128:131], v[16:19]
    v_add_u32 v6, s47, v5
    v_mfma_f32_16x16x32_bf16 v[20:23], v[100:103], v[128:131], v[20:23]
    v_mfma_f32_16x16x32_bf16 v[24:27], v[104:107], v[128:131], v[24:27]
    ds_read_b64_tr_b16 v[112:113], v6 offset:0
    v_mfma_f32_16x16x32_bf16 v[28:31], v[108:111], v[128:131], v[28:31]
    v_mfma_f32_16x16x32_bf16 v[32:35], v[96:99], v[132:135], v[32:35]
    ds_read_b64_tr_b16 v[114:115], v6 offset:256
    v_mfma_f32_16x16x32_bf16 v[36:39], v[100:103], v[132:135], v[36:39]
    ds_read_b64_tr_b16 v[116:117], v6 offset:32
    v_mfma_f32_16x16x32_bf16 v[40:43], v[104:107], v[132:135], v[40:43]
    v_mfma_f32_16x16x32_bf16 v[44:47], v[108:111], v[132:135], v[44:47]
    ds_read_b64_tr_b16 v[118:119], v6 offset:288
    v_mfma_f32_16x16x32_bf16 v[48:51], v[96:99], v[136:139], v[48:51]
    v_mfma_f32_16x16x32_bf16 v[52:55], v[100:103], v[136:139], v[52:55]
    ds_read_b64_tr_b16 v[120:121], v6 offset:64
    v_mfma_f32_16x16x32_bf16 v[56:59], v[104:107], v[136:139], v[56:59]
    ds_read_b64_tr_b16 v[122:123], v6 offset:320
    v_mfma_f32_16x16x32_bf16 v[60:63], v[108:111], v[136:139], v[60:63]
    v_mfma_f32_16x16x32_bf16 v[64:67], v[96:99], v[140:143], v[64:67]
    ds_read_b64_tr_b16 v[124:125], v6 offset:96
    v_mfma_f32_16x16x32_bf16 v[68:71], v[100:103], v[140:143], v[68:71]
    v_mfma_f32_16x16x32_bf16 v[72:75], v[104:107], v[140:143], v[72:75]
    ds_read_b64_tr_b16 v[126:127], v6 offset:352
    v_mfma_f32_16x16x32_bf16 v[76:79], v[108:111], v[140:143], v[76:79]
    s_add_u32 s47, s47, 16896
    v_mfma_f32_16x16x32_bf16 v[80:83], v[96:99], v[144:147], v[80:83]
    v_mfma_f32_16x16x32_bf16 v[84:87], v[100:103], v[144:147], v[84:87]
    s_cmp_eq_u32 s47, 163584
    v_mfma_f32_16x16x32_bf16 v[88:91], v[104:107], v[144:147], v[88:91]
    v_mfma_f32_16x16x32_bf16 v[92:95], v[108:111], v[144:147], v[92:95]
    s_cselect_b32 s47, 79104, s47
    s_waitcnt lgkmcnt(0)
    s_waitcnt vmcnt(2)
    s_barrier
    v_mfma_f32_16x16x32_bf16 v[16:19], v[112:115], v[148:151], v[16:19]
    ds_read_b128 v[128:131], v7 offset:18432
    v_mfma_f32_16x16x32_bf16 v[20:23], v[116:119], v[148:151], v[20:23]
    ds_read_b128 v[132:135], v7 offset:20480
    v_mfma_f32_16x16x32_bf16 v[24:27], v[120:123], v[148:151], v[24:27]
    ds_read_b128 v[136:139], v7 offset:22528
    v_mfma_f32_16x16x32_bf16 v[28:31], v[124:127], v[148:151], v[28:31]
    ds_read_b128 v[148:151], v8 offset:18432
    v_mfma_f32_16x16x32_bf16 v[32:35], v[112:115], v[152:155], v[32:35]
    ds_read_b128 v[140:143], v7 offset:24576
    ds_read_b128 v[144:147], v7 offset:26624
    v_mfma_f32_16x16x32_bf16 v[36:39], v[116:119], v[152:155], v[36:39]
    v_add_u32 v6, s47, v5
    v_mfma_f32_16x16x32_bf16 v[40:43], v[120:123], v[152:155], v[40:43]
    ds_read_b64_tr_b16 v[96:97], v6 offset:0
    v_mfma_f32_16x16x32_bf16 v[44:47], v[124:127], v[152:155], v[44:47]
    ds_read_b128 v[152:155], v8 offset:20480
    v_mfma_f32_16x16x32_bf16 v[48:51], v[112:115], v[156:159], v[48:51]
    ds_read_b64_tr_b16 v[98:99], v6 offset:256
    v_mfma_f32_16x16x32_bf16 v[52:55], v[116:119], v[156:159], v[52:55]
    ds_read_b64_tr_b16 v[100:101], v6 offset:32
    v_mfma_f32_16x16x32_bf16 v[56:59], v[120:123], v[156:159], v[56:59]
    ds_read_b64_tr_b16 v[102:103], v6 offset:288
    v_mfma_f32_16x16x32_bf16 v[60:63], v[124:127], v[156:159], v[60:63]
    ds_read_b128 v[156:159], v8 offset:22528
    v_mfma_f32_16x16x32_bf16 v[64:67], v[112:115], v[160:163], v[64:67]
    ds_read_b64_tr_b16 v[104:105], v6 offset:64
    v_mfma_f32_16x16x32_bf16 v[68:71], v[116:119], v[160:163], v[68:71]
    ds_read_b64_tr_b16 v[106:107], v6 offset:320
    v_mfma_f32_16x16x32_bf16 v[72:75], v[120:123], v[160:163], v[72:75]
    ds_read_b64_tr_b16 v[108:109], v6 offset:96
    ds_read_b64_tr_b16 v[110:111], v6 offset:352
    v_mfma_f32_16x16x32_bf16 v[76:79], v[124:127], v[160:163], v[76:79]
    ds_read_b128 v[160:163], v8 offset:24576
    v_mfma_f32_16x16x32_bf16 v[80:83], v[112:115], v[164:167], v[80:83]
    s_add_u32 s47, s47, 16896
    v_mfma_f32_16x16x32_bf16 v[84:87], v[116:119], v[164:167], v[84:87]
    s_cmp_eq_u32 s47, 163584
    v_mfma_f32_16x16x32_bf16 v[88:91], v[120:123], v[164:167], v[88:91]
    s_cselect_b32 s47, 79104, s47
    v_mfma_f32_16x16x32_bf16 v[92:95], v[124:127], v[164:167], v[92:95]
    ds_read_b128 v[164:167], v8 offset:26624
    s_waitcnt lgkmcnt(0)
    s_waitcnt vmcnt(0)
    s_barrier
    v_mfma_f32_16x16x32_bf16 v[16:19], v[96:99], v[128:131], v[16:19]
    v_add_u32 v6, s47, v5
    v_mfma_f32_16x16x32_bf16 v[20:23], v[100:103], v[128:131], v[20:23]
    v_mfma_f32_16x16x32_bf16 v[24:27], v[104:107], v[128:131], v[24:27]
    ds_read_b64_tr_b16 v[112:113], v6 offset:0
    v_mfma_f32_16x16x32_bf16 v[28:31], v[108:111], v[128:131], v[28:31]
    v_mfma_f32_16x16x32_bf16 v[32:35], v[96:99], v[132:135], v[32:35]
    ds_read_b64_tr_b16 v[114:115], v6 offset:256
    v_mfma_f32_16x16x32_bf16 v[36:39], v[100:103], v[132:135], v[36:39]
    ds_read_b64_tr_b16 v[116:117], v6 offset:32
    v_mfma_f32_16x16x32_bf16 v[40:43], v[104:107], v[132:135], v[40:43]
    v_mfma_f32_16x16x32_bf16 v[44:47], v[108:111], v[132:135], v[44:47]
    ds_read_b64_tr_b16 v[118:119], v6 offset:288
    v_mfma_f32_16x16x32_bf16 v[48:51], v[96:99], v[136:139], v[48:51]
    v_mfma_f32_16x16x32_bf16 v[52:55], v[100:103], v[136:139], v[52:55]
    ds_read_b64_tr_b16 v[120:121], v6 offset:64
    v_mfma_f32_16x16x32_bf16 v[56:59], v[104:107], v[136:139], v[56:59]
    ds_read_b64_tr_b16 v[122:123], v6 offset:320
    v_mfma_f32_16x16x32_bf16 v[60:63], v[108:111], v[136:139], v[60:63]
    v_mfma_f32_16x16x32_bf16 v[64:67], v[96:99], v[140:143], v[64:67]
    ds_read_b64_tr_b16 v[124:125], v6 offset:96
    v_mfma_f32_16x16x32_bf16 v[68:71], v[100:103], v[140:143], v[68:71]
    v_mfma_f32_16x16x32_bf16 v[72:75], v[104:107], v[140:143], v[72:75]
    ds_read_b64_tr_b16 v[126:127], v6 offset:352
    v_mfma_f32_16x16x32_bf16 v[76:79], v[108:111], v[140:143], v[76:79]
    s_add_u32 s47, s47, 16896
    v_mfma_f32_16x16x32_bf16 v[80:83], v[96:99], v[144:147], v[80:83]
    v_mfma_f32_16x16x32_bf16 v[84:87], v[100:103], v[144:147], v[84:87]
    s_cmp_eq_u32 s47, 163584
    v_mfma_f32_16x16x32_bf16 v[88:91], v[104:107], v[144:147], v[88:91]
    v_mfma_f32_16x16x32_bf16 v[92:95], v[108:111], v[144:147], v[92:95]
    s_cselect_b32 s47, 79104, s47
    s_waitcnt lgkmcnt(0)
    s_barrier
    v_mfma_f32_16x16x32_bf16 v[16:19], v[112:115], v[148:151], v[16:19]
    s_mov_b32 s34, 0x3e0293ee
    s_mov_b32 s35, 0x3e0293ee
    v_mfma_f32_16x16x32_bf16 v[20:23], v[116:119], v[148:151], v[20:23]
    v_mfma_f32_16x16x32_bf16 v[24:27], v[120:123], v[148:151], v[24:27]
    v_mfma_f32_16x16x32_bf16 v[28:31], v[124:127], v[148:151], v[28:31]
    v_mfma_f32_16x16x32_bf16 v[32:35], v[112:115], v[152:155], v[32:35]
    v_mfma_f32_16x16x32_bf16 v[36:39], v[116:119], v[152:155], v[36:39]
    v_mfma_f32_16x16x32_bf16 v[40:43], v[120:123], v[152:155], v[40:43]
    v_mfma_f32_16x16x32_bf16 v[44:47], v[124:127], v[152:155], v[44:47]
    v_mfma_f32_16x16x32_bf16 v[48:51], v[112:115], v[156:159], v[48:51]
    v_pk_mul_f32 v[16:17], v[16:17], s[34:35]
    v_pk_mul_f32 v[18:19], v[18:19], s[34:35]
    v_cvt_pk_bf16_f32 v16, v16, v17
    v_cvt_pk_bf16_f32 v17, v18, v19
    ds_write_b64 v9, v[16:17] offset:0
    v_mfma_f32_16x16x32_bf16 v[52:55], v[116:119], v[156:159], v[52:55]
    v_pk_mul_f32 v[20:21], v[20:21], s[34:35]
    v_pk_mul_f32 v[22:23], v[22:23], s[34:35]
    v_cvt_pk_bf16_f32 v20, v20, v21
    v_cvt_pk_bf16_f32 v21, v22, v23
    ds_write_b64 v9, v[20:21] offset:32
    v_mfma_f32_16x16x32_bf16 v[56:59], v[120:123], v[156:159], v[56:59]
    v_pk_mul_f32 v[24:25], v[24:25], s[34:35]
    v_pk_mul_f32 v[26:27], v[26:27], s[34:35]
    v_cvt_pk_bf16_f32 v24, v24, v25
    v_cvt_pk_bf16_f32 v25, v26, v27
    ds_write_b64 v9, v[24:25] offset:64
    v_mfma_f32_16x16x32_bf16 v[60:63], v[124:127], v[156:159], v[60:63]
    v_pk_mul_f32 v[28:29], v[28:29], s[34:35]
    v_pk_mul_f32 v[30:31], v[30:31], s[34:35]
    v_cvt_pk_bf16_f32 v28, v28, v29
    v_cvt_pk_bf16_f32 v29, v30, v31
    ds_write_b64 v9, v[28:29] offset:96
    v_mfma_f32_16x16x32_bf16 v[64:67], v[112:115], v[160:163], v[64:67]
    v_pk_mul_f32 v[32:33], v[32:33], s[34:35]
    v_pk_mul_f32 v[34:35], v[34:35], s[34:35]
    v_cvt_pk_bf16_f32 v32, v32, v33
    v_cvt_pk_bf16_f32 v33, v34, v35
    ds_write_b64 v9, v[32:33] offset:4352
    v_mfma_f32_16x16x32_bf16 v[68:71], v[116:119], v[160:163], v[68:71]
    v_pk_mul_f32 v[36:37], v[36:37], s[34:35]
    v_pk_mul_f32 v[38:39], v[38:39], s[34:35]
    v_cvt_pk_bf16_f32 v36, v36, v37
    v_cvt_pk_bf16_f32 v37, v38, v39
    ds_write_b64 v9, v[36:37] offset:4384
    v_mfma_f32_16x16x32_bf16 v[72:75], v[120:123], v[160:163], v[72:75]
    v_pk_mul_f32 v[40:41], v[40:41], s[34:35]
    v_pk_mul_f32 v[42:43], v[42:43], s[34:35]
    v_cvt_pk_bf16_f32 v40, v40, v41
    v_cvt_pk_bf16_f32 v41, v42, v43
    ds_write_b64 v9, v[40:41] offset:4416
    v_mfma_f32_16x16x32_bf16 v[76:79], v[124:127], v[160:163], v[76:79]
    v_pk_mul_f32 v[44:45], v[44:45], s[34:35]
    v_pk_mul_f32 v[46:47], v[46:47], s[34:35]
    v_cvt_pk_bf16_f32 v44, v44, v45
    v_cvt_pk_bf16_f32 v45, v46, v47
    ds_write_b64 v9, v[44:45] offset:4448
    v_mfma_f32_16x16x32_bf16 v[80:83], v[112:115], v[164:167], v[80:83]
    v_pk_mul_f32 v[48:49], v[48:49], s[34:35]
    v_pk_mul_f32 v[50:51], v[50:51], s[34:35]
    v_cvt_pk_bf16_f32 v48, v48, v49
    v_cvt_pk_bf16_f32 v49, v50, v51
    ds_write_b64 v9, v[48:49] offset:8704
    v_mfma_f32_16x16x32_bf16 v[84:87], v[116:119], v[164:167], v[84:87]
    v_pk_mul_f32 v[52:53], v[52:53], s[34:35]
    v_pk_mul_f32 v[54:55], v[54:55], s[34:35]
    v_cvt_pk_bf16_f32 v52, v52, v53
    v_cvt_pk_bf16_f32 v53, v54, v55
    ds_write_b64 v9, v[52:53] offset:8736
    v_mfma_f32_16x16x32_bf16 v[88:91], v[120:123], v[164:167], v[88:91]
    v_pk_mul_f32 v[56:57], v[56:57], s[34:35]
    v_pk_mul_f32 v[58:59], v[58:59], s[34:35]
    v_cvt_pk_bf16_f32 v56, v56, v57
    v_cvt_pk_bf16_f32 v57, v58, v59
    ds_write_b64 v9, v[56:57] offset:8768
    v_mfma_f32_16x16x32_bf16 v[92:95], v[124:127], v[164:167], v[92:95]
    v_pk_mul_f32 v[60:61], v[60:61], s[34:35]
    v_pk_mul_f32 v[62:63], v[62:63], s[34:35]
    v_cvt_pk_bf16_f32 v60, v60, v61
    v_cvt_pk_bf16_f32 v61, v62, v63
    ds_write_b64 v9, v[60:61] offset:8800
    s_waitcnt lgkmcnt(0)
    s_nop 4
    v_pk_mul_f32 v[64:65], v[64:65], s[34:35]
    v_pk_mul_f32 v[66:67], v[66:67], s[34:35]
    v_cvt_pk_bf16_f32 v64, v64, v65
    v_cvt_pk_bf16_f32 v65, v66, v67
    ds_write_b64 v9, v[64:65] offset:13056
    v_pk_mul_f32 v[68:69], v[68:69], s[34:35]
    v_pk_mul_f32 v[70:71], v[70:71], s[34:35]
    v_cvt_pk_bf16_f32 v68, v68, v69
    v_cvt_pk_bf16_f32 v69, v70, v71
    ds_write_b64 v9, v[68:69] offset:13088
    v_pk_mul_f32 v[72:73], v[72:73], s[34:35]
    v_pk_mul_f32 v[74:75], v[74:75], s[34:35]
    v_cvt_pk_bf16_f32 v72, v72, v73
    v_cvt_pk_bf16_f32 v73, v74, v75
    ds_write_b64 v9, v[72:73] offset:13120
    v_pk_mul_f32 v[76:77], v[76:77], s[34:35]
    v_pk_mul_f32 v[78:79], v[78:79], s[34:35]
    v_cvt_pk_bf16_f32 v76, v76, v77
    v_cvt_pk_bf16_f32 v77, v78, v79
    ds_write_b64 v9, v[76:77] offset:13152
    v_pk_mul_f32 v[80:81], v[80:81], s[34:35]
    v_pk_mul_f32 v[82:83], v[82:83], s[34:35]
    v_cvt_pk_bf16_f32 v80, v80, v81
    v_cvt_pk_bf16_f32 v81, v82, v83
    ds_write_b64 v9, v[80:81] offset:17408
    v_pk_mul_f32 v[84:85], v[84:85], s[34:35]
    v_pk_mul_f32 v[86:87], v[86:87], s[34:35]
    v_cvt_pk_bf16_f32 v84, v84, v85
    v_cvt_pk_bf16_f32 v85, v86, v87
    ds_write_b64 v9, v[84:85] offset:17440
    v_pk_mul_f32 v[88:89], v[88:89], s[34:35]
    v_pk_mul_f32 v[90:91], v[90:91], s[34:35]
    v_cvt_pk_bf16_f32 v88, v88, v89
    v_cvt_pk_bf16_f32 v89, v90, v91
    ds_write_b64 v9, v[88:89] offset:17472
    v_pk_mul_f32 v[92:93], v[92:93], s[34:35]
    v_pk_mul_f32 v[94:95], v[94:95], s[34:35]
    v_cvt_pk_bf16_f32 v92, v92, v93
    v_cvt_pk_bf16_f32 v93, v94, v95
    ds_write_b64 v9, v[92:93] offset:17504
    s_waitcnt lgkmcnt(0)
    s_branch L_main
PG_b:
    v_add_u32 v6, s47, v5
    ds_read_b64_tr_b16 v[96:97], v6 offset:0
    ds_read_b64_tr_b16 v[98:99], v6 offset:256
    ds_read_b64_tr_b16 v[100:101], v6 offset:32
    ds_read_b64_tr_b16 v[102:103], v6 offset:288
    ds_read_b64_tr_b16 v[104:105], v6 offset:64
    ds_read_b64_tr_b16 v[106:107], v6 offset:320
    ds_read_b64_tr_b16 v[108:109], v6 offset:96
    ds_read_b64_tr_b16 v[110:111], v6 offset:352
    s_add_u32 s47, s47, 16896
    s_cmp_eq_u32 s47, 163584
    s_cselect_b32 s47, 79104, s47
    ds_read_b128 v[128:131], v7 offset:0
    ds_read_b128 v[132:135], v7 offset:2048
    ds_read_b128 v[136:139], v7 offset:4096
    ds_read_b128 v[140:143], v7 offset:6144
    ds_read_b128 v[148:151], v8 offset:0
    ds_read_b128 v[152:155], v8 offset:2048
    ds_read_b128 v[156:159], v8 offset:4096
    ds_read_b128 v[160:163], v8 offset:6144
    s_add_u32 m0, s46, s48
    s_add_u32 s32, s44, 8192
    buffer_load_dwordx4 v2, s[16:19], s44 offen nt lds
    s_add_u32 m0, m0, 1056
    s_add_u32 s44, s44, 262144
    buffer_load_dwordx4 v2, s[16:19], s32 offen nt lds
    s_cmp_ge_u32 s44, 5242880
    s_cselect_b32 s32, 5242880, 0
    s_sub_u32 s44, s44, s32
    s_add_u32 s46, s46, 16896
    s_cmp_eq_u32 s46, 163584
    s_cselect_b32 s46, 79104, s46
    s_add_u32 m0, s46, s48
    s_add_u32 s32, s44, 8192
    buffer_load_dwordx4 v2, s[16:19], s44 offen nt lds
    s_add_u32 m0, m0, 1056
    s_add_u32 s44, s44, 262144
    buffer_load_dwordx4 v2, s[16:19], s32 offen nt lds
    s_cmp_ge_u32 s44, 5242880
    s_cselect_b32 s32, 5242880, 0
    s_sub_u32 s44, s44, s32
    s_add_u32 s46, s46, 16896
    s_cmp_eq_u32 s46, 163584
    s_cselect_b32 s46, 79104, s46
    s_waitcnt lgkmcnt(0)
    s_waitcnt vmcnt(9)
    s_barrier
    s_mov_b32 s30, 3
PG_b_loop:
    v_mfma_f32_16x16x32_bf16 v[16:19], v[96:99], v[128:131], v[16:19]
    v_add_u32 v6, s47, v5
    ds_read_b64_tr_b16 v[112:113], v6 offset:0
    v_mfma_f32_16x16x32_bf16 v[20:23], v[100:103], v[128:131], v[20:23]
    ds_read_b64_tr_b16 v[114:115], v6 offset:256
    ds_read_b64_tr_b16 v[116:117], v6 offset:32
    ds_read_b64_tr_b16 v[118:119], v6 offset:288
    v_mfma_f32_16x16x32_bf16 v[24:27], v[104:107], v[128:131], v[24:27]
    ds_read_b64_tr_b16 v[120:121], v6 offset:64
    ds_read_b64_tr_b16 v[122:123], v6 offset:320
    v_mfma_f32_16x16x32_bf16 v[28:31], v[108:111], v[128:131], v[28:31]
    ds_read_b64_tr_b16 v[124:125], v6 offset:96
    ds_read_b64_tr_b16 v[126:127], v6 offset:352
    v_mfma_f32_16x16x32_bf16 v[32:35], v[96:99], v[132:135], v[32:35]
    s_add_u32 s47, s47, 16896
    s_cmp_eq_u32 s47, 163584
    s_cselect_b32 s47, 79104, s47
    v_mfma_f32_16x16x32_bf16 v[36:39], v[100:103], v[132:135], v[36:39]
    s_add_u32 s32, s45, s49
    s_add_u32 m0, s50, 0
    v_mfma_f32_16x16x32_bf16 v[40:43], v[104:107], v[132:135], v[40:43]
    s_nop 0
    buffer_load_dwordx4 v3, s[4:7], s32 offen lds
    v_mfma_f32_16x16x32_bf16 v[44:47], v[108:111], v[132:135], v[44:47]
    s_add_u32 m0, s50, 1024
    s_add_u32 s32, s32, 10240
    buffer_load_dwordx4 v4, s[4:7], s32 offen lds
    v_mfma_f32_16x16x32_bf16 v[48:51], v[96:99], v[136:139], v[48:51]
    s_add_u32 m0, s50, 2048
    s_add_u32 s32, s32, 10240
    v_mfma_f32_16x16x32_bf16 v[52:55], v[100:103], v[136:139], v[52:55]
    buffer_load_dwordx4 v3, s[4:7], s32 offen lds
    s_add_u32 s45, s45, 128
    v_mfma_f32_16x16x32_bf16 v[56:59], v[104:107], v[136:139], v[56:59]
    s_cmp_eq_u32 s45, 1280
    s_cselect_b32 s45, 0, s45
    v_mfma_f32_16x16x32_bf16 v[60:63], v[108:111], v[136:139], v[60:63]
    s_add_u32 m0, s46, s48
    s_add_u32 s32, s44, 8192
    buffer_load_dwordx4 v2, s[16:19], s44 offen nt lds
    v_mfma_f32_16x16x32_bf16 v[64:67], v[96:99], v[140:143], v[64:67]
    s_add_u32 m0, m0, 1056
    s_add_u32 s44, s44, 262144
    v_mfma_f32_16x16x32_bf16 v[68:71], v[100:103], v[140:143], v[68:71]
    buffer_load_dwordx4 v2, s[16:19], s32 offen nt lds
    s_cmp_ge_u32 s44, 5242880
    v_mfma_f32_16x16x32_bf16 v[72:75], v[104:107], v[140:143], v[72:75]
    s_cselect_b32 s32, 5242880, 0
    s_sub_u32 s44, s44, s32
    s_add_u32 s46, s46, 16896
    v_mfma_f32_16x16x32_bf16 v[76:79], v[108:111], v[140:143], v[76:79]
    s_cmp_eq_u32 s46, 163584
    s_cselect_b32 s46, 79104, s46
    s_waitcnt lgkmcnt(0)
    s_waitcnt vmcnt(9)
    s_barrier
    v_mfma_f32_16x16x32_bf16 v[16:19], v[112:115], v[148:151], v[16:19]
    ds_read_b128 v[128:131], v7 offset:18432
    ds_read_b128 v[132:135], v7 offset:20480
    v_mfma_f32_16x16x32_bf16 v[20:23], v[116:119], v[148:151], v[20:23]
    ds_read_b128 v[136:139], v7 offset:22528
    ds_read_b128 v[140:143], v7 offset:24576
    v_mfma_f32_16x16x32_bf16 v[24:27], v[120:123], v[148:151], v[24:27]
    v_add_u32 v6, s47, v5
    ds_read_b64_tr_b16 v[96:97], v6 offset:0
    v_mfma_f32_16x16x32_bf16 v[28:31], v[124:127], v[148:151], v[28:31]
    ds_read_b128 v[148:151], v8 offset:18432
    ds_read_b64_tr_b16 v[98:99], v6 offset:256
    v_mfma_f32_16x16x32_bf16 v[32:35], v[112:115], v[152:155], v[32:35]
    ds_read_b64_tr_b16 v[100:101], v6 offset:32
    ds_read_b64_tr_b16 v[102:103], v6 offset:288
    v_mfma_f32_16x16x32_bf16 v[36:39], v[116:119], v[152:155], v[36:39]
    ds_read_b64_tr_b16 v[104:105], v6 offset:64
    ds_read_b64_tr_b16 v[106:107], v6 offset:320
    v_mfma_f32_16x16x32_bf16 v[40:43], v[120:123], v[152:155], v[40:43]
    ds_read_b64_tr_b16 v[108:109], v6 offset:96
    ds_read_b64_tr_b16 v[110:111], v6 offset:352
    v_mfma_f32_16x16x32_bf16 v[44:47], v[124:127], v[152:155], v[44:47]
    ds_read_b128 v[152:155], v8 offset:20480
    s_add_u32 s47, s47, 16896
    v_mfma_f32_16x16x32_bf16 v[48:51], v[112:115], v[156:159], v[48:51]
    s_cmp_eq_u32 s47, 163584
    s_cselect_b32 s47, 79104, s47
    v_mfma_f32_16x16x32_bf16 v[52:55], v[116:119], v[156:159], v[52:55]
    s_add_u32 m0, s46, s48
    s_add_u32 s32, s44, 8192
    v_mfma_f32_16x16x32_bf16 v[56:59], v[120:123], v[156:159], v[56:59]
    buffer_load_dwordx4 v2, s[16:19], s44 offen nt lds
    s_add_u32 m0, m0, 1056
    v_mfma_f32_16x16x32_bf16 v[60:63], v[124:127], v[156:159], v[60:63]
    ds_read_b128 v[156:159], v8 offset:22528
    s_add_u32 s44, s44, 262144
    v_mfma_f32_16x16x32_bf16 v[64:67], v[112:115], v[160:163], v[64:67]
    buffer_load_dwordx4 v2, s[16:19], s32 offen nt lds
    s_cmp_ge_u32 s44, 5242880
    v_mfma_f32_16x16x32_bf16 v[68:71], v[116:119], v[160:163], v[68:71]
    s_cselect_b32 s32, 5242880, 0
    s_sub_u32 s44, s44, s32
    v_mfma_f32_16x16x32_bf16 v[72:75], v[120:123], v[160:163], v[72:75]
    s_add_u32 s46, s46, 16896
    s_cmp_eq_u32 s46, 163584
    v_mfma_f32_16x16x32_bf16 v[76:79], v[124:127], v[160:163], v[76:79]
    ds_read_b128 v[160:163], v8 offset:24576
    s_cselect_b32 s46, 79104, s46
    s_waitcnt lgkmcnt(0)
    s_waitcnt vmcnt(9)
    s_barrier
    v_mfma_f32_16x16x32_bf16 v[16:19], v[96:99], v[128:131], v[16:19]
    v_add_u32 v6, s47, v5
    ds_read_b64_tr_b16 v[112:113], v6 offset:0
    v_mfma_f32_16x16x32_bf16 v[20:23], v[100:103], v[128:131], v[20:23]
    ds_read_b64_tr_b16 v[114:115], v6 offset:256
    ds_read_b64_tr_b16 v[116:117], v6 offset:32
    ds_read_b64_tr_b16 v[118:119], v6 offset:288
    v_mfma_f32_16x16x32_bf16 v[24:27], v[104:107], v[128:131], v[24:27]
    ds_read_b64_tr_b16 v[120:121], v6 offset:64
    ds_read_b64_tr_b16 v[122:123], v6 offset:320
    v_mfma_f32_16x16x32_bf16 v[28:31], v[108:111], v[128:131], v[28:31]
    ds_read_b64_tr_b16 v[124:125], v6 offset:96
    ds_read_b64_tr_b16 v[126:127], v6 offset:352
    v_mfma_f32_16x16x32_bf16 v[32:35], v[96:99], v[132:135], v[32:35]
    s_add_u32 s47, s47, 16896
    s_cmp_eq_u32 s47, 163584
    s_cselect_b32 s47, 79104, s47
    v_mfma_f32_16x16x32_bf16 v[36:39], v[100:103], v[132:135], v[36:39]
    s_add_u32 s32, s45, s49
    s_add_u32 m0, s50, 18432
    v_mfma_f32_16x16x32_bf16 v[40:43], v[104:107], v[132:135], v[40:43]
    s_nop 0
    buffer_load_dwordx4 v3, s[4:7], s32 offen lds
    v_mfma_f32_16x16x32_bf16 v[44:47], v[108:111], v[132:135], v[44:47]
    s_add_u32 m0, s50, 19456
    s_add_u32 s32, s32, 10240
    buffer_load_dwordx4 v4, s[4:7], s32 offen lds
    v_mfma_f32_16x16x32_bf16 v[48:51], v[96:99], v[136:139], v[48:51]
    s_add_u32 m0, s50, 20480
    s_add_u32 s32, s32, 10240
    v_mfma_f32_16x16x32_bf16 v[52:55], v[100:103], v[136:139], v[52:55]
    buffer_load_dwordx4 v3, s[4:7], s32 offen lds
    s_add_u32 s45, s45, 128
    v_mfma_f32_16x16x32_bf16 v[56:59], v[104:107], v[136:139], v[56:59]
    s_cmp_eq_u32 s45, 1280
    s_cselect_b32 s45, 0, s45
    v_mfma_f32_16x16x32_bf16 v[60:63], v[108:111], v[136:139], v[60:63]
    s_add_u32 m0, s46, s48
    s_add_u32 s32, s44, 8192
    buffer_load_dwordx4 v2, s[16:19], s44 offen nt lds
    v_mfma_f32_16x16x32_bf16 v[64:67], v[96:99], v[140:143], v[64:67]
    s_add_u32 m0, m0, 1056
    s_add_u32 s44, s44, 262144
    v_mfma_f32_16x16x32_bf16 v[68:71], v[100:103], v[140:143], v[68:71]
    buffer_load_dwordx4 v2, s[16:19], s32 offen nt lds
    s_cmp_ge_u32 s44, 5242880
    v_mfma_f32_16x16x32_bf16 v[72:75], v[104:107], v[140:143], v[72:75]
    s_cselect_b32 s32, 5242880, 0
    s_sub_u32 s44, s44, s32
    s_add_u32 s46, s46, 16896
    v_mfma_f32_16x16x32_bf16 v[76:79], v[108:111], v[140:143], v[76:79]
    s_cmp_eq_u32 s46, 163584
    s_cselect_b32 s46, 79104, s46
    s_waitcnt lgkmcnt(0)
    s_waitcnt vmcnt(9)
    s_barrier
    v_mfma_f32_16x16x32_bf16 v[16:19], v[112:115], v[148:151], v[16:19]
    ds_read_b128 v[128:131], v7 offset:0
    ds_read_b128 v[132:135], v7 offset:2048
    v_mfma_f32_16x16x32_bf16 v[20:23], v[116:119], v[148:151], v[20:23]
    ds_read_b128 v[136:139], v7 offset:4096
    ds_read_b128 v[140:143], v7 offset:6144
    v_mfma_f32_16x16x32_bf16 v[24:27], v[120:123], v[148:151], v[24:27]
    v_add_u32 v6, s47, v5
    ds_read_b64_tr_b16 v[96:97], v6 offset:0
    v_mfma_f32_16x16x32_bf16 v[28:31], v[124:127], v[148:151], v[28:31]
    ds_read_b128 v[148:151], v8 offset:0
    ds_read_b64_tr_b16 v[98:99], v6 offset:256
    v_mfma_f32_16x16x32_bf16 v[32:35], v[112:115], v[152:155], v[32:35]
    ds_read_b64_tr_b16 v[100:101], v6 offset:32
    ds_read_b64_tr_b16 v[102:103], v6 offset:288
    v_mfma_f32_16x16x32_bf16 v[36:39], v[116:119], v[152:155], v[36:39]
    ds_read_b64_tr_b16 v[104:105], v6 offset:64
    ds_read_b64_tr_b16 v[106:107], v6 offset:320
    v_mfma_f32_16x16x32_bf16 v[40:43], v[120:123], v[152:155], v[40:43]
    ds_read_b64_tr_b16 v[108:109], v6 offset:96
    ds_read_b64_tr_b16 v[110:111], v6 offset:352
    v_mfma_f32_16x16x32_bf16 v[44:47], v[124:127], v[152:155], v[44:47]
    ds_read_b128 v[152:155], v8 offset:2048
    s_add_u32 s47, s47, 16896
    v_mfma_f32_16x16x32_bf16 v[48:51], v[112:115], v[156:159], v[48:51]
    s_cmp_eq_u32 s47, 163584
    s_cselect_b32 s47, 79104, s47
    v_mfma_f32_16x16x32_bf16 v[52:55], v[116:119], v[156:159], v[52:55]
    s_add_u32 m0, s46, s48
    s_add_u32 s32, s44, 8192
    v_mfma_f32_16x16x32_bf16 v[56:59], v[120:123], v[156:159], v[56:59]
    buffer_load_dwordx4 v2, s[16:19], s44 offen nt lds
    s_add_u32 m0, m0, 1056
    v_mfma_f32_16x16x32_bf16 v[60:63], v[124:127], v[156:159], v[60:63]
    ds_read_b128 v[156:159], v8 offset:4096
    s_add_u32 s44, s44, 262144
    v_mfma_f32_16x16x32_bf16 v[64:67], v[112:115], v[160:163], v[64:67]
    buffer_load_dwordx4 v2, s[16:19], s32 offen nt lds
    s_cmp_ge_u32 s44, 5242880
    v_mfma_f32_16x16x32_bf16 v[68:71], v[116:119], v[160:163], v[68:71]
    s_cselect_b32 s32, 5242880, 0
    s_sub_u32 s44, s44, s32
    v_mfma_f32_16x16x32_bf16 v[72:75], v[120:123], v[160:163], v[72:75]
    s_add_u32 s46, s46, 16896
    s_cmp_eq_u32 s46, 163584
    v_mfma_f32_16x16x32_bf16 v[76:79], v[124:127], v[160:163], v[76:79]
    ds_read_b128 v[160:163], v8 offset:6144
    s_cselect_b32 s46, 79104, s46
    s_waitcnt lgkmcnt(0)
    s_waitcnt vmcnt(9)
    s_sub_u32 s30, s30, 1
    s_cmp_lg_u32 s30, 0
    s_barrier
    s_cbranch_scc1 PG_b_loop
    v_mfma_f32_16x16x32_bf16 v[16:19], v[96:99], v[128:131], v[16:19]
    v_add_u32 v6, s47, v5
    ds_read_b64_tr_b16 v[112:113], v6 offset:0
    v_mfma_f32_16x16x32_bf16 v[20:23], v[100:103], v[128:131], v[20:23]
    ds_read_b64_tr_b16 v[114:115], v6 offset:256
    ds_read_b64_tr_b16 v[116:117], v6 offset:32
    ds_read_b64_tr_b16 v[118:119], v6 offset:288
    v_mfma_f32_16x16x32_bf16 v[24:27], v[104:107], v[128:131], v[24:27]
    ds_read_b64_tr_b16 v[120:121], v6 offset:64
    ds_read_b64_tr_b16 v[122:123], v6 offset:320
    v_mfma_f32_16x16x32_bf16 v[28:31], v[108:111], v[128:131], v[28:31]
    ds_read_b64_tr_b16 v[124:125], v6 offset:96
    ds_read_b64_tr_b16 v[126:127], v6 offset:352
    v_mfma_f32_16x16x32_bf16 v[32:35], v[96:99], v[132:135], v[32:35]
    s_add_u32 s47, s47, 16896
    s_cmp_eq_u32 s47, 163584
    s_cselect_b32 s47, 79104, s47
    v_mfma_f32_16x16x32_bf16 v[36:39], v[100:103], v[132:135], v[36:39]
    s_add_u32 s32, s45, s49
    s_add_u32 m0, s50, 0
    v_mfma_f32_16x16x32_bf16 v[40:43], v[104:107], v[132:135], v[40:43]
    s_nop 0
    buffer_load_dwordx4 v3, s[4:7], s32 offen lds
    v_mfma_f32_16x16x32_bf16 v[44:47], v[108:111], v[132:135], v[44:47]
    s_add_u32 m0, s50, 1024
    s_add_u32 s32, s32, 10240
    buffer_load_dwordx4 v4, s[4:7], s32 offen lds
    v_mfma_f32_16x16x32_bf16 v[48:51], v[96:99], v[136:139], v[48:51]
    s_add_u32 m0, s50, 2048
    s_add_u32 s32, s32, 10240
    v_mfma_f32_16x16x32_bf16 v[52:55], v[100:103], v[136:139], v[52:55]
    buffer_load_dwordx4 v3, s[4:7], s32 offen lds
    s_add_u32 s45, s45, 128
    v_mfma_f32_16x16x32_bf16 v[56:59], v[104:107], v[136:139], v[56:59]
    s_cmp_eq_u32 s45, 1280
    s_cselect_b32 s45, 0, s45
    v_mfma_f32_16x16x32_bf16 v[60:63], v[108:111], v[136:139], v[60:63]
    s_add_u32 m0, s46, s48
    s_add_u32 s32, s44, 8192
    buffer_load_dwordx4 v2, s[16:19], s44 offen nt lds
    v_mfma_f32_16x16x32_bf16 v[64:67], v[96:99], v[140:143], v[64:67]
    s_add_u32 m0, m0, 1056
    s_add_u32 s44, s44, 262144
    v_mfma_f32_16x16x32_bf16 v[68:71], v[100:103], v[140:143], v[68:71]
    buffer_load_dwordx4 v2, s[16:19], s32 offen nt lds
    s_cmp_ge_u32 s44, 5242880
    v_mfma_f32_16x16x32_bf16 v[72:75], v[104:107], v[140:143], v[72:75]
    s_cselect_b32 s32, 5242880, 0
    s_sub_u32 s44, s44, s32
    s_add_u32 s46, s46, 16896
    v_mfma_f32_16x16x32_bf16 v[76:79], v[108:111], v[140:143], v[76:79]
    s_cmp_eq_u32 s46, 163584
    s_cselect_b32 s46, 79104, s46
    s_waitcnt lgkmcnt(0)
    s_waitcnt vmcnt(9)
    s_barrier
    v_mfma_f32_16x16x32_bf16 v[16:19], v[112:115], v[148:151], v[16:19]
    ds_read_b128 v[128:131], v7 offset:18432
    ds_read_b128 v[132:135], v7 offset:20480
    v_mfma_f32_16x16x32_bf16 v[20:23], v[116:119], v[148:151], v[20:23]
    ds_read_b128 v[136:139], v7 offset:22528
    ds_read_b128 v[140:143], v7 offset:24576
    v_mfma_f32_16x16x32_bf16 v[24:27], v[120:123], v[148:151], v[24:27]
    v_add_u32 v6, s47, v5
    ds_read_b64_tr_b16 v[96:97], v6 offset:0
    v_mfma_f32_16x16x32_bf16 v[28:31], v[124:127], v[148:151], v[28:31]
    ds_read_b128 v[148:151], v8 offset:18432
    ds_read_b64_tr_b16 v[98:99], v6 offset:256
    v_mfma_f32_16x16x32_bf16 v[32:35], v[112:115], v[152:155], v[32:35]
    ds_read_b64_tr_b16 v[100:101], v6 offset:32
    ds_read_b64_tr_b16 v[102:103], v6 offset:288
    v_mfma_f32_16x16x32_bf16 v[36:39], v[116:119], v[152:155], v[36:39]
    ds_read_b64_tr_b16 v[104:105], v6 offset:64
    ds_read_b64_tr_b16 v[106:107], v6 offset:320
    v_mfma_f32_16x16x32_bf16 v[40:43], v[120:123], v[152:155], v[40:43]
    ds_read_b64_tr_b16 v[108:109], v6 offset:96
    ds_read_b64_tr_b16 v[110:111], v6 offset:352
    v_mfma_f32_16x16x32_bf16 v[44:47], v[124:127], v[152:155], v[44:47]
    ds_read_b128 v[152:155], v8 offset:20480
    s_add_u32 s47, s47, 16896
    v_mfma_f32_16x16x32_bf16 v[48:51], v[112:115], v[156:159], v[48:51]
    s_cmp_eq_u32 s47, 163584
    s_cselect_b32 s47, 79104, s47
    v_mfma_f32_16x16x32_bf16 v[52:55], v[116:119], v[156:159], v[52:55]
    s_add_u32 m0, s46, s48
    s_add_u32 s32, s44, 8192
    v_mfma_f32_16x16x32_bf16 v[56:59], v[120:123], v[156:159], v[56:59]
    buffer_load_dwordx4 v2, s[16:19], s44 offen nt lds
    s_add_u32 m0, m0, 1056
    v_mfma_f32_16x16x32_bf16 v[60:63], v[124:127], v[156:159], v[60:63]
    ds_read_b128 v[156:159], v8 offset:22528
    s_add_u32 s44, s44, 262144
    v_mfma_f32_16x16x32_bf16 v[64:67], v[112:115], v[160:163], v[64:67]
    buffer_load_dwordx4 v2, s[16:19], s32 offen nt lds
    s_cmp_ge_u32 s44, 5242880
    v_mfma_f32_16x16x32_bf16 v[68:71], v[116:119], v[160:163], v[68:71]
    s_cselect_b32 s32, 5242880, 0
    s_sub_u32 s44, s44, s32
    v_mfma_f32_16x16x32_bf16 v[72:75], v[120:123], v[160:163], v[72:75]
    s_add_u32 s46, s46, 16896
    s_cmp_eq_u32 s46, 163584
    v_mfma_f32_16x16x32_bf16 v[76:79], v[124:127], v[160:163], v[76:79]
    ds_read_b128 v[160:163], v8 offset:24576
    s_cselect_b32 s46, 79104, s46
    s_waitcnt lgkmcnt(0)
    s_waitcnt vmcnt(9)
    s_barrier
    v_mfma_f32_16x16x32_bf16 v[16:19], v[96:99], v[128:131], v[16:19]
    v_add_u32 v6, s47, v5
    ds_read_b64_tr_b16 v[112:113], v6 offset:0
    v_mfma_f32_16x16x32_bf16 v[20:23], v[100:103], v[128:131], v[20:23]
    ds_read_b64_tr_b16 v[114:115], v6 offset:256
    ds_read_b64_tr_b16 v[116:117], v6 offset:32
    ds_read_b64_tr_b16 v[118:119], v6 offset:288
    v_mfma_f32_16x16x32_bf16 v[24:27], v[104:107], v[128:131], v[24:27]
    ds_read_b64_tr_b16 v[120:121], v6 offset:64
    ds_read_b64_tr_b16 v[122:123], v6 offset:320
    v_mfma_f32_16x16x32_bf16 v[28:31], v[108:111], v[128:131], v[28:31]
    ds_read_b64_tr_b16 v[124:125], v6 offset:96
    ds_read_b64_tr_b16 v[126:127], v6 offset:352
    v_mfma_f32_16x16x32_bf16 v[32:35], v[96:99], v[132:135], v[32:35]
    s_add_u32 s47, s47, 16896
    s_cmp_eq_u32 s47, 163584
    s_cselect_b32 s47, 79104, s47
    v_mfma_f32_16x16x32_bf16 v[36:39], v[100:103], v[132:135], v[36:39]
    s_add_u32 s32, s45, s49
    s_add_u32 m0, s50, 18432
    v_mfma_f32_16x16x32_bf16 v[40:43], v[104:107], v[132:135], v[40:43]
    s_nop 0
    buffer_load_dwordx4 v3, s[4:7], s32 offen lds
    v_mfma_f32_16x16x32_bf16 v[44:47], v[108:111], v[132:135], v[44:47]
    s_add_u32 m0, s50, 19456
    s_add_u32 s32, s32, 10240
    buffer_load_dwordx4 v4, s[4:7], s32 offen lds
    v_mfma_f32_16x16x32_bf16 v[48:51], v[96:99], v[136:139], v[48:51]
    s_add_u32 m0, s50, 20480
    s_add_u32 s32, s32, 10240
    v_mfma_f32_16x16x32_bf16 v[52:55], v[100:103], v[136:139], v[52:55]
    buffer_load_dwordx4 v3, s[4:7], s32 offen lds
    s_add_u32 s45, s45, 128
    v_mfma_f32_16x16x32_bf16 v[56:59], v[104:107], v[136:139], v[56:59]
    s_cmp_eq_u32 s45, 1280
    s_cselect_b32 s45, 0, s45
    v_mfma_f32_16x16x32_bf16 v[60:63], v[108:111], v[136:139], v[60:63]
    s_add_u32 m0, s46, s48
    s_add_u32 s32, s44, 8192
    buffer_load_dwordx4 v2, s[16:19], s44 offen nt lds
    v_mfma_f32_16x16x32_bf16 v[64:67], v[96:99], v[140:143], v[64:67]
    s_add_u32 m0, m0, 1056
    s_add_u32 s44, s44, 262144
    v_mfma_f32_16x16x32_bf16 v[68:71], v[100:103], v[140:143], v[68:71]
    buffer_load_dwordx4 v2, s[16:19], s32 offen nt lds
    s_cmp_ge_u32 s44, 5242880
    v_mfma_f32_16x16x32_bf16 v[72:75], v[104:107], v[140:143], v[72:75]
    s_cselect_b32 s32, 5242880, 0
    s_sub_u32 s44, s44, s32
    s_add_u32 s46, s46, 16896
    v_mfma_f32_16x16x32_bf16 v[76:79], v[108:111], v[140:143], v[76:79]
    s_cmp_eq_u32 s46, 163584
    s_cselect_b32 s46, 79104, s46
    s_waitcnt lgkmcnt(0)
    s_waitcnt vmcnt(9)
    s_barrier
    v_mfma_f32_16x16x32_bf16 v[16:19], v[112:115], v[148:151], v[16:19]
    ds_read_b128 v[128:131], v7 offset:0
    v_mfma_f32_16x16x32_bf16 v[20:23], v[116:119], v[148:151], v[20:23]
    ds_read_b128 v[132:135], v7 offset:2048
    ds_read_b128 v[136:139], v7 offset:4096
    v_mfma_f32_16x16x32_bf16 v[24:27], v[120:123], v[148:151], v[24:27]
    ds_read_b128 v[140:143], v7 offset:6144
    v_mfma_f32_16x16x32_bf16 v[28:31], v[124:127], v[148:151], v[28:31]
    ds_read_b128 v[148:151], v8 offset:0
    v_mfma_f32_16x16x32_bf16 v[32:35], v[112:115], v[152:155], v[32:35]
    v_add_u32 v6, s47, v5
    v_mfma_f32_16x16x32_bf16 v[36:39], v[116:119], v[152:155], v[36:39]
    ds_read_b64_tr_b16 v[96:97], v6 offset:0
    ds_read_b64_tr_b16 v[98:99], v6 offset:256
    v_mfma_f32_16x16x32_bf16 v[40:43], v[120:123], v[152:155], v[40:43]
    ds_read_b64_tr_b16 v[100:101], v6 offset:32
    v_mfma_f32_16x16x32_bf16 v[44:47], v[124:127], v[152:155], v[44:47]
    ds_read_b128 v[152:155], v8 offset:2048
    v_mfma_f32_16x16x32_bf16 v[48:51], v[112:115], v[156:159], v[48:51]
    ds_read_b64_tr_b16 v[102:103], v6 offset:288
    v_mfma_f32_16x16x32_bf16 v[52:55], v[116:119], v[156:159], v[52:55]
    ds_read_b64_tr_b16 v[104:105], v6 offset:64
    ds_read_b64_tr_b16 v[106:107], v6 offset:320
    v_mfma_f32_16x16x32_bf16 v[56:59], v[120:123], v[156:159], v[56:59]
    ds_read_b64_tr_b16 v[108:109], v6 offset:96
    v_mfma_f32_16x16x32_bf16 v[60:63], v[124:127], v[156:159], v[60:63]
    ds_read_b128 v[156:159], v8 offset:4096
    v_mfma_f32_16x16x32_bf16 v[64:67], v[112:115], v[160:163], v[64:67]
    ds_read_b64_tr_b16 v[110:111], v6 offset:352
    v_mfma_f32_16x16x32_bf16 v[68:71], v[116:119], v[160:163], v[68:71]
    s_add_u32 s47, s47, 16896
    s_cmp_eq_u32 s47, 163584
    v_mfma_f32_16x16x32_bf16 v[72:75], v[120:123], v[160:163], v[72:75]
    s_cselect_b32 s47, 79104, s47
    v_mfma_f32_16x16x32_bf16 v[76:79], v[124:127], v[160:163], v[76:79]
    ds_read_b128 v[160:163], v8 offset:6144
    s_waitcnt lgkmcnt(0)
    s_waitcnt vmcnt(7)
    s_barrier
    v_mfma_f32_16x16x32_bf16 v[16:19], v[96:99], v[128:131], v[16:19]
    v_add_u32 v6, s47, v5
    v_mfma_f32_16x16x32_bf16 v[20:23], v[100:103], v[128:131], v[20:23]
    ds_read_b64_tr_b16 v[112:113], v6 offset:0
    v_mfma_f32_16x16x32_bf16 v[24:27], v[104:107], v[128:131], v[24:27]
    v_mfma_f32_16x16x32_bf16 v[28:31], v[108:111], v[128:131], v[28:31]
    ds_read_b64_tr_b16 v[114:115], v6 offset:256
    v_mfma_f32_16x16x32_bf16 v[32:35], v[96:99], v[132:135], v[32:35]
    ds_read_b64_tr_b16 v[116:117], v6 offset:32
    v_mfma_f32_16x16x32_bf16 v[36:39], v[100:103], v[132:135], v[36:39]
    ds_read_b64_tr_b16 v[118:119], v6 offset:288
    v_mfma_f32_16x16x32_bf16 v[40:43], v[104:107], v[132:135], v[40:43]
    v_mfma_f32_16x16x32_bf16 v[44:47], v[108:111], v[132:135], v[44:47]
    ds_read_b64_tr_b16 v[120:121], v6 offset:64
    v_mfma_f32_16x16x32_bf16 v[48:51], v[96:99], v[136:139], v[48:51]
    ds_read_b64_tr_b16 v[122:123], v6 offset:320
    v_mfma_f32_16x16x32_bf16 v[52:55], v[100:103], v[136:139], v[52:55]
    ds_read_b64_tr_b16 v[124:125], v6 offset:96
    v_mfma_f32_16x16x32_bf16 v[56:59], v[104:107], v[136:139], v[56:59]
    v_mfma_f32_16x16x32_bf16 v[60:63], v[108:111], v[136:139], v[60:63]
    ds_read_b64_tr_b16 v[126:127], v6 offset:352
    v_mfma_f32_16x16x32_bf16 v[64:67], v[96:99], v[140:143], v[64:67]
    s_add_u32 s47, s47, 16896
    v_mfma_f32_16x16x32_bf16 v[68:71], v[100:103], v[140:143], v[68:71]
    s_cmp_eq_u32 s47, 163584
    v_mfma_f32_16x16x32_bf16 v[72:75], v[104:107], v[140:143], v[72:75]
    v_mfma_f32_16x16x32_bf16 v[76:79], v[108:111], v[140:143], v[76:79]
    s_cselect_b32 s47, 79104, s47
    s_waitcnt lgkmcnt(0)
    s_waitcnt vmcnt(2)
    s_barrier
    v_mfma_f32_16x16x32_bf16 v[16:19], v[112:115], v[148:151], v[16:19]
    ds_read_b128 v[128:131], v7 offset:18432
    v_mfma_f32_16x16x32_bf16 v[20:23], v[116:119], v[148:151], v[20:23]
    ds_read_b128 v[132:135], v7 offset:20480
    ds_read_b128 v[136:139], v7 offset:22528
    v_mfma_f32_16x16x32_bf16 v[24:27], v[120:123], v[148:151], v[24:27]
    ds_read_b128 v[140:143], v7 offset:24576
    v_mfma_f32_16x16x32_bf16 v[28:31], v[124:127], v[148:151], v[28:31]
    ds_read_b128 v[148:151], v8 offset:18432
    v_mfma_f32_16x16x32_bf16 v[32:35], v[112:115], v[152:155], v[32:35]
    v_add_u32 v6, s47, v5
    v_mfma_f32_16x16x32_bf16 v[36:39], v[116:119], v[152:155], v[36:39]
    ds_read_b64_tr_b16 v[96:97], v6 offset:0
    ds_read_b64_tr_b16 v[98:99], v6 offset:256
    v_mfma_f32_16x16x32_bf16 v[40:43], v[120:123], v[152:155], v[40:43]
    ds_read_b64_tr_b16 v[100:101], v6 offset:32
    v_mfma_f32_16x16x32_bf16 v[44:47], v[124:127], v[152:155], v[44:47]
    ds_read_b128 v[152:155], v8 offset:20480
    v_mfma_f32_16x16x32_bf16 v[48:51], v[112:115], v[156:159], v[48:51]
    ds_read_b64_tr_b16 v[102:103], v6 offset:288
    v_mfma_f32_16x16x32_bf16 v[52:55], v[116:119], v[156:159], v[52:55]
    ds_read_b64_tr_b16 v[104:105], v6 offset:64
    ds_read_b64_tr_b16 v[106:107], v6 offset:320
    v_mfma_f32_16x16x32_bf16 v[56:59], v[120:123], v[156:159], v[56:59]
    ds_read_b64_tr_b16 v[108:109], v6 offset:96
    v_mfma_f32_16x16x32_bf16 v[60:63], v[124:127], v[156:159], v[60:63]
    ds_read_b128 v[156:159], v8 offset:22528
    v_mfma_f32_16x16x32_bf16 v[64:67], v[112:115], v[160:163], v[64:67]
    ds_read_b64_tr_b16 v[110:111], v6 offset:352
    v_mfma_f32_16x16x32_bf16 v[68:71], v[116:119], v[160:163], v[68:71]
    s_add_u32 s47, s47, 16896
    s_cmp_eq_u32 s47, 163584
    v_mfma_f32_16x16x32_bf16 v[72:75], v[120:123], v[160:163], v[72:75]
    s_cselect_b32 s47, 79104, s47
    v_mfma_f32_16x16x32_bf16 v[76:79], v[124:127], v[160:163], v[76:79]
    ds_read_b128 v[160:163], v8 offset:24576
    s_waitcnt lgkmcnt(0)
    s_waitcnt vmcnt(0)
    s_add_u32 s32, s37, s38
    s_and_b32 s32, s32, 0x3ffff
    s_and_b32 s33, s37, 0xfffc0000
    s_mov_b32 m0, s39
    s_or_b32 s32, s32, s33
    buffer_load_dwordx4 v15, s[8:11], s32 offen nt lds
    s_add_u32 m0, m0, s42
    s_add_u32 s32, s32, s43
    buffer_load_dwordx4 v15, s[8:11], s32 offen nt lds
    s_add_u32 m0, m0, s42
    s_add_u32 s32, s32, s43
    buffer_load_dwordx4 v15, s[8:11], s32 offen nt lds
    s_add_u32 m0, m0, s42
    s_add_u32 s32, s32, s43
    buffer_load_dwordx4 v15, s[8:11], s32 offen nt lds
    s_add_u32 s37, s37, 8192
    s_add_u32 s39, s39, 8448
    s_cmp_eq_u32 s39, s41
    s_cselect_b32 s39, s40, s39
    s_barrier
    v_mfma_f32_16x16x32_bf16 v[16:19], v[96:99], v[128:131], v[16:19]
    v_add_u32 v6, s47, v5
    v_mfma_f32_16x16x32_bf16 v[20:23], v[100:103], v[128:131], v[20:23]
    ds_read_b64_tr_b16 v[112:113], v6 offset:0
    v_mfma_f32_16x16x32_bf16 v[24:27], v[104:107], v[128:131], v[24:27]
    v_mfma_f32_16x16x32_bf16 v[28:31], v[108:111], v[128:131], v[28:31]
    ds_read_b64_tr_b16 v[114:115], v6 offset:256
    v_mfma_f32_16x16x32_bf16 v[32:35], v[96:99], v[132:135], v[32:35]
    ds_read_b64_tr_b16 v[116:117], v6 offset:32
    v_mfma_f32_16x16x32_bf16 v[36:39], v[100:103], v[132:135], v[36:39]
    ds_read_b64_tr_b16 v[118:119], v6 offset:288
    v_mfma_f32_16x16x32_bf16 v[40:43], v[104:107], v[132:135], v[40:43]
    v_mfma_f32_16x16x32_bf16 v[44:47], v[108:111], v[132:135], v[44:47]
    ds_read_b64_tr_b16 v[120:121], v6 offset:64
    v_mfma_f32_16x16x32_bf16 v[48:51], v[96:99], v[136:139], v[48:51]
    ds_read_b64_tr_b16 v[122:123], v6 offset:320
    v_mfma_f32_16x16x32_bf16 v[52:55], v[100:103], v[136:139], v[52:55]
    ds_read_b64_tr_b16 v[124:125], v6 offset:96
    v_mfma_f32_16x16x32_bf16 v[56:59], v[104:107], v[136:139], v[56:59]
    v_mfma_f32_16x16x32_bf16 v[60:63], v[108:111], v[136:139], v[60:63]
    ds_read_b64_tr_b16 v[126:127], v6 offset:352
    v_mfma_f32_16x16x32_bf16 v[64:67], v[96:99], v[140:143], v[64:67]
    s_add_u32 s47, s47, 16896
    v_mfma_f32_16x16x32_bf16 v[68:71], v[100:103], v[140:143], v[68:71]
    s_cmp_eq_u32 s47, 163584
    v_mfma_f32_16x16x32_bf16 v[72:75], v[104:107], v[140:143], v[72:75]
    v_mfma_f32_16x16x32_bf16 v[76:79], v[108:111], v[140:143], v[76:79]
    s_cselect_b32 s47, 79104, s47
    s_waitcnt lgkmcnt(0)
    s_add_u32 s32, s37, s38
    s_and_b32 s32, s32, 0x3ffff
    s_and_b32 s33, s37, 0xfffc0000
    s_mov_b32 m0, s39
    s_or_b32 s32, s32, s33
    buffer_load_dwordx4 v15, s[8:11], s32 offen nt lds
    s_add_u32 m0, m0, s42
    s_add_u32 s32, s32, s43
    buffer_load_dwordx4 v15, s[8:11], s32 offen nt lds
    s_add_u32 m0, m0, s42
    s_add_u32 s32, s32, s43
    buffer_load_dwordx4 v15, s[8:11], s32 offen nt lds
    s_add_u32 m0, m0, s42
    s_add_u32 s32, s32, s43
    buffer_load_dwordx4 v15, s[8:11], s32 offen nt lds
    s_add_u32 s37, s37, 8192
    s_add_u32 s39, s39, 8448
    s_cmp_eq_u32 s39, s41
    s_cselect_b32 s39, s40, s39
    s_barrier
    v_mfma_f32_16x16x32_bf16 v[16:19], v[112:115], v[148:151], v[16:19]
    s_mov_b32 s34, 0x3e0293ee
    s_mov_b32 s35, 0x3e0293ee
    v_mfma_f32_16x16x32_bf16 v[20:23], v[116:119], v[148:151], v[20:23]
    v_mfma_f32_16x16x32_bf16 v[24:27], v[120:123], v[148:151], v[24:27]
    v_mfma_f32_16x16x32_bf16 v[28:31], v[124:127], v[148:151], v[28:31]
    v_mfma_f32_16x16x32_bf16 v[32:35], v[112:115], v[152:155], v[32:35]
    v_mfma_f32_16x16x32_bf16 v[36:39], v[116:119], v[152:155], v[36:39]
    v_mfma_f32_16x16x32_bf16 v[40:43], v[120:123], v[152:155], v[40:43]
    v_mfma_f32_16x16x32_bf16 v[44:47], v[124:127], v[152:155], v[44:47]
    v_mfma_f32_16x16x32_bf16 v[48:51], v[112:115], v[156:159], v[48:51]
    v_pk_mul_f32 v[16:17], v[16:17], s[34:35]
    v_pk_mul_f32 v[18:19], v[18:19], s[34:35]
    v_cvt_pk_bf16_f32 v16, v16, v17
    v_cvt_pk_bf16_f32 v17, v18, v19
    ds_write_b64 v9, v[16:17] offset:0
    v_mfma_f32_16x16x32_bf16 v[52:55], v[116:119], v[156:159], v[52:55]
    v_pk_mul_f32 v[20:21], v[20:21], s[34:35]
    v_pk_mul_f32 v[22:23], v[22:23], s[34:35]
    v_cvt_pk_bf16_f32 v20, v20, v21
    v_cvt_pk_bf16_f32 v21, v22, v23
    ds_write_b64 v9, v[20:21] offset:32
    v_mfma_f32_16x16x32_bf16 v[56:59], v[120:123], v[156:159], v[56:59]
    v_pk_mul_f32 v[24:25], v[24:25], s[34:35]
    v_pk_mul_f32 v[26:27], v[26:27], s[34:35]
    v_cvt_pk_bf16_f32 v24, v24, v25
    v_cvt_pk_bf16_f32 v25, v26, v27
    ds_write_b64 v9, v[24:25] offset:64
    v_mfma_f32_16x16x32_bf16 v[60:63], v[124:127], v[156:159], v[60:63]
    v_pk_mul_f32 v[28:29], v[28:29], s[34:35]
    v_pk_mul_f32 v[30:31], v[30:31], s[34:35]
    v_cvt_pk_bf16_f32 v28, v28, v29
    v_cvt_pk_bf16_f32 v29, v30, v31
    ds_write_b64 v9, v[28:29] offset:96
    v_mfma_f32_16x16x32_bf16 v[64:67], v[112:115], v[160:163], v[64:67]
    v_pk_mul_f32 v[32:33], v[32:33], s[34:35]
    v_pk_mul_f32 v[34:35], v[34:35], s[34:35]
    v_cvt_pk_bf16_f32 v32, v32, v33
    v_cvt_pk_bf16_f32 v33, v34, v35
    ds_write_b64 v9, v[32:33] offset:4352
    v_mfma_f32_16x16x32_bf16 v[68:71], v[116:119], v[160:163], v[68:71]
    v_pk_mul_f32 v[36:37], v[36:37], s[34:35]
    v_pk_mul_f32 v[38:39], v[38:39], s[34:35]
    v_cvt_pk_bf16_f32 v36, v36, v37
    v_cvt_pk_bf16_f32 v37, v38, v39
    ds_write_b64 v9, v[36:37] offset:4384
    v_mfma_f32_16x16x32_bf16 v[72:75], v[120:123], v[160:163], v[72:75]
    v_pk_mul_f32 v[40:41], v[40:41], s[34:35]
    v_pk_mul_f32 v[42:43], v[42:43], s[34:35]
    v_cvt_pk_bf16_f32 v40, v40, v41
    v_cvt_pk_bf16_f32 v41, v42, v43
    ds_write_b64 v9, v[40:41] offset:4416
    v_mfma_f32_16x16x32_bf16 v[76:79], v[124:127], v[160:163], v[76:79]
    v_pk_mul_f32 v[44:45], v[44:45], s[34:35]
    v_pk_mul_f32 v[46:47], v[46:47], s[34:35]
    v_cvt_pk_bf16_f32 v44, v44, v45
    v_cvt_pk_bf16_f32 v45, v46, v47
    ds_write_b64 v9, v[44:45] offset:4448
    s_waitcnt lgkmcnt(0)
    s_add_u32 s32, s37, s38
    s_and_b32 s32, s32, 0x3ffff
    s_and_b32 s33, s37, 0xfffc0000
    s_mov_b32 m0, s39
    s_or_b32 s32, s32, s33
    buffer_load_dwordx4 v15, s[8:11], s32 offen nt lds
    s_add_u32 m0, m0, s42
    s_add_u32 s32, s32, s43
    buffer_load_dwordx4 v15, s[8:11], s32 offen nt lds
    s_add_u32 m0, m0, s42
    s_add_u32 s32, s32, s43
    buffer_load_dwordx4 v15, s[8:11], s32 offen nt lds
    s_add_u32 m0, m0, s42
    s_add_u32 s32, s32, s43
    buffer_load_dwordx4 v15, s[8:11], s32 offen nt lds
    s_add_u32 s37, s37, 8192
    s_add_u32 s39, s39, 8448
    s_cmp_eq_u32 s39, s41
    s_cselect_b32 s39, s40, s39
    s_add_u32 s32, s37, s38
    s_and_b32 s32, s32, 0x3ffff
    s_and_b32 s33, s37, 0xfffc0000
    s_mov_b32 m0, s39
    s_or_b32 s32, s32, s33
    buffer_load_dwordx4 v15, s[8:11], s32 offen nt lds
    s_add_u32 m0, m0, s42
    s_add_u32 s32, s32, s43
    buffer_load_dwordx4 v15, s[8:11], s32 offen nt lds
    s_add_u32 m0, m0, s42
    s_add_u32 s32, s32, s43
    buffer_load_dwordx4 v15, s[8:11], s32 offen nt lds
    s_add_u32 m0, m0, s42
    s_add_u32 s32, s32, s43
    buffer_load_dwordx4 v15, s[8:11], s32 offen nt lds
    s_add_u32 s37, s37, 8192
    s_add_u32 s39, s39, 8448
    s_cmp_eq_u32 s39, s41
    s_cselect_b32 s39, s40, s39
    s_nop 4
    v_pk_mul_f32 v[48:49], v[48:49], s[34:35]
    v_pk_mul_f32 v[50:51], v[50:51], s[34:35]
    v_cvt_pk_bf16_f32 v48, v48, v49
    v_cvt_pk_bf16_f32 v49, v50, v51
    ds_write_b64 v9, v[48:49] offset:8704
    v_pk_mul_f32 v[52:53], v[52:53], s[34:35]
    v_pk_mul_f32 v[54:55], v[54:55], s[34:35]
    v_cvt_pk_bf16_f32 v52, v52, v53
    v_cvt_pk_bf16_f32 v53, v54, v55
    ds_write_b64 v9, v[52:53] offset:8736
    v_pk_mul_f32 v[56:57], v[56:57], s[34:35]
    v_pk_mul_f32 v[58:59], v[58:59], s[34:35]
    v_cvt_pk_bf16_f32 v56, v56, v57
    v_cvt_pk_bf16_f32 v57, v58, v59
    ds_write_b64 v9, v[56:57] offset:8768
    v_pk_mul_f32 v[60:61], v[60:61], s[34:35]
    v_pk_mul_f32 v[62:63], v[62:63], s[34:35]
    v_cvt_pk_bf16_f32 v60, v60, v61
    v_cvt_pk_bf16_f32 v61, v62, v63
    ds_write_b64 v9, v[60:61] offset:8800
    v_pk_mul_f32 v[64:65], v[64:65], s[34:35]
    v_pk_mul_f32 v[66:67], v[66:67], s[34:35]
    v_cvt_pk_bf16_f32 v64, v64, v65
    v_cvt_pk_bf16_f32 v65, v66, v67
    ds_write_b64 v9, v[64:65] offset:13056
    v_pk_mul_f32 v[68:69], v[68:69], s[34:35]
    v_pk_mul_f32 v[70:71], v[70:71], s[34:35]
    v_cvt_pk_bf16_f32 v68, v68, v69
    v_cvt_pk_bf16_f32 v69, v70, v71
    ds_write_b64 v9, v[68:69] offset:13088
    v_pk_mul_f32 v[72:73], v[72:73], s[34:35]
    v_pk_mul_f32 v[74:75], v[74:75], s[34:35]
    v_cvt_pk_bf16_f32 v72, v72, v73
    v_cvt_pk_bf16_f32 v73, v74, v75
    ds_write_b64 v9, v[72:73] offset:13120
    v_pk_mul_f32 v[76:77], v[76:77], s[34:35]
    v_pk_mul_f32 v[78:79], v[78:79], s[34:35]
    v_cvt_pk_bf16_f32 v76, v76, v77
    v_cvt_pk_bf16_f32 v77, v78, v79
    ds_write_b64 v9, v[76:77] offset:13152
    s_waitcnt lgkmcnt(0)
    s_setprio 0
    s_branch L_help
PG_c:
    v_add_u32 v6, s47, v5
    ds_read_b64_tr_b16 v[96:97], v6 offset:0
    ds_read_b64_tr_b16 v[98:99], v6 offset:256
    ds_read_b64_tr_b16 v[100:101], v6 offset:32
    ds_read_b64_tr_b16 v[102:103], v6 offset:288
    ds_read_b64_tr_b16 v[104:105], v6 offset:64
    ds_read_b64_tr_b16 v[106:107], v6 offset:320
    ds_read_b64_tr_b16 v[108:109], v6 offset:96
    ds_read_b64_tr_b16 v[110:111], v6 offset:352
    s_add_u32 s47, s47, 16896
    s_cmp_eq_u32 s47, 163584
    s_cselect_b32 s47, 79104, s47
    ds_read_b128 v[128:131], v7 offset:0
    ds_read_b128 v[132:135], v7 offset:2048
    ds_read_b128 v[136:139], v7 offset:4096
    ds_read_b128 v[140:143], v7 offset:6144
    ds_read_b128 v[148:151], v8 offset:0
    ds_read_b128 v[152:155], v8 offset:2048
    ds_read_b128 v[156:159], v8 offset:4096
    ds_read_b128 v[160:163], v8 offset:6144
    s_add_u32 m0, s46, s48
    s_add_u32 s32, s44, 8192
    buffer_load_dwordx4 v2, s[16:19], s44 offen nt lds
    s_add_u32 m0, m0, 1056
    s_add_u32 s44, s44, 262144
    buffer_load_dwordx4 v2, s[16:19], s32 offen nt lds
    s_cmp_ge_u32 s44, 5242880
    s_cselect_b32 s32, 5242880, 0
    s_sub_u32 s44, s44, s32
    s_add_u32 s46, s46, 16896
    s_cmp_eq_u32 s46, 163584
    s_cselect_b32 s46, 79104, s46
    s_add_u32 m0, s46, s48
    s_add_u32 s32, s44, 8192
    buffer_load_dwordx4 v2, s[16:19], s44 offen nt lds
    s_add_u32 m0, m0, 1056
    s_add_u32 s44, s44, 262144
    buffer_load_dwordx4 v2, s[16:19], s32 offen nt lds
    s_cmp_ge_u32 s44, 5242880
    s_cselect_b32 s32, 5242880, 0
    s_sub_u32 s44, s44, s32
    s_add_u32 s46, s46, 16896
    s_cmp_eq_u32 s46, 163584
    s_cselect_b32 s46, 79104, s46
    s_waitcnt lgkmcnt(0)
    s_waitcnt vmcnt(6)
    s_barrier
    s_mov_b32 s30, 3
PG_c_loop:
    v_mfma_f32_16x16x32_bf16 v[16:19], v[96:99], v[128:131], v[16:19]
    v_add_u32 v6, s47, v5
    ds_read_b64_tr_b16 v[112:113], v6 offset:0
    v_mfma_f32_16x16x32_bf16 v[20:23], v[100:103], v[128:131], v[20:23]
    ds_read_b64_tr_b16 v[114:115], v6 offset:256
    v_mfma_f32_16x16x32_bf16 v[24:27], v[104:107], v[128:131], v[24:27]
    ds_read_b64_tr_b16 v[116:117], v6 offset:32
    ds_read_b64_tr_b16 v[118:119], v6 offset:288
    v_mfma_f32_16x16x32_bf16 v[28:31], v[108:111], v[128:131], v[28:31]
    ds_read_b64_tr_b16 v[120:121], v6 offset:64
    v_mfma_f32_16x16x32_bf16 v[32:35], v[96:99], v[132:135], v[32:35]
    ds_read_b64_tr_b16 v[122:123], v6 offset:320
    ds_read_b64_tr_b16 v[124:125], v6 offset:96
    v_mfma_f32_16x16x32_bf16 v[36:39], v[100:103], v[132:135], v[36:39]
    ds_read_b64_tr_b16 v[126:127], v6 offset:352
    v_mfma_f32_16x16x32_bf16 v[40:43], v[104:107], v[132:135], v[40:43]
    s_add_u32 s47, s47, 16896
    s_cmp_eq_u32 s47, 163584
    v_mfma_f32_16x16x32_bf16 v[44:47], v[108:111], v[132:135], v[44:47]
    s_cselect_b32 s47, 79104, s47
    v_mfma_f32_16x16x32_bf16 v[48:51], v[96:99], v[136:139], v[48:51]
    s_add_u32 m0, s46, s48
    s_add_u32 s32, s44, 8192
    v_mfma_f32_16x16x32_bf16 v[52:55], v[100:103], v[136:139], v[52:55]
    buffer_load_dwordx4 v2, s[16:19], s44 offen nt lds
    v_mfma_f32_16x16x32_bf16 v[56:59], v[104:107], v[136:139], v[56:59]
    s_add_u32 m0, m0, 1056
    s_add_u32 s44, s44, 262144
    v_mfma_f32_16x16x32_bf16 v[60:63], v[108:111], v[136:139], v[60:63]
    buffer_load_dwordx4 v2, s[16:19], s32 offen nt lds
    v_mfma_f32_16x16x32_bf16 v[64:67], v[96:99], v[140:143], v[64:67]
    s_cmp_ge_u32 s44, 5242880
    s_cselect_b32 s32, 5242880, 0
    v_mfma_f32_16x16x32_bf16 v[68:71], v[100:103], v[140:143], v[68:71]
    s_sub_u32 s44, s44, s32
    v_mfma_f32_16x16x32_bf16 v[72:75], v[104:107], v[140:143], v[72:75]
    s_add_u32 s46, s46, 16896
    s_cmp_eq_u32 s46, 163584
    v_mfma_f32_16x16x32_bf16 v[76:79], v[108:111], v[140:143], v[76:79]
    s_cselect_b32 s46, 79104, s46
    s_waitcnt lgkmcnt(0)
    s_waitcnt vmcnt(6)
    s_barrier
    v_mfma_f32_16x16x32_bf16 v[16:19], v[112:115], v[148:151], v[16:19]
    ds_read_b128 v[128:131], v7 offset:18432
    ds_read_b128 v[132:135], v7 offset:20480
    ds_read_b128 v[136:139], v7 offset:22528
    v_mfma_f32_16x16x32_bf16 v[20:23], v[116:119], v[148:151], v[20:23]
    ds_read_b128 v[140:143], v7 offset:24576
    v_add_u32 v6, s47, v5
    ds_read_b64_tr_b16 v[96:97], v6 offset:0
    v_mfma_f32_16x16x32_bf16 v[24:27], v[120:123], v[148:151], v[24:27]
    ds_read_b64_tr_b16 v[98:99], v6 offset:256
    ds_read_b64_tr_b16 v[100:101], v6 offset:32
    ds_read_b64_tr_b16 v[102:103], v6 offset:288
    ds_read_b64_tr_b16 v[104:105], v6 offset:64
    v_mfma_f32_16x16x32_bf16 v[28:31], v[124:127], v[148:151], v[28:31]
    ds_read_b128 v[148:151], v8 offset:18432
    ds_read_b64_tr_b16 v[106:107], v6 offset:320
    ds_read_b64_tr_b16 v[108:109], v6 offset:96
    v_mfma_f32_16x16x32_bf16 v[32:35], v[112:115], v[152:155], v[32:35]
    ds_read_b64_tr_b16 v[110:111], v6 offset:352
    s_add_u32 s47, s47, 16896
    s_cmp_eq_u32 s47, 163584
    v_mfma_f32_16x16x32_bf16 v[36:39], v[116:119], v[152:155], v[36:39]
    s_cselect_b32 s47, 79104, s47
    s_add_u32 m0, s46, s48
    s_add_u32 s32, s44, 8192
    v_mfma_f32_16x16x32_bf16 v[40:43], v[120:123], v[152:155], v[40:43]
    buffer_load_dwordx4 v2, s[16:19], s44 offen nt lds
    s_add_u32 m0, m0, 1056
    s_add_u32 s44, s44, 262144
    v_mfma_f32_16x16x32_bf16 v[44:47], v[124:127], v[152:155], v[44:47]
    ds_read_b128 v[152:155], v8 offset:20480
    buffer_load_dwordx4 v2, s[16:19], s32 offen nt lds
    s_cmp_ge_u32 s44, 5242880
    s_cselect_b32 s32, 5242880, 0
    v_mfma_f32_16x16x32_bf16 v[48:51], v[112:115], v[156:159], v[48:51]
    s_sub_u32 s44, s44, s32
    s_add_u32 s46, s46, 16896
    s_cmp_eq_u32 s46, 163584
    v_mfma_f32_16x16x32_bf16 v[52:55], v[116:119], v[156:159], v[52:55]
    s_cselect_b32 s46, 79104, s46
    s_add_u32 s32, s37, s38
    s_and_b32 s32, s32, 0x3ffff
    v_mfma_f32_16x16x32_bf16 v[56:59], v[120:123], v[156:159], v[56:59]
    s_and_b32 s33, s37, 0xfffc0000
    s_mov_b32 m0, s39
    s_or_b32 s32, s32, s33
    v_mfma_f32_16x16x32_bf16 v[60:63], v[124:127], v[156:159], v[60:63]
    ds_read_b128 v[156:159], v8 offset:22528
    buffer_load_dwordx4 v15, s[8:11], s32 offen nt lds
    s_add_u32 m0, m0, s42
    v_mfma_f32_16x16x32_bf16 v[64:67], v[112:115], v[160:163], v[64:67]
    s_add_u32 s32, s32, s43
    buffer_load_dwordx4 v15, s[8:11], s32 offen nt lds
    s_add_u32 m0, m0, s42
    v_mfma_f32_16x16x32_bf16 v[68:71], v[116:119], v[160:163], v[68:71]
    s_add_u32 s32, s32, s43
    buffer_load_dwordx4 v15, s[8:11], s32 offen nt lds
    s_add_u32 m0, m0, s42
    s_add_u32 s32, s32, s43
    v_mfma_f32_16x16x32_bf16 v[72:75], v[120:123], v[160:163], v[72:75]
    buffer_load_dwordx4 v15, s[8:11], s32 offen nt lds
    s_add_u32 s37, s37, 8192
    s_add_u32 s39, s39, 8448
    v_mfma_f32_16x16x32_bf16 v[76:79], v[124:127], v[160:163], v[76:79]
    ds_read_b128 v[160:163], v8 offset:24576
    s_cmp_eq_u32 s39, s41
    s_cselect_b32 s39, s40, s39
    s_waitcnt lgkmcnt(0)
    s_waitcnt vmcnt(10)
    s_barrier
    v_mfma_f32_16x16x32_bf16 v[16:19], v[96:99], v[128:131], v[16:19]
    v_add_u32 v6, s47, v5
    ds_read_b64_tr_b16 v[112:113], v6 offset:0
    v_mfma_f32_16x16x32_bf16 v[20:23], v[100:103], v[128:131], v[20:23]
    ds_read_b64_tr_b16 v[114:115], v6 offset:256
    v_mfma_f32_16x16x32_bf16 v[24:27], v[104:107], v[128:131], v[24:27]
    ds_read_b64_tr_b16 v[116:117], v6 offset:32
    ds_read_b64_tr_b16 v[118:119], v6 offset:288
    v_mfma_f32_16x16x32_bf16 v[28:31], v[108:111], v[128:131], v[28:31]
    ds_read_b64_tr_b16 v[120:121], v6 offset:64
    v_mfma_f32_16x16x32_bf16 v[32:35], v[96:99], v[132:135], v[32:35]
    ds_read_b64_tr_b16 v[122:123], v6 offset:320
    ds_read_b64_tr_b16 v[124:125], v6 offset:96
    v_mfma_f32_16x16x32_bf16 v[36:39], v[100:103], v[132:135], v[36:39]
    ds_read_b64_tr_b16 v[126:127], v6 offset:352
    v_mfma_f32_16x16x32_bf16 v[40:43], v[104:107], v[132:135], v[40:43]
    s_add_u32 s47, s47, 16896
    s_cmp_eq_u32 s47, 163584
    v_mfma_f32_16x16x32_bf16 v[44:47], v[108:111], v[132:135], v[44:47]
    s_cselect_b32 s47, 79104, s47
    v_mfma_f32_16x16x32_bf16 v[48:51], v[96:99], v[136:139], v[48:51]
    s_add_u32 m0, s46, s48
    s_add_u32 s32, s44, 8192
    v_mfma_f32_16x16x32_bf16 v[52:55], v[100:103], v[136:139], v[52:55]
    buffer_load_dwordx4 v2, s[16:19], s44 offen nt lds
    v_mfma_f32_16x16x32_bf16 v[56:59], v[104:107], v[136:139], v[56:59]
    s_add_u32 m0, m0, 1056
    s_add_u32 s44, s44, 262144
    v_mfma_f32_16x16x32_bf16 v[60:63], v[108:111], v[136:139], v[60:63]
    buffer_load_dwordx4 v2, s[16:19], s32 offen nt lds
    v_mfma_f32_16x16x32_bf16 v[64:67], v[96:99], v[140:143], v[64:67]
    s_cmp_ge_u32 s44, 5242880
    s_cselect_b32 s32, 5242880, 0
    v_mfma_f32_16x16x32_bf16 v[68:71], v[100:103], v[140:143], v[68:71]
    s_sub_u32 s44, s44, s32
    v_mfma_f32_16x16x32_bf16 v[72:75], v[104:107], v[140:143], v[72:75]
    s_add_u32 s46, s46, 16896
    s_cmp_eq_u32 s46, 163584
    v_mfma_f32_16x16x32_bf16 v[76:79], v[108:111], v[140:143], v[76:79]
    s_cselect_b32 s46, 79104, s46
    s_waitcnt lgkmcnt(0)
    s_waitcnt vmcnt(10)
    s_barrier
    v_mfma_f32_16x16x32_bf16 v[16:19], v[112:115], v[148:151], v[16:19]
    ds_read_b128 v[128:131], v7 offset:0
    ds_read_b128 v[132:135], v7 offset:2048
    v_mfma_f32_16x16x32_bf16 v[20:23], v[116:119], v[148:151], v[20:23]
    ds_read_b128 v[136:139], v7 offset:4096
    ds_read_b128 v[140:143], v7 offset:6144
    v_mfma_f32_16x16x32_bf16 v[24:27], v[120:123], v[148:151], v[24:27]
    v_add_u32 v6, s47, v5
    ds_read_b64_tr_b16 v[96:97], v6 offset:0
    v_mfma_f32_16x16x32_bf16 v[28:31], v[124:127], v[148:151], v[28:31]
    ds_read_b128 v[148:151], v8 offset:0
    ds_read_b64_tr_b16 v[98:99], v6 offset:256
    v_mfma_f32_16x16x32_bf16 v[32:35], v[112:115], v[152:155], v[32:35]
    ds_read_b64_tr_b16 v[100:101], v6 offset:32
    ds_read_b64_tr_b16 v[102:103], v6 offset:288
    v_mfma_f32_16x16x32_bf16 v[36:39], v[116:119], v[152:155], v[36:39]
    ds_read_b64_tr_b16 v[104:105], v6 offset:64
    ds_read_b64_tr_b16 v[106:107], v6 offset:320
    v_mfma_f32_16x16x32_bf16 v[40:43], v[120:123], v[152:155], v[40:43]
    ds_read_b64_tr_b16 v[108:109], v6 offset:96
    ds_read_b64_tr_b16 v[110:111], v6 offset:352
    v_mfma_f32_16x16x32_bf16 v[44:47], v[124:127], v[152:155], v[44:47]
    ds_read_b128 v[152:155], v8 offset:2048
    s_add_u32 s47, s47, 16896
    v_mfma_f32_16x16x32_bf16 v[48:51], v[112:115], v[156:159], v[48:51]
    s_cmp_eq_u32 s47, 163584
    s_cselect_b32 s47, 79104, s47
    v_mfma_f32_16x16x32_bf16 v[52:55], v[116:119], v[156:159], v[52:55]
    s_add_u32 m0, s46, s48
    s_add_u32 s32, s44, 8192
    v_mfma_f32_16x16x32_bf16 v[56:59], v[120:123], v[156:159], v[56:59]
    buffer_load_dwordx4 v2, s[16:19], s44 offen nt lds
    s_add_u32 m0, m0, 1056
    v_mfma_f32_16x16x32_bf16 v[60:63], v[124:127], v[156:159], v[60:63]
    ds_read_b128 v[156:159], v8 offset:4096
    s_add_u32 s44, s44, 262144
    v_mfma_f32_16x16x32_bf16 v[64:67], v[112:115], v[160:163], v[64:67]
    buffer_load_dwordx4 v2, s[16:19], s32 offen nt lds
    s_cmp_ge_u32 s44, 5242880
    v_mfma_f32_16x16x32_bf16 v[68:71], v[116:119], v[160:163], v[68:71]
    s_cselect_b32 s32, 5242880, 0
    s_sub_u32 s44, s44, s32
    v_mfma_f32_16x16x32_bf16 v[72:75], v[120:123], v[160:163], v[72:75]
    s_add_u32 s46, s46, 16896
    s_cmp_eq_u32 s46, 163584
    v_mfma_f32_16x16x32_bf16 v[76:79], v[124:127], v[160:163], v[76:79]
    ds_read_b128 v[160:163], v8 offset:6144
    s_cselect_b32 s46, 79104, s46
    s_waitcnt lgkmcnt(0)
    s_waitcnt vmcnt(10)
    s_sub_u32 s30, s30, 1
    s_cmp_lg_u32 s30, 0
    s_barrier
    s_cbranch_scc1 PG_c_loop
    v_mfma_f32_16x16x32_bf16 v[16:19], v[96:99], v[128:131], v[16:19]
    v_add_u32 v6, s47, v5
    ds_read_b64_tr_b16 v[112:113], v6 offset:0
    v_mfma_f32_16x16x32_bf16 v[20:23], v[100:103], v[128:131], v[20:23]
    ds_read_b64_tr_b16 v[114:115], v6 offset:256
    v_mfma_f32_16x16x32_bf16 v[24:27], v[104:107], v[128:131], v[24:27]
    ds_read_b64_tr_b16 v[116:117], v6 offset:32
    ds_read_b64_tr_b16 v[118:119], v6 offset:288
    v_mfma_f32_16x16x32_bf16 v[28:31], v[108:111], v[128:131], v[28:31]
    ds_read_b64_tr_b16 v[120:121], v6 offset:64
    v_mfma_f32_16x16x32_bf16 v[32:35], v[96:99], v[132:135], v[32:35]
    ds_read_b64_tr_b16 v[122:123], v6 offset:320
    ds_read_b64_tr_b16 v[124:125], v6 offset:96
    v_mfma_f32_16x16x32_bf16 v[36:39], v[100:103], v[132:135], v[36:39]
    ds_read_b64_tr_b16 v[126:127], v6 offset:352
    v_mfma_f32_16x16x32_bf16 v[40:43], v[104:107], v[132:135], v[40:43]
    s_add_u32 s47, s47, 16896
    s_cmp_eq_u32 s47, 163584
    v_mfma_f32_16x16x32_bf16 v[44:47], v[108:111], v[132:135], v[44:47]
    s_cselect_b32 s47, 79104, s47
    v_mfma_f32_16x16x32_bf16 v[48:51], v[96:99], v[136:139], v[48:51]
    s_add_u32 m0, s46, s48
    s_add_u32 s32, s44, 8192
    v_mfma_f32_16x16x32_bf16 v[52:55], v[100:103], v[136:139], v[52:55]
    buffer_load_dwordx4 v2, s[16:19], s44 offen nt lds
    v_mfma_f32_16x16x32_bf16 v[56:59], v[104:107], v[136:139], v[56:59]
    s_add_u32 m0, m0, 1056
    s_add_u32 s44, s44, 262144
    v_mfma_f32_16x16x32_bf16 v[60:63], v[108:111], v[136:139], v[60:63]
    buffer_load_dwordx4 v2, s[16:19], s32 offen nt lds
    v_mfma_f32_16x16x32_bf16 v[64:67], v[96:99], v[140:143], v[64:67]
    s_cmp_ge_u32 s44, 5242880
    s_cselect_b32 s32, 5242880, 0
    v_mfma_f32_16x16x32_bf16 v[68:71], v[100:103], v[140:143], v[68:71]
    s_sub_u32 s44, s44, s32
    v_mfma_f32_16x16x32_bf16 v[72:75], v[104:107], v[140:143], v[72:75]
    s_add_u32 s46, s46, 16896
    s_cmp_eq_u32 s46, 163584
    v_mfma_f32_16x16x32_bf16 v[76:79], v[108:111], v[140:143], v[76:79]
    s_cselect_b32 s46, 79104, s46
    s_waitcnt lgkmcnt(0)
    s_waitcnt vmcnt(10)
    s_barrier
    v_mfma_f32_16x16x32_bf16 v[16:19], v[112:115], v[148:151], v[16:19]
    ds_read_b128 v[128:131], v7 offset:18432
    ds_read_b128 v[132:135], v7 offset:20480
    ds_read_b128 v[136:139], v7 offset:22528
    v_mfma_f32_16x16x32_bf16 v[20:23], v[116:119], v[148:151], v[20:23]
    ds_read_b128 v[140:143], v7 offset:24576
    v_add_u32 v6, s47, v5
    ds_read_b64_tr_b16 v[96:97], v6 offset:0
    v_mfma_f32_16x16x32_bf16 v[24:27], v[120:123], v[148:151], v[24:27]
    ds_read_b64_tr_b16 v[98:99], v6 offset:256
    ds_read_b64_tr_b16 v[100:101], v6 offset:32
    ds_read_b64_tr_b16 v[102:103], v6 offset:288
    ds_read_b64_tr_b16 v[104:105], v6 offset:64
    v_mfma_f32_16x16x32_bf16 v[28:31], v[124:127], v[148:151], v[28:31]
    ds_read_b128 v[148:151], v8 offset:18432
    ds_read_b64_tr_b16 v[106:107], v6 offset:320
    ds_read_b64_tr_b16 v[108:109], v6 offset:96
    v_mfma_f32_16x16x32_bf16 v[32:35], v[112:115], v[152:155], v[32:35]
    ds_read_b64_tr_b16 v[110:111], v6 offset:352
    s_add_u32 s47, s47, 16896
    s_cmp_eq_u32 s47, 163584
    v_mfma_f32_16x16x32_bf16 v[36:39], v[116:119], v[152:155], v[36:39]
    s_cselect_b32 s47, 79104, s47
    s_add_u32 m0, s46, s48
    s_add_u32 s32, s44, 8192
    v_mfma_f32_16x16x32_bf16 v[40:43], v[120:123], v[152:155], v[40:43]
    buffer_load_dwordx4 v2, s[16:19], s44 offen nt lds
    s_add_u32 m0, m0, 1056
    s_add_u32 s44, s44, 262144
    v_mfma_f32_16x16x32_bf16 v[44:47], v[124:127], v[152:155], v[44:47]
    ds_read_b128 v[152:155], v8 offset:20480
    buffer_load_dwordx4 v2, s[16:19], s32 offen nt lds
    s_cmp_ge_u32 s44, 5242880
    s_cselect_b32 s32, 5242880, 0
    v_mfma_f32_16x16x32_bf16 v[48:51], v[112:115], v[156:159], v[48:51]
    s_sub_u32 s44, s44, s32
    s_add_u32 s46, s46, 16896
    s_cmp_eq_u32 s46, 163584
    v_mfma_f32_16x16x32_bf16 v[52:55], v[116:119], v[156:159], v[52:55]
    s_cselect_b32 s46, 79104, s46
    s_add_u32 s32, s37, s38
    s_and_b32 s32, s32, 0x3ffff
    v_mfma_f32_16x16x32_bf16 v[56:59], v[120:123], v[156:159], v[56:59]
    s_and_b32 s33, s37, 0xfffc0000
    s_mov_b32 m0, s39
    s_or_b32 s32, s32, s33
    v_mfma_f32_16x16x32_bf16 v[60:63], v[124:127], v[156:159], v[60:63]
    ds_read_b128 v[156:159], v8 offset:22528
    buffer_load_dwordx4 v15, s[8:11], s32 offen nt lds
    s_add_u32 m0, m0, s42
    v_mfma_f32_16x16x32_bf16 v[64:67], v[112:115], v[160:163], v[64:67]
    s_add_u32 s32, s32, s43
    buffer_load_dwordx4 v15, s[8:11], s32 offen nt lds
    s_add_u32 m0, m0, s42
    v_mfma_f32_16x16x32_bf16 v[68:71], v[116:119], v[160:163], v[68:71]
    s_add_u32 s32, s32, s43
    buffer_load_dwordx4 v15, s[8:11], s32 offen nt lds
    s_add_u32 m0, m0, s42
    s_add_u32 s32, s32, s43
    v_mfma_f32_16x16x32_bf16 v[72:75], v[120:123], v[160:163], v[72:75]
    buffer_load_dwordx4 v15, s[8:11], s32 offen nt lds
    s_add_u32 s37, s37, 8192
    s_add_u32 s39, s39, 8448
    v_mfma_f32_16x16x32_bf16 v[76:79], v[124:127], v[160:163], v[76:79]
    ds_read_b128 v[160:163], v8 offset:24576
    s_cmp_eq_u32 s39, s41
    s_cselect_b32 s39, s40, s39
    s_waitcnt lgkmcnt(0)
    s_waitcnt vmcnt(10)
    s_barrier
    v_mfma_f32_16x16x32_bf16 v[16:19], v[96:99], v[128:131], v[16:19]
    v_add_u32 v6, s47, v5
    ds_read_b64_tr_b16 v[112:113], v6 offset:0
    v_mfma_f32_16x16x32_bf16 v[20:23], v[100:103], v[128:131], v[20:23]
    ds_read_b64_tr_b16 v[114:115], v6 offset:256
    v_mfma_f32_16x16x32_bf16 v[24:27], v[104:107], v[128:131], v[24:27]
    ds_read_b64_tr_b16 v[116:117], v6 offset:32
    ds_read_b64_tr_b16 v[118:119], v6 offset:288
    v_mfma_f32_16x16x32_bf16 v[28:31], v[108:111], v[128:131], v[28:31]
    ds_read_b64_tr_b16 v[120:121], v6 offset:64
    v_mfma_f32_16x16x32_bf16 v[32:35], v[96:99], v[132:135], v[32:35]
    ds_read_b64_tr_b16 v[122:123], v6 offset:320
    ds_read_b64_tr_b16 v[124:125], v6 offset:96
    v_mfma_f32_16x16x32_bf16 v[36:39], v[100:103], v[132:135], v[36:39]
    ds_read_b64_tr_b16 v[126:127], v6 offset:352
    v_mfma_f32_16x16x32_bf16 v[40:43], v[104:107], v[132:135], v[40:43]
    s_add_u32 s47, s47, 16896
    s_cmp_eq_u32 s47, 163584
    v_mfma_f32_16x16x32_bf16 v[44:47], v[108:111], v[132:135], v[44:47]
    s_cselect_b32 s47, 79104, s47
    v_mfma_f32_16x16x32_bf16 v[48:51], v[96:99], v[136:139], v[48:51]
    s_add_u32 m0, s46, s48
    s_add_u32 s32, s44, 8192
    v_mfma_f32_16x16x32_bf16 v[52:55], v[100:103], v[136:139], v[52:55]
    buffer_load_dwordx4 v2, s[16:19], s44 offen nt lds
    v_mfma_f32_16x16x32_bf16 v[56:59], v[104:107], v[136:139], v[56:59]
    s_add_u32 m0, m0, 1056
    s_add_u32 s44, s44, 262144
    v_mfma_f32_16x16x32_bf16 v[60:63], v[108:111], v[136:139], v[60:63]
    buffer_load_dwordx4 v2, s[16:19], s32 offen nt lds
    v_mfma_f32_16x16x32_bf16 v[64:67], v[96:99], v[140:143], v[64:67]
    s_cmp_ge_u32 s44, 5242880
    s_cselect_b32 s32, 5242880, 0
    v_mfma_f32_16x16x32_bf16 v[68:71], v[100:103], v[140:143], v[68:71]
    s_sub_u32 s44, s44, s32
    v_mfma_f32_16x16x32_bf16 v[72:75], v[104:107], v[140:143], v[72:75]
    s_add_u32 s46, s46, 16896
    s_cmp_eq_u32 s46, 163584
    v_mfma_f32_16x16x32_bf16 v[76:79], v[108:111], v[140:143], v[76:79]
    s_cselect_b32 s46, 79104, s46
    s_waitcnt lgkmcnt(0)
    s_waitcnt vmcnt(10)
    s_barrier
    v_mfma_f32_16x16x32_bf16 v[16:19], v[112:115], v[148:151], v[16:19]
    ds_read_b128 v[128:131], v7 offset:0
    v_mfma_f32_16x16x32_bf16 v[20:23], v[116:119], v[148:151], v[20:23]
    ds_read_b128 v[132:135], v7 offset:2048
    ds_read_b128 v[136:139], v7 offset:4096
    v_mfma_f32_16x16x32_bf16 v[24:27], v[120:123], v[148:151], v[24:27]
    ds_read_b128 v[140:143], v7 offset:6144
    v_mfma_f32_16x16x32_bf16 v[28:31], v[124:127], v[148:151], v[28:31]
    ds_read_b128 v[148:151], v8 offset:0
    v_mfma_f32_16x16x32_bf16 v[32:35], v[112:115], v[152:155], v[32:35]
    v_add_u32 v6, s47, v5
    v_mfma_f32_16x16x32_bf16 v[36:39], v[116:119], v[152:155], v[36:39]
    ds_read_b64_tr_b16 v[96:97], v6 offset:0
    ds_read_b64_tr_b16 v[98:99], v6 offset:256
    v_mfma_f32_16x16x32_bf16 v[40:43], v[120:123], v[152:155], v[40:43]
    ds_read_b64_tr_b16 v[100:101], v6 offset:32
    v_mfma_f32_16x16x32_bf16 v[44:47], v[124:127], v[152:155], v[44:47]
    ds_read_b128 v[152:155], v8 offset:2048
    v_mfma_f32_16x16x32_bf16 v[48:51], v[112:115], v[156:159], v[48:51]
    ds_read_b64_tr_b16 v[102:103], v6 offset:288
    v_mfma_f32_16x16x32_bf16 v[52:55], v[116:119], v[156:159], v[52:55]
    ds_read_b64_tr_b16 v[104:105], v6 offset:64
    ds_read_b64_tr_b16 v[106:107], v6 offset:320
    v_mfma_f32_16x16x32_bf16 v[56:59], v[120:123], v[156:159], v[56:59]
    ds_read_b64_tr_b16 v[108:109], v6 offset:96
    v_mfma_f32_16x16x32_bf16 v[60:63], v[124:127], v[156:159], v[60:63]
    ds_read_b128 v[156:159], v8 offset:4096
    v_mfma_f32_16x16x32_bf16 v[64:67], v[112:115], v[160:163], v[64:67]
    ds_read_b64_tr_b16 v[110:111], v6 offset:352
    v_mfma_f32_16x16x32_bf16 v[68:71], v[116:119], v[160:163], v[68:71]
    s_add_u32 s47, s47, 16896
    s_cmp_eq_u32 s47, 163584
    v_mfma_f32_16x16x32_bf16 v[72:75], v[120:123], v[160:163], v[72:75]
    s_cselect_b32 s47, 79104, s47
    v_mfma_f32_16x16x32_bf16 v[76:79], v[124:127], v[160:163], v[76:79]
    ds_read_b128 v[160:163], v8 offset:6144
    s_waitcnt lgkmcnt(0)
    s_waitcnt vmcnt(8)
    s_barrier
    v_mfma_f32_16x16x32_bf16 v[16:19], v[96:99], v[128:131], v[16:19]
    v_add_u32 v6, s47, v5
    v_mfma_f32_16x16x32_bf16 v[20:23], v[100:103], v[128:131], v[20:23]
    ds_read_b64_tr_b16 v[112:113], v6 offset:0
    v_mfma_f32_16x16x32_bf16 v[24:27], v[104:107], v[128:131], v[24:27]
    v_mfma_f32_16x16x32_bf16 v[28:31], v[108:111], v[128:131], v[28:31]
    ds_read_b64_tr_b16 v[114:115], v6 offset:256
    v_mfma_f32_16x16x32_bf16 v[32:35], v[96:99], v[132:135], v[32:35]
    ds_read_b64_tr_b16 v[116:117], v6 offset:32
    v_mfma_f32_16x16x32_bf16 v[36:39], v[100:103], v[132:135], v[36:39]
    ds_read_b64_tr_b16 v[118:119], v6 offset:288
    v_mfma_f32_16x16x32_bf16 v[40:43], v[104:107], v[132:135], v[40:43]
    v_mfma_f32_16x16x32_bf16 v[44:47], v[108:111], v[132:135], v[44:47]
    ds_read_b64_tr_b16 v[120:121], v6 offset:64
    v_mfma_f32_16x16x32_bf16 v[48:51], v[96:99], v[136:139], v[48:51]
    ds_read_b64_tr_b16 v[122:123], v6 offset:320
    v_mfma_f32_16x16x32_bf16 v[52:55], v[100:103], v[136:139], v[52:55]
    ds_read_b64_tr_b16 v[124:125], v6 offset:96
    v_mfma_f32_16x16x32_bf16 v[56:59], v[104:107], v[136:139], v[56:59]
    v_mfma_f32_16x16x32_bf16 v[60:63], v[108:111], v[136:139], v[60:63]
    ds_read_b64_tr_b16 v[126:127], v6 offset:352
    v_mfma_f32_16x16x32_bf16 v[64:67], v[96:99], v[140:143], v[64:67]
    s_add_u32 s47, s47, 16896
    v_mfma_f32_16x16x32_bf16 v[68:71], v[100:103], v[140:143], v[68:71]
    s_cmp_eq_u32 s47, 163584
    v_mfma_f32_16x16x32_bf16 v[72:75], v[104:107], v[140:143], v[72:75]
    v_mfma_f32_16x16x32_bf16 v[76:79], v[108:111], v[140:143], v[76:79]
    s_cselect_b32 s47, 79104, s47
    s_waitcnt lgkmcnt(0)
    s_waitcnt vmcnt(6)
    s_barrier
    v_mfma_f32_16x16x32_bf16 v[16:19], v[112:115], v[148:151], v[16:19]
    ds_read_b128 v[128:131], v7 offset:18432
    ds_read_b128 v[132:135], v7 offset:20480
    v_mfma_f32_16x16x32_bf16 v[20:23], v[116:119], v[148:151], v[20:23]
    ds_read_b128 v[136:139], v7 offset:22528
    ds_read_b128 v[140:143], v7 offset:24576
    v_add_u32 v6, s47, v5
    v_mfma_f32_16x16x32_bf16 v[24:27], v[120:123], v[148:151], v[24:27]
    ds_read_b64_tr_b16 v[96:97], v6 offset:0
    ds_read_b64_tr_b16 v[98:99], v6 offset:256
    v_mfma_f32_16x16x32_bf16 v[28:31], v[124:127], v[148:151], v[28:31]
    ds_read_b128 v[148:151], v8 offset:18432
    ds_read_b64_tr_b16 v[100:101], v6 offset:32
    ds_read_b64_tr_b16 v[102:103], v6 offset:288
    v_mfma_f32_16x16x32_bf16 v[32:35], v[112:115], v[152:155], v[32:35]
    ds_read_b64_tr_b16 v[104:105], v6 offset:64
    ds_read_b64_tr_b16 v[106:107], v6 offset:320
    v_mfma_f32_16x16x32_bf16 v[36:39], v[116:119], v[152:155], v[36:39]
    ds_read_b64_tr_b16 v[108:109], v6 offset:96
    ds_read_b64_tr_b16 v[110:111], v6 offset:352
    s_add_u32 s47, s47, 16896
    v_mfma_f32_16x16x32_bf16 v[40:43], v[120:123], v[152:155], v[40:43]
    s_cmp_eq_u32 s47, 163584
    s_cselect_b32 s47, 79104, s47
    v_mfma_f32_16x16x32_bf16 v[44:47], v[124:127], v[152:155], v[44:47]
    ds_read_b128 v[152:155], v8 offset:20480
    s_add_u32 s32, s37, s38
    s_and_b32 s32, s32, 0x3ffff
    v_mfma_f32_16x16x32_bf16 v[48:51], v[112:115], v[156:159], v[48:51]
    s_and_b32 s33, s37, 0xfffc0000
    s_mov_b32 m0, s39
    v_mfma_f32_16x16x32_bf16 v[52:55], v[116:119], v[156:159], v[52:55]
    s_or_b32 s32, s32, s33
    buffer_load_dwordx4 v15, s[8:11], s32 offen nt lds
    v_mfma_f32_16x16x32_bf16 v[56:59], v[120:123], v[156:159], v[56:59]
    s_add_u32 m0, m0, s42
    s_add_u32 s32, s32, s43
    buffer_load_dwordx4 v15, s[8:11], s32 offen nt lds
    v_mfma_f32_16x16x32_bf16 v[60:63], v[124:127], v[156:159], v[60:63]
    ds_read_b128 v[156:159], v8 offset:22528
    s_add_u32 m0, m0, s42
    v_mfma_f32_16x16x32_bf16 v[64:67], v[112:115], v[160:163], v[64:67]
    s_add_u32 s32, s32, s43
    buffer_load_dwordx4 v15, s[8:11], s32 offen nt lds
    s_add_u32 m0, m0, s42
    v_mfma_f32_16x16x32_bf16 v[68:71], v[116:119], v[160:163], v[68:71]
    s_add_u32 s32, s32, s43
    buffer_load_dwordx4 v15, s[8:11], s32 offen nt lds
    v_mfma_f32_16x16x32_bf16 v[72:75], v[120:123], v[160:163], v[72:75]
    s_add_u32 s37, s37, 8192
    s_add_u32 s39, s39, 8448
    s_cmp_eq_u32 s39, s41
    v_mfma_f32_16x16x32_bf16 v[76:79], v[124:127], v[160:163], v[76:79]
    ds_read_b128 v[160:163], v8 offset:24576
    s_cselect_b32 s39, s40, s39
    s_waitcnt lgkmcnt(0)
    s_waitcnt vmcnt(4)
    s_barrier
    v_mfma_f32_16x16x32_bf16 v[16:19], v[96:99], v[128:131], v[16:19]
    v_add_u32 v6, s47, v5
    v_mfma_f32_16x16x32_bf16 v[20:23], v[100:103], v[128:131], v[20:23]
    ds_read_b64_tr_b16 v[112:113], v6 offset:0
    v_mfma_f32_16x16x32_bf16 v[24:27], v[104:107], v[128:131], v[24:27]
    v_mfma_f32_16x16x32_bf16 v[28:31], v[108:111], v[128:131], v[28:31]
    ds_read_b64_tr_b16 v[114:115], v6 offset:256
    v_mfma_f32_16x16x32_bf16 v[32:35], v[96:99], v[132:135], v[32:35]
    ds_read_b64_tr_b16 v[116:117], v6 offset:32
    v_mfma_f32_16x16x32_bf16 v[36:39], v[100:103], v[132:135], v[36:39]
    ds_read_b64_tr_b16 v[118:119], v6 offset:288
    v_mfma_f32_16x16x32_bf16 v[40:43], v[104:107], v[132:135], v[40:43]
    v_mfma_f32_16x16x32_bf16 v[44:47], v[108:111], v[132:135], v[44:47]
    ds_read_b64_tr_b16 v[120:121], v6 offset:64
    v_mfma_f32_16x16x32_bf16 v[48:51], v[96:99], v[136:139], v[48:51]
    ds_read_b64_tr_b16 v[122:123], v6 offset:320
    v_mfma_f32_16x16x32_bf16 v[52:55], v[100:103], v[136:139], v[52:55]
    ds_read_b64_tr_b16 v[124:125], v6 offset:96
    v_mfma_f32_16x16x32_bf16 v[56:59], v[104:107], v[136:139], v[56:59]
    v_mfma_f32_16x16x32_bf16 v[60:63], v[108:111], v[136:139], v[60:63]
    ds_read_b64_tr_b16 v[126:127], v6 offset:352
    v_mfma_f32_16x16x32_bf16 v[64:67], v[96:99], v[140:143], v[64:67]
    s_add_u32 s47, s47, 16896
    v_mfma_f32_16x16x32_bf16 v[68:71], v[100:103], v[140:143], v[68:71]
    s_cmp_eq_u32 s47, 163584
    v_mfma_f32_16x16x32_bf16 v[72:75], v[104:107], v[140:143], v[72:75]
    v_mfma_f32_16x16x32_bf16 v[76:79], v[108:111], v[140:143], v[76:79]
    s_cselect_b32 s47, 79104, s47
    s_waitcnt lgkmcnt(0)
    s_barrier
    v_mfma_f32_16x16x32_bf16 v[16:19], v[112:115], v[148:151], v[16:19]
    s_mov_b32 s34, 0x3e0293ee
    s_mov_b32 s35, 0x3e0293ee
    v_mfma_f32_16x16x32_bf16 v[20:23], v[116:119], v[148:151], v[20:23]
    v_mfma_f32_16x16x32_bf16 v[24:27], v[120:123], v[148:151], v[24:27]
    v_mfma_f32_16x16x32_bf16 v[28:31], v[124:127], v[148:151], v[28:31]
    v_mfma_f32_16x16x32_bf16 v[32:35], v[112:115], v[152:155], v[32:35]
    v_mfma_f32_16x16x32_bf16 v[36:39], v[116:119], v[152:155], v[36:39]
    v_mfma_f32_16x16x32_bf16 v[40:43], v[120:123], v[152:155], v[40:43]
    v_mfma_f32_16x16x32_bf16 v[44:47], v[124:127], v[152:155], v[44:47]
    v_mfma_f32_16x16x32_bf16 v[48:51], v[112:115], v[156:159], v[48:51]
    v_pk_mul_f32 v[16:17], v[16:17], s[34:35]
    v_pk_mul_f32 v[18:19], v[18:19], s[34:35]
    v_cvt_pk_bf16_f32 v16, v16, v17
    v_cvt_pk_bf16_f32 v17, v18, v19
    ds_write_b64 v9, v[16:17] offset:0
    v_mfma_f32_16x16x32_bf16 v[52:55], v[116:119], v[156:159], v[52:55]
    v_pk_mul_f32 v[20:21], v[20:21], s[34:35]
    v_pk_mul_f32 v[22:23], v[22:23], s[34:35]
    v_cvt_pk_bf16_f32 v20, v20, v21
    v_cvt_pk_bf16_f32 v21, v22, v23
    ds_write_b64 v9, v[20:21] offset:32
    v_mfma_f32_16x16x32_bf16 v[56:59], v[120:123], v[156:159], v[56:59]
    v_pk_mul_f32 v[24:25], v[24:25], s[34:35]
    v_pk_mul_f32 v[26:27], v[26:27], s[34:35]
    v_cvt_pk_bf16_f32 v24, v24, v25
    v_cvt_pk_bf16_f32 v25, v26, v27
    ds_write_b64 v9, v[24:25] offset:64
    v_mfma_f32_16x16x32_bf16 v[60:63], v[124:127], v[156:159], v[60:63]
    v_pk_mul_f32 v[28:29], v[28:29], s[34:35]
    v_pk_mul_f32 v[30:31], v[30:31], s[34:35]
    v_cvt_pk_bf16_f32 v28, v28, v29
    v_cvt_pk_bf16_f32 v29, v30, v31
    ds_write_b64 v9, v[28:29] offset:96
    v_mfma_f32_16x16x32_bf16 v[64:67], v[112:115], v[160:163], v[64:67]
    v_pk_mul_f32 v[32:33], v[32:33], s[34:35]
    v_pk_mul_f32 v[34:35], v[34:35], s[34:35]
    v_cvt_pk_bf16_f32 v32, v32, v33
    v_cvt_pk_bf16_f32 v33, v34, v35
    ds_write_b64 v9, v[32:33] offset:4352
    v_mfma_f32_16x16x32_bf16 v[68:71], v[116:119], v[160:163], v[68:71]
    v_pk_mul_f32 v[36:37], v[36:37], s[34:35]
    v_pk_mul_f32 v[38:39], v[38:39], s[34:35]
    v_cvt_pk_bf16_f32 v36, v36, v37
    v_cvt_pk_bf16_f32 v37, v38, v39
    ds_write_b64 v9, v[36:37] offset:4384
    v_mfma_f32_16x16x32_bf16 v[72:75], v[120:123], v[160:163], v[72:75]
    v_pk_mul_f32 v[40:41], v[40:41], s[34:35]
    v_pk_mul_f32 v[42:43], v[42:43], s[34:35]
    v_cvt_pk_bf16_f32 v40, v40, v41
    v_cvt_pk_bf16_f32 v41, v42, v43
    ds_write_b64 v9, v[40:41] offset:4416
    v_mfma_f32_16x16x32_bf16 v[76:79], v[124:127], v[160:163], v[76:79]
    v_pk_mul_f32 v[44:45], v[44:45], s[34:35]
    v_pk_mul_f32 v[46:47], v[46:47], s[34:35]
    v_cvt_pk_bf16_f32 v44, v44, v45
    v_cvt_pk_bf16_f32 v45, v46, v47
    ds_write_b64 v9, v[44:45] offset:4448
    s_waitcnt lgkmcnt(0)
    s_nop 4
    v_pk_mul_f32 v[48:49], v[48:49], s[34:35]
    v_pk_mul_f32 v[50:51], v[50:51], s[34:35]
    v_cvt_pk_bf16_f32 v48, v48, v49
    v_cvt_pk_bf16_f32 v49, v50, v51
    ds_write_b64 v9, v[48:49] offset:8704
    v_pk_mul_f32 v[52:53], v[52:53], s[34:35]
    v_pk_mul_f32 v[54:55], v[54:55], s[34:35]
    v_cvt_pk_bf16_f32 v52, v52, v53
    v_cvt_pk_bf16_f32 v53, v54, v55
    ds_write_b64 v9, v[52:53] offset:8736
    v_pk_mul_f32 v[56:57], v[56:57], s[34:35]
    v_pk_mul_f32 v[58:59], v[58:59], s[34:35]
    v_cvt_pk_bf16_f32 v56, v56, v57
    v_cvt_pk_bf16_f32 v57, v58, v59
    ds_write_b64 v9, v[56:57] offset:8768
    v_pk_mul_f32 v[60:61], v[60:61], s[34:35]
    v_pk_mul_f32 v[62:63], v[62:63], s[34:35]
    v_cvt_pk_bf16_f32 v60, v60, v61
    v_cvt_pk_bf16_f32 v61, v62, v63
    ds_write_b64 v9, v[60:61] offset:8800
    v_pk_mul_f32 v[64:65], v[64:65], s[34:35]
    v_pk_mul_f32 v[66:67], v[66:67], s[34:35]
    v_cvt_pk_bf16_f32 v64, v64, v65
    v_cvt_pk_bf16_f32 v65, v66, v67
    ds_write_b64 v9, v[64:65] offset:13056
    v_pk_mul_f32 v[68:69], v[68:69], s[34:35]
    v_pk_mul_f32 v[70:71], v[70:71], s[34:35]
    v_cvt_pk_bf16_f32 v68, v68, v69
    v_cvt_pk_bf16_f32 v69, v70, v71
    ds_write_b64 v9, v[68:69] offset:13088
    v_pk_mul_f32 v[72:73], v[72:73], s[34:35]
    v_pk_mul_f32 v[74:75], v[74:75], s[34:35]
    v_cvt_pk_bf16_f32 v72, v72, v73
    v_cvt_pk_bf16_f32 v73, v74, v75
    ds_write_b64 v9, v[72:73] offset:13120
    v_pk_mul_f32 v[76:77], v[76:77], s[34:35]
    v_pk_mul_f32 v[78:79], v[78:79], s[34:35]
    v_cvt_pk_bf16_f32 v76, v76, v77
    v_cvt_pk_bf16_f32 v77, v78, v79
    ds_write_b64 v9, v[76:77] offset:13152
    s_waitcnt lgkmcnt(0)
    s_setprio 0
    s_waitcnt vmcnt(12)
    s_cmp_lt_u32 s3, 7
    s_cbranch_scc1 L_help
    s_branch L_rem
L_main:
    v_and_b32 v12, 15, v0
    v_lshrrev_b32 v12, 1, v12
    v_mul_u32_u24 v2, 1056, v12
    v_and_b32 v12, 1, v0
    v_lshl_add_u32 v2, v12, 8, v2
    v_lshrrev_b32 v13, 4, v0
    v_xor_b32 v12, v12, v13
    v_lshl_add_u32 v2, v12, 4, v2
    v_bfe_u32 v12, v0, 2, 2
    v_lshlrev_b32 v12, 1, v12
    v_bfe_u32 v14, v0, 4, 1
    v_add_u32 v12, v12, v14
    v_mul_u32_u24 v3, 1056, v12
    v_lshrrev_b32 v12, 5, v0
    v_lshl_add_u32 v3, v12, 8, v3
    v_and_b32 v12, 3, v0
    v_lshl_add_u32 v3, v12, 3, v3
    v_and_b32 v12, 15, v0
    s_lshl_b32 s32, s3, 5
    s_min_u32 s32, s32, 128
    v_add_u32 v14, s32, v12
    v_mul_u32_u24 v11, 272, v14
    v_lshl_add_u32 v11, v13, 4, v11
    v_add_u32 v11, 42240, v11
    v_lshlrev_b32 v10, 4, v12
    s_lshl_b32 s32, s32, 6
    s_add_u32 s32, s32, 42240
    v_add_u32 v10, s32, v10
    v_and_b32 v12, 1, v13
    v_lshl_add_u32 v10, v12, 3, v10
    v_lshrrev_b32 v12, 1, v13
    v_lshl_add_u32 v10, v12, 8, v10
    v_mov_b32 v236, 0x3f803f80
    v_mov_b32 v237, 0x3f803f80
    v_mov_b32 v238, 0x3f803f80
    v_mov_b32 v239, 0x3f803f80
    s_barrier
    ds_read_b128 v[16:19], v11 offset:0
    ds_read_b128 v[20:23], v11 offset:64
    ds_read_b128 v[24:27], v11 offset:128
    ds_read_b128 v[28:31], v11 offset:192
    ds_read_b128 v[32:35], v11 offset:4352
    ds_read_b128 v[36:39], v11 offset:4416
    ds_read_b128 v[40:43], v11 offset:4480
    ds_read_b128 v[44:47], v11 offset:4544
    v_add_u32 v4, s28, v2
    s_add_u32 s28, s28, 8448
    s_cmp_eq_u32 s28, 42240
    s_cselect_b32 s28, 0, s28
    ds_read_b128 v[168:171], v4 offset:0
    ds_read_b128 v[172:175], v4 offset:64
    ds_read_b128 v[176:179], v4 offset:128
    ds_read_b128 v[180:183], v4 offset:192
    ds_read_b128 v[184:187], v4 offset:512
    ds_read_b128 v[188:191], v4 offset:576
    ds_read_b128 v[192:195], v4 offset:640
    ds_read_b128 v[196:199], v4 offset:704
    v_add_u32 v4, s28, v2
    s_add_u32 s28, s28, 8448
    s_cmp_eq_u32 s28, 42240
    s_cselect_b32 s28, 0, s28
    v_mov_b32 v6, 0
    v_mov_b32 v12, 0
    s_waitcnt lgkmcnt(7)
    v_mfma_f32_16x16x32_bf16 v[112:115], v[168:171], v[16:19], 0
    v_mfma_f32_16x16x32_bf16 v[120:123], v[168:171], v[32:35], 0
    ds_read_b128 v[168:171], v4 offset:0
    s_waitcnt lgkmcnt(7)
    v_mfma_f32_16x16x32_bf16 v[112:115], v[172:175], v[20:23], v[112:115]
    v_mfma_f32_16x16x32_bf16 v[120:123], v[172:175], v[36:39], v[120:123]
    ds_read_b128 v[172:175], v4 offset:64
    s_waitcnt lgkmcnt(7)
    v_mfma_f32_16x16x32_bf16 v[112:115], v[176:179], v[24:27], v[112:115]
    v_mfma_f32_16x16x32_bf16 v[120:123], v[176:179], v[40:43], v[120:123]
    ds_read_b128 v[176:179], v4 offset:128
    s_waitcnt lgkmcnt(7)
    v_mfma_f32_16x16x32_bf16 v[112:115], v[180:183], v[28:31], v[112:115]
    v_mfma_f32_16x16x32_bf16 v[120:123], v[180:183], v[44:47], v[120:123]
    ds_read_b128 v[180:183], v4 offset:192
    s_waitcnt lgkmcnt(7)
    v_mfma_f32_16x16x32_bf16 v[116:119], v[184:187], v[16:19], 0
    v_mfma_f32_16x16x32_bf16 v[124:127], v[184:187], v[32:35], 0
    ds_read_b128 v[184:187], v4 offset:512
    s_waitcnt lgkmcnt(7)
    v_mfma_f32_16x16x32_bf16 v[116:119], v[188:191], v[20:23], v[116:119]
    v_mfma_f32_16x16x32_bf16 v[124:127], v[188:191], v[36:39], v[124:127]
    ds_read_b128 v[188:191], v4 offset:576
    s_waitcnt lgkmcnt(7)
    v_mfma_f32_16x16x32_bf16 v[116:119], v[192:195], v[24:27], v[116:119]
    v_mfma_f32_16x16x32_bf16 v[124:127], v[192:195], v[40:43], v[124:127]
    ds_read_b128 v[192:195], v4 offset:640
    s_waitcnt lgkmcnt(7)
    v_mfma_f32_16x16x32_bf16 v[116:119], v[196:199], v[28:31], v[116:119]
    v_mfma_f32_16x16x32_bf16 v[124:127], v[196:199], v[44:47], v[124:127]
    ds_read_b128 v[196:199], v4 offset:704
    s_nop 15
    v_max3_f32 v8, v112, v113, v114
    v_max3_f32 v8, v8, v115, v116
    v_max3_f32 v8, v8, v117, v118
    v_max_f32 v8, v8, v119
    v_mov_b32 v9, v8
    s_nop 1
    v_permlane16_swap_b32 v8, v9
    s_nop 1
    v_max_f32 v8, v8, v9
    v_mov_b32 v9, v8
    s_nop 1
    v_permlane32_swap_b32 v8, v9
    s_nop 1
    v_max_f32 v8, v8, v9
    v_sub_f32 v144, 0, v8
    v_mov_b32 v145, v144
    v_mov_b32 v146, v144
    v_mov_b32 v147, v144
    v_sub_f32 v112, v112, v8
    v_sub_f32 v113, v113, v8
    v_sub_f32 v114, v114, v8
    v_sub_f32 v115, v115, v8
    v_sub_f32 v116, v116, v8
    v_sub_f32 v117, v117, v8
    v_sub_f32 v118, v118, v8
    v_sub_f32 v119, v119, v8
    v_max3_f32 v8, v120, v121, v122
    v_max3_f32 v8, v8, v123, v124
    v_max3_f32 v8, v8, v125, v126
    v_max_f32 v8, v8, v127
    v_mov_b32 v9, v8
    s_nop 1
    v_permlane16_swap_b32 v8, v9
    s_nop 1
    v_max_f32 v8, v8, v9
    v_mov_b32 v9, v8
    s_nop 1
    v_permlane32_swap_b32 v8, v9
    s_nop 1
    v_max_f32 v8, v8, v9
    v_sub_f32 v148, 0, v8
    v_mov_b32 v149, v148
    v_mov_b32 v150, v148
    v_mov_b32 v151, v148
    v_sub_f32 v120, v120, v8
    v_sub_f32 v121, v121, v8
    v_sub_f32 v122, v122, v8
    v_sub_f32 v123, v123, v8
    v_sub_f32 v124, v124, v8
    v_sub_f32 v125, v125, v8
    v_sub_f32 v126, v126, v8
    v_sub_f32 v127, v127, v8
    s_waitcnt lgkmcnt(0)
    s_barrier
    v_add_u32 v5, s29, v3
    s_add_u32 s29, s29, 8448
    s_cmp_eq_u32 s29, 163584
    s_cselect_b32 s29, 121344, s29
    v_mfma_f32_16x16x32_bf16 v[128:131], v[168:171], v[16:19], v[144:147]
    v_add_u32 v4, s28, v2
    s_add_u32 s28, s28, 8448
    s_cmp_eq_u32 s28, 42240
    s_cselect_b32 s28, 0, s28
    v_exp_f32 v232, v112
    v_exp_f32 v233, v113
    v_mfma_f32_16x16x32_bf16 v[136:139], v[168:171], v[32:35], v[148:151]
    ds_read_b64_tr_b16 v[200:201], v5 offset:0
    ds_read_b64_tr_b16 v[202:203], v5 offset:512
    ds_read_b128 v[168:171], v4 offset:0
    v_mfma_f32_16x16x32_bf16 v[128:131], v[172:175], v[20:23], v[128:131]
    v_exp_f32 v234, v114
    v_mfma_f32_16x16x32_bf16 v[136:139], v[172:175], v[36:39], v[136:139]
    ds_read_b64_tr_b16 v[204:205], v5 offset:32
    ds_read_b64_tr_b16 v[206:207], v5 offset:544
    ds_read_b128 v[172:175], v4 offset:64
    v_mfma_f32_16x16x32_bf16 v[128:131], v[176:179], v[24:27], v[128:131]
    v_exp_f32 v235, v115
    v_cvt_pk_bf16_f32 v152, v232, v233
    v_mfma_f32_16x16x32_bf16 v[136:139], v[176:179], v[40:43], v[136:139]
    ds_read_b64_tr_b16 v[208:209], v5 offset:64
    ds_read_b64_tr_b16 v[210:211], v5 offset:576
    ds_read_b128 v[176:179], v4 offset:128
    v_mfma_f32_16x16x32_bf16 v[128:131], v[180:183], v[28:31], v[128:131]
    v_exp_f32 v232, v116
    v_exp_f32 v233, v117
    v_mfma_f32_16x16x32_bf16 v[136:139], v[180:183], v[44:47], v[136:139]
    ds_read_b64_tr_b16 v[212:213], v5 offset:96
    ds_read_b64_tr_b16 v[214:215], v5 offset:608
    ds_read_b128 v[180:183], v4 offset:192
    v_mfma_f32_16x16x32_bf16 v[132:135], v[184:187], v[16:19], v[144:147]
    v_cvt_pk_bf16_f32 v153, v234, v235
    v_exp_f32 v234, v118
    v_mfma_f32_16x16x32_bf16 v[140:143], v[184:187], v[32:35], v[148:151]
    ds_read_b64_tr_b16 v[216:217], v5 offset:128
    ds_read_b64_tr_b16 v[218:219], v5 offset:640
    ds_read_b128 v[184:187], v4 offset:512
    v_mfma_f32_16x16x32_bf16 v[132:135], v[188:191], v[20:23], v[132:135]
    v_exp_f32 v235, v119
    v_mfma_f32_16x16x32_bf16 v[140:143], v[188:191], v[36:39], v[140:143]
    ds_read_b64_tr_b16 v[220:221], v5 offset:160
    ds_read_b64_tr_b16 v[222:223], v5 offset:672
    ds_read_b128 v[188:191], v4 offset:576
    v_mfma_f32_16x16x32_bf16 v[132:135], v[192:195], v[24:27], v[132:135]
    v_cvt_pk_bf16_f32 v154, v232, v233
    v_exp_f32 v232, v120
    v_mfma_f32_16x16x32_bf16 v[140:143], v[192:195], v[40:43], v[140:143]
    ds_read_b64_tr_b16 v[224:225], v5 offset:192
    ds_read_b64_tr_b16 v[226:227], v5 offset:704
    ds_read_b128 v[192:195], v4 offset:640
    v_mfma_f32_16x16x32_bf16 v[132:135], v[196:199], v[28:31], v[132:135]
    v_exp_f32 v233, v121
    v_cvt_pk_bf16_f32 v155, v234, v235
    v_mfma_f32_16x16x32_bf16 v[140:143], v[196:199], v[44:47], v[140:143]
    ds_read_b64_tr_b16 v[228:229], v5 offset:224
    ds_read_b64_tr_b16 v[230:231], v5 offset:736
    ds_read_b128 v[196:199], v4 offset:704
    v_exp_f32 v234, v122
    v_exp_f32 v235, v123
    v_cvt_pk_bf16_f32 v156, v232, v233
    v_exp_f32 v232, v124
    v_exp_f32 v233, v125
    v_cvt_pk_bf16_f32 v157, v234, v235
    v_exp_f32 v234, v126
    v_exp_f32 v235, v127
    v_cvt_pk_bf16_f32 v158, v232, v233
    v_cvt_pk_bf16_f32 v159, v234, v235
    s_nop 1
    v_mfma_f32_16x16x32_bf16 v[240:243], v[236:239], v[152:155], 0
    v_mfma_f32_16x16x32_bf16 v[244:247], v[236:239], v[156:159], 0
    s_waitcnt lgkmcnt(0)
    s_barrier
    s_nop 5
    v_add_f32 v8, v240, v244
    v_cmp_nge_f32 vcc, s31, v8
    s_cbranch_vccnz Mrare_7
Mback_8:
    v_add_f32 v6, v6, v240
    v_add_f32 v12, v12, v244
    v_mfma_f32_16x16x32_bf16 v[112:115], v[168:171], v[16:19], v[144:147]
    v_add_u32 v5, s29, v3
    s_add_u32 s29, s29, 8448
    s_cmp_eq_u32 s29, 163584
    s_cselect_b32 s29, 121344, s29
    v_add_u32 v4, s28, v2
    s_add_u32 s28, s28, 8448
    s_cmp_eq_u32 s28, 42240
    s_cselect_b32 s28, 0, s28
    v_exp_f32 v232, v128
    v_mfma_f32_16x16x32_bf16 v[120:123], v[168:171], v[32:35], v[148:151]
    ds_read_b128 v[168:171], v4 offset:0
    v_exp_f32 v233, v129
    v_mfma_f32_16x16x32_bf16 v[112:115], v[172:175], v[20:23], v[112:115]
    v_exp_f32 v234, v130
    v_mfma_f32_16x16x32_bf16 v[120:123], v[172:175], v[36:39], v[120:123]
    ds_read_b128 v[172:175], v4 offset:64
    v_mfma_f32_16x16x32_bf16 v[112:115], v[176:179], v[24:27], v[112:115]
    v_exp_f32 v235, v131
    v_mfma_f32_16x16x32_bf16 v[120:123], v[176:179], v[40:43], v[120:123]
    ds_read_b128 v[176:179], v4 offset:128
    v_cvt_pk_bf16_f32 v160, v232, v233
    v_mfma_f32_16x16x32_bf16 v[112:115], v[180:183], v[28:31], v[112:115]
    v_exp_f32 v232, v132
    v_mfma_f32_16x16x32_bf16 v[120:123], v[180:183], v[44:47], v[120:123]
    ds_read_b128 v[180:183], v4 offset:192
    v_exp_f32 v233, v133
    v_mfma_f32_16x16x32_bf16 v[116:119], v[184:187], v[16:19], v[144:147]
    v_cvt_pk_bf16_f32 v161, v234, v235
    v_mfma_f32_16x16x32_bf16 v[124:127], v[184:187], v[32:35], v[148:151]
    ds_read_b128 v[184:187], v4 offset:512
    v_exp_f32 v234, v134
    v_mfma_f32_16x16x32_bf16 v[116:119], v[188:191], v[20:23], v[116:119]
    v_exp_f32 v235, v135
    v_mfma_f32_16x16x32_bf16 v[124:127], v[188:191], v[36:39], v[124:127]
    ds_read_b128 v[188:191], v4 offset:576
    v_mfma_f32_16x16x32_bf16 v[116:119], v[192:195], v[24:27], v[116:119]
    v_cvt_pk_bf16_f32 v162, v232, v233
    v_exp_f32 v232, v136
    v_mfma_f32_16x16x32_bf16 v[124:127], v[192:195], v[40:43], v[124:127]
    ds_read_b128 v[192:195], v4 offset:640
    v_mfma_f32_16x16x32_bf16 v[116:119], v[196:199], v[28:31], v[116:119]
    v_exp_f32 v233, v137
    v_mfma_f32_16x16x32_bf16 v[124:127], v[196:199], v[44:47], v[124:127]
    ds_read_b128 v[196:199], v4 offset:704
    v_cvt_pk_bf16_f32 v163, v234, v235
    v_mfma_f32_16x16x32_bf16 v[48:51], v[200:203], v[152:155], 0
    v_exp_f32 v234, v138
    v_mfma_f32_16x16x32_bf16 v[80:83], v[200:203], v[156:159], 0
    ds_read_b64_tr_b16 v[200:201], v5 offset:0
    ds_read_b64_tr_b16 v[202:203], v5 offset:512
    v_mfma_f32_16x16x32_bf16 v[52:55], v[204:207], v[152:155], 0
    v_exp_f32 v235, v139
    v_mfma_f32_16x16x32_bf16 v[84:87], v[204:207], v[156:159], 0
    ds_read_b64_tr_b16 v[204:205], v5 offset:32
    ds_read_b64_tr_b16 v[206:207], v5 offset:544
    v_mfma_f32_16x16x32_bf16 v[56:59], v[208:211], v[152:155], 0
    v_cvt_pk_bf16_f32 v164, v232, v233
    v_exp_f32 v232, v140
    v_mfma_f32_16x16x32_bf16 v[88:91], v[208:211], v[156:159], 0
    ds_read_b64_tr_b16 v[208:209], v5 offset:64
    ds_read_b64_tr_b16 v[210:211], v5 offset:576
    v_mfma_f32_16x16x32_bf16 v[60:63], v[212:215], v[152:155], 0
    v_exp_f32 v233, v141
    v_mfma_f32_16x16x32_bf16 v[92:95], v[212:215], v[156:159], 0
    ds_read_b64_tr_b16 v[212:213], v5 offset:96
    ds_read_b64_tr_b16 v[214:215], v5 offset:608
    v_mfma_f32_16x16x32_bf16 v[64:67], v[216:219], v[152:155], 0
    v_cvt_pk_bf16_f32 v165, v234, v235
    v_mfma_f32_16x16x32_bf16 v[96:99], v[216:219], v[156:159], 0
    ds_read_b64_tr_b16 v[216:217], v5 offset:128
    ds_read_b64_tr_b16 v[218:219], v5 offset:640
    v_mfma_f32_16x16x32_bf16 v[68:71], v[220:223], v[152:155], 0
    v_exp_f32 v234, v142
    v_mfma_f32_16x16x32_bf16 v[100:103], v[220:223], v[156:159], 0
    ds_read_b64_tr_b16 v[220:221], v5 offset:160
    ds_read_b64_tr_b16 v[222:223], v5 offset:672
    v_mfma_f32_16x16x32_bf16 v[72:75], v[224:227], v[152:155], 0
    v_exp_f32 v235, v143
    v_mfma_f32_16x16x32_bf16 v[104:107], v[224:227], v[156:159], 0
    ds_read_b64_tr_b16 v[224:225], v5 offset:192
    ds_read_b64_tr_b16 v[226:227], v5 offset:704
    v_mfma_f32_16x16x32_bf16 v[76:79], v[228:231], v[152:155], 0
    v_cvt_pk_bf16_f32 v166, v232, v233
    v_cvt_pk_bf16_f32 v167, v234, v235
    v_mfma_f32_16x16x32_bf16 v[108:111], v[228:231], v[156:159], 0
    ds_read_b64_tr_b16 v[228:229], v5 offset:224
    ds_read_b64_tr_b16 v[230:231], v5 offset:736
    s_nop 1
    v_mfma_f32_16x16x32_bf16 v[240:243], v[236:239], v[160:163], 0
    v_mfma_f32_16x16x32_bf16 v[244:247], v[236:239], v[164:167], 0
    s_waitcnt lgkmcnt(0)
    s_barrier
    s_nop 5
    v_add_f32 v8, v240, v244
    v_cmp_nge_f32 vcc, s31, v8
    s_cbranch_vccnz Mrare_9
Mback_10:
    v_add_f32 v6, v6, v240
    v_add_f32 v12, v12, v244
    v_mfma_f32_16x16x32_bf16 v[128:131], v[168:171], v[16:19], v[144:147]
    v_add_u32 v5, s29, v3
    s_add_u32 s29, s29, 8448
    s_cmp_eq_u32 s29, 163584
    s_cselect_b32 s29, 121344, s29
    v_add_u32 v4, s28, v2
    s_add_u32 s28, s28, 8448
    s_cmp_eq_u32 s28, 42240
    s_cselect_b32 s28, 0, s28
    v_exp_f32 v232, v112
    v_mfma_f32_16x16x32_bf16 v[136:139], v[168:171], v[32:35], v[148:151]
    ds_read_b128 v[168:171], v4 offset:0
    v_exp_f32 v233, v113
    v_mfma_f32_16x16x32_bf16 v[128:131], v[172:175], v[20:23], v[128:131]
    v_exp_f32 v234, v114
    v_mfma_f32_16x16x32_bf16 v[136:139], v[172:175], v[36:39], v[136:139]
    ds_read_b128 v[172:175], v4 offset:64
    v_mfma_f32_16x16x32_bf16 v[128:131], v[176:179], v[24:27], v[128:131]
    v_exp_f32 v235, v115
    v_mfma_f32_16x16x32_bf16 v[136:139], v[176:179], v[40:43], v[136:139]
    ds_read_b128 v[176:179], v4 offset:128
    v_cvt_pk_bf16_f32 v152, v232, v233
    v_mfma_f32_16x16x32_bf16 v[128:131], v[180:183], v[28:31], v[128:131]
    v_exp_f32 v232, v116
    v_mfma_f32_16x16x32_bf16 v[136:139], v[180:183], v[44:47], v[136:139]
    ds_read_b128 v[180:183], v4 offset:192
    v_exp_f32 v233, v117
    v_mfma_f32_16x16x32_bf16 v[132:135], v[184:187], v[16:19], v[144:147]
    v_cvt_pk_bf16_f32 v153, v234, v235
    v_mfma_f32_16x16x32_bf16 v[140:143], v[184:187], v[32:35], v[148:151]
    ds_read_b128 v[184:187], v4 offset:512
    v_exp_f32 v234, v118
    v_mfma_f32_16x16x32_bf16 v[132:135], v[188:191], v[20:23], v[132:135]
    v_exp_f32 v235, v119
    v_mfma_f32_16x16x32_bf16 v[140:143], v[188:191], v[36:39], v[140:143]
    ds_read_b128 v[188:191], v4 offset:576
    v_mfma_f32_16x16x32_bf16 v[132:135], v[192:195], v[24:27], v[132:135]
    v_cvt_pk_bf16_f32 v154, v232, v233
    v_exp_f32 v232, v120
    v_mfma_f32_16x16x32_bf16 v[140:143], v[192:195], v[40:43], v[140:143]
    ds_read_b128 v[192:195], v4 offset:640
    v_mfma_f32_16x16x32_bf16 v[132:135], v[196:199], v[28:31], v[132:135]
    v_exp_f32 v233, v121
    v_mfma_f32_16x16x32_bf16 v[140:143], v[196:199], v[44:47], v[140:143]
    ds_read_b128 v[196:199], v4 offset:704
    v_cvt_pk_bf16_f32 v155, v234, v235
    v_mfma_f32_16x16x32_bf16 v[48:51], v[200:203], v[160:163], v[48:51]
    v_exp_f32 v234, v122
    v_mfma_f32_16x16x32_bf16 v[80:83], v[200:203], v[164:167], v[80:83]
    ds_read_b64_tr_b16 v[200:201], v5 offset:0
    ds_read_b64_tr_b16 v[202:203], v5 offset:512
    v_mfma_f32_16x16x32_bf16 v[52:55], v[204:207], v[160:163], v[52:55]
    v_exp_f32 v235, v123
    v_mfma_f32_16x16x32_bf16 v[84:87], v[204:207], v[164:167], v[84:87]
    ds_read_b64_tr_b16 v[204:205], v5 offset:32
    ds_read_b64_tr_b16 v[206:207], v5 offset:544
    v_mfma_f32_16x16x32_bf16 v[56:59], v[208:211], v[160:163], v[56:59]
    v_cvt_pk_bf16_f32 v156, v232, v233
    v_exp_f32 v232, v124
    v_mfma_f32_16x16x32_bf16 v[88:91], v[208:211], v[164:167], v[88:91]
    ds_read_b64_tr_b16 v[208:209], v5 offset:64
    ds_read_b64_tr_b16 v[210:211], v5 offset:576
    v_mfma_f32_16x16x32_bf16 v[60:63], v[212:215], v[160:163], v[60:63]
    v_exp_f32 v233, v125
    v_mfma_f32_16x16x32_bf16 v[92:95], v[212:215], v[164:167], v[92:95]
    ds_read_b64_tr_b16 v[212:213], v5 offset:96
    ds_read_b64_tr_b16 v[214:215], v5 offset:608
    v_mfma_f32_16x16x32_bf16 v[64:67], v[216:219], v[160:163], v[64:67]
    v_cvt_pk_bf16_f32 v157, v234, v235
    v_mfma_f32_16x16x32_bf16 v[96:99], v[216:219], v[164:167], v[96:99]
    ds_read_b64_tr_b16 v[216:217], v5 offset:128
    ds_read_b64_tr_b16 v[218:219], v5 offset:640
    v_mfma_f32_16x16x32_bf16 v[68:71], v[220:223], v[160:163], v[68:71]
    v_exp_f32 v234, v126
    v_mfma_f32_16x16x32_bf16 v[100:103], v[220:223], v[164:167], v[100:103]
    ds_read_b64_tr_b16 v[220:221], v5 offset:160
    ds_read_b64_tr_b16 v[222:223], v5 offset:672
    v_mfma_f32_16x16x32_bf16 v[72:75], v[224:227], v[160:163], v[72:75]
    v_exp_f32 v235, v127
    v_mfma_f32_16x16x32_bf16 v[104:107], v[224:227], v[164:167], v[104:107]
    ds_read_b64_tr_b16 v[224:225], v5 offset:192
    ds_read_b64_tr_b16 v[226:227], v5 offset:704
    v_mfma_f32_16x16x32_bf16 v[76:79], v[228:231], v[160:163], v[76:79]
    v_cvt_pk_bf16_f32 v158, v232, v233
    v_cvt_pk_bf16_f32 v159, v234, v235
    v_mfma_f32_16x16x32_bf16 v[108:111], v[228:231], v[164:167], v[108:111]
    ds_read_b64_tr_b16 v[228:229], v5 offset:224
    ds_read_b64_tr_b16 v[230:231], v5 offset:736
    s_nop 1
    v_mfma_f32_16x16x32_bf16 v[240:243], v[236:239], v[152:155], 0
    v_mfma_f32_16x16x32_bf16 v[244:247], v[236:239], v[156:159], 0
    s_waitcnt lgkmcnt(0)
    s_barrier
    s_mov_b32 s30, 14
    s_mov_b32 s27, 0
M_loop:
    s_nop 5
    v_add_f32 v8, v240, v244
    v_cmp_nge_f32 vcc, s31, v8
    s_cbranch_vccnz Mrare_11
Mback_12:
    v_add_f32 v6, v6, v240
    v_add_f32 v12, v12, v244
    v_mfma_f32_16x16x32_bf16 v[112:115], v[168:171], v[16:19], v[144:147]
    v_add_u32 v5, s29, v3
    s_add_u32 s29, s29, 8448
    s_cmp_eq_u32 s29, 163584
    s_cselect_b32 s29, 121344, s29
    v_add_u32 v4, s28, v2
    s_add_u32 s28, s28, 8448
    s_cmp_eq_u32 s28, 42240
    s_cselect_b32 s28, 0, s28
    v_exp_f32 v232, v128
    v_mfma_f32_16x16x32_bf16 v[120:123], v[168:171], v[32:35], v[148:151]
    ds_read_b128 v[168:171], v4 offset:0
    v_exp_f32 v233, v129
    v_mfma_f32_16x16x32_bf16 v[112:115], v[172:175], v[20:23], v[112:115]
    v_exp_f32 v234, v130
    v_mfma_f32_16x16x32_bf16 v[120:123], v[172:175], v[36:39], v[120:123]
    ds_read_b128 v[172:175], v4 offset:64
    v_mfma_f32_16x16x32_bf16 v[112:115], v[176:179], v[24:27], v[112:115]
    v_exp_f32 v235, v131
    v_mfma_f32_16x16x32_bf16 v[120:123], v[176:179], v[40:43], v[120:123]
    ds_read_b128 v[176:179], v4 offset:128
    v_cvt_pk_bf16_f32 v160, v232, v233
    v_mfma_f32_16x16x32_bf16 v[112:115], v[180:183], v[28:31], v[112:115]
    v_exp_f32 v232, v132
    v_mfma_f32_16x16x32_bf16 v[120:123], v[180:183], v[44:47], v[120:123]
    ds_read_b128 v[180:183], v4 offset:192
    v_exp_f32 v233, v133
    v_mfma_f32_16x16x32_bf16 v[116:119], v[184:187], v[16:19], v[144:147]
    v_cvt_pk_bf16_f32 v161, v234, v235
    v_mfma_f32_16x16x32_bf16 v[124:127], v[184:187], v[32:35], v[148:151]
    ds_read_b128 v[184:187], v4 offset:512
    v_exp_f32 v234, v134
    v_mfma_f32_16x16x32_bf16 v[116:119], v[188:191], v[20:23], v[116:119]
    v_exp_f32 v235, v135
    v_mfma_f32_16x16x32_bf16 v[124:127], v[188:191], v[36:39], v[124:127]
    ds_read_b128 v[188:191], v4 offset:576
    v_mfma_f32_16x16x32_bf16 v[116:119], v[192:195], v[24:27], v[116:119]
    v_cvt_pk_bf16_f32 v162, v232, v233
    v_exp_f32 v232, v136
    v_mfma_f32_16x16x32_bf16 v[124:127], v[192:195], v[40:43], v[124:127]
    ds_read_b128 v[192:195], v4 offset:640
    v_mfma_f32_16x16x32_bf16 v[116:119], v[196:199], v[28:31], v[116:119]
    v_exp_f32 v233, v137
    v_mfma_f32_16x16x32_bf16 v[124:127], v[196:199], v[44:47], v[124:127]
    ds_read_b128 v[196:199], v4 offset:704
    v_cvt_pk_bf16_f32 v163, v234, v235
    v_mfma_f32_16x16x32_bf16 v[48:51], v[200:203], v[152:155], v[48:51]
    v_exp_f32 v234, v138
    v_mfma_f32_16x16x32_bf16 v[80:83], v[200:203], v[156:159], v[80:83]
    ds_read_b64_tr_b16 v[200:201], v5 offset:0
    ds_read_b64_tr_b16 v[202:203], v5 offset:512
    v_mfma_f32_16x16x32_bf16 v[52:55], v[204:207], v[152:155], v[52:55]
    v_exp_f32 v235, v139
    v_mfma_f32_16x16x32_bf16 v[84:87], v[204:207], v[156:159], v[84:87]
    ds_read_b64_tr_b16 v[204:205], v5 offset:32
    ds_read_b64_tr_b16 v[206:207], v5 offset:544
    v_mfma_f32_16x16x32_bf16 v[56:59], v[208:211], v[152:155], v[56:59]
    v_cvt_pk_bf16_f32 v164, v232, v233
    v_exp_f32 v232, v140
    v_mfma_f32_16x16x32_bf16 v[88:91], v[208:211], v[156:159], v[88:91]
    ds_read_b64_tr_b16 v[208:209], v5 offset:64
    ds_read_b64_tr_b16 v[210:211], v5 offset:576
    v_mfma_f32_16x16x32_bf16 v[60:63], v[212:215], v[152:155], v[60:63]
    v_exp_f32 v233, v141
    v_mfma_f32_16x16x32_bf16 v[92:95], v[212:215], v[156:159], v[92:95]
    ds_read_b64_tr_b16 v[212:213], v5 offset:96
    ds_read_b64_tr_b16 v[214:215], v5 offset:608
    v_mfma_f32_16x16x32_bf16 v[64:67], v[216:219], v[152:155], v[64:67]
    v_cvt_pk_bf16_f32 v165, v234, v235
    v_mfma_f32_16x16x32_bf16 v[96:99], v[216:219], v[156:159], v[96:99]
    ds_read_b64_tr_b16 v[216:217], v5 offset:128
    ds_read_b64_tr_b16 v[218:219], v5 offset:640
    v_mfma_f32_16x16x32_bf16 v[68:71], v[220:223], v[152:155], v[68:71]
    v_exp_f32 v234, v142
    v_mfma_f32_16x16x32_bf16 v[100:103], v[220:223], v[156:159], v[100:103]
    ds_read_b64_tr_b16 v[220:221], v5 offset:160
    ds_read_b64_tr_b16 v[222:223], v5 offset:672
    v_mfma_f32_16x16x32_bf16 v[72:75], v[224:227], v[152:155], v[72:75]
    v_exp_f32 v235, v143
    v_mfma_f32_16x16x32_bf16 v[104:107], v[224:227], v[156:159], v[104:107]
    ds_read_b64_tr_b16 v[224:225], v5 offset:192
    ds_read_b64_tr_b16 v[226:227], v5 offset:704
    v_mfma_f32_16x16x32_bf16 v[76:79], v[228:231], v[152:155], v[76:79]
    v_cvt_pk_bf16_f32 v166, v232, v233
    v_cvt_pk_bf16_f32 v167, v234, v235
    v_mfma_f32_16x16x32_bf16 v[108:111], v[228:231], v[156:159], v[108:111]
    ds_read_b64_tr_b16 v[228:229], v5 offset:224
    ds_read_b64_tr_b16 v[230:231], v5 offset:736
    s_nop 1
    v_mfma_f32_16x16x32_bf16 v[240:243], v[236:239], v[160:163], 0
    v_mfma_f32_16x16x32_bf16 v[244:247], v[236:239], v[164:167], 0
    s_waitcnt lgkmcnt(0)
    s_barrier
    s_nop 5
    v_add_f32 v8, v240, v244
    v_cmp_nge_f32 vcc, s31, v8
    s_cbranch_vccnz Mrare_13
Mback_14:
    v_add_f32 v6, v6, v240
    v_add_f32 v12, v12, v244
    v_mfma_f32_16x16x32_bf16 v[128:131], v[168:171], v[16:19], v[144:147]
    v_add_u32 v5, s29, v3
    s_add_u32 s29, s29, 8448
    s_cmp_eq_u32 s29, 163584
    s_cselect_b32 s29, 121344, s29
    v_add_u32 v4, s28, v2
    s_add_u32 s28, s28, 8448
    s_cmp_eq_u32 s28, 42240
    s_cselect_b32 s28, 0, s28
    v_exp_f32 v232, v112
    v_mfma_f32_16x16x32_bf16 v[136:139], v[168:171], v[32:35], v[148:151]
    ds_read_b128 v[168:171], v4 offset:0
    v_exp_f32 v233, v113
    v_mfma_f32_16x16x32_bf16 v[128:131], v[172:175], v[20:23], v[128:131]
    v_exp_f32 v234, v114
    v_mfma_f32_16x16x32_bf16 v[136:139], v[172:175], v[36:39], v[136:139]
    ds_read_b128 v[172:175], v4 offset:64
    v_mfma_f32_16x16x32_bf16 v[128:131], v[176:179], v[24:27], v[128:131]
    v_exp_f32 v235, v115
    v_mfma_f32_16x16x32_bf16 v[136:139], v[176:179], v[40:43], v[136:139]
    ds_read_b128 v[176:179], v4 offset:128
    v_cvt_pk_bf16_f32 v152, v232, v233
    v_mfma_f32_16x16x32_bf16 v[128:131], v[180:183], v[28:31], v[128:131]
    v_exp_f32 v232, v116
    v_mfma_f32_16x16x32_bf16 v[136:139], v[180:183], v[44:47], v[136:139]
    ds_read_b128 v[180:183], v4 offset:192
    v_exp_f32 v233, v117
    v_mfma_f32_16x16x32_bf16 v[132:135], v[184:187], v[16:19], v[144:147]
    v_cvt_pk_bf16_f32 v153, v234, v235
    v_mfma_f32_16x16x32_bf16 v[140:143], v[184:187], v[32:35], v[148:151]
    ds_read_b128 v[184:187], v4 offset:512
    v_exp_f32 v234, v118
    v_mfma_f32_16x16x32_bf16 v[132:135], v[188:191], v[20:23], v[132:135]
    v_exp_f32 v235, v119
    v_mfma_f32_16x16x32_bf16 v[140:143], v[188:191], v[36:39], v[140:143]
    ds_read_b128 v[188:191], v4 offset:576
    v_mfma_f32_16x16x32_bf16 v[132:135], v[192:195], v[24:27], v[132:135]
    v_cvt_pk_bf16_f32 v154, v232, v233
    v_exp_f32 v232, v120
    v_mfma_f32_16x16x32_bf16 v[140:143], v[192:195], v[40:43], v[140:143]
    ds_read_b128 v[192:195], v4 offset:640
    v_mfma_f32_16x16x32_bf16 v[132:135], v[196:199], v[28:31], v[132:135]
    v_exp_f32 v233, v121
    v_mfma_f32_16x16x32_bf16 v[140:143], v[196:199], v[44:47], v[140:143]
    ds_read_b128 v[196:199], v4 offset:704
    v_cvt_pk_bf16_f32 v155, v234, v235
    v_mfma_f32_16x16x32_bf16 v[48:51], v[200:203], v[160:163], v[48:51]
    v_exp_f32 v234, v122
    v_mfma_f32_16x16x32_bf16 v[80:83], v[200:203], v[164:167], v[80:83]
    ds_read_b64_tr_b16 v[200:201], v5 offset:0
    ds_read_b64_tr_b16 v[202:203], v5 offset:512
    v_mfma_f32_16x16x32_bf16 v[52:55], v[204:207], v[160:163], v[52:55]
    v_exp_f32 v235, v123
    v_mfma_f32_16x16x32_bf16 v[84:87], v[204:207], v[164:167], v[84:87]
    ds_read_b64_tr_b16 v[204:205], v5 offset:32
    ds_read_b64_tr_b16 v[206:207], v5 offset:544
    v_mfma_f32_16x16x32_bf16 v[56:59], v[208:211], v[160:163], v[56:59]
    v_cvt_pk_bf16_f32 v156, v232, v233
    v_exp_f32 v232, v124
    v_mfma_f32_16x16x32_bf16 v[88:91], v[208:211], v[164:167], v[88:91]
    ds_read_b64_tr_b16 v[208:209], v5 offset:64
    ds_read_b64_tr_b16 v[210:211], v5 offset:576
    v_mfma_f32_16x16x32_bf16 v[60:63], v[212:215], v[160:163], v[60:63]
    v_exp_f32 v233, v125
    v_mfma_f32_16x16x32_bf16 v[92:95], v[212:215], v[164:167], v[92:95]
    ds_read_b64_tr_b16 v[212:213], v5 offset:96
    ds_read_b64_tr_b16 v[214:215], v5 offset:608
    v_mfma_f32_16x16x32_bf16 v[64:67], v[216:219], v[160:163], v[64:67]
    v_cvt_pk_bf16_f32 v157, v234, v235
    v_mfma_f32_16x16x32_bf16 v[96:99], v[216:219], v[164:167], v[96:99]
    ds_read_b64_tr_b16 v[216:217], v5 offset:128
    ds_read_b64_tr_b16 v[218:219], v5 offset:640
    s_add_u32 s32, s30, s27
    s_cmp_lg_u32 s32, 1
    s_cbranch_scc1 Mq_15
    ds_read_b128 v[16:19], v11 offset:39168
    ds_read_b128 v[20:23], v11 offset:39232
    ds_read_b128 v[24:27], v11 offset:39296
    ds_read_b128 v[28:31], v11 offset:39360
    ds_read_b128 v[32:35], v11 offset:43520
    ds_read_b128 v[36:39], v11 offset:43584
    ds_read_b128 v[40:43], v11 offset:43648
    ds_read_b128 v[44:47], v11 offset:43712
Mq_15:
    v_mfma_f32_16x16x32_bf16 v[68:71], v[220:223], v[160:163], v[68:71]
    v_exp_f32 v234, v126
    v_mfma_f32_16x16x32_bf16 v[100:103], v[220:223], v[164:167], v[100:103]
    ds_read_b64_tr_b16 v[220:221], v5 offset:160
    ds_read_b64_tr_b16 v[222:223], v5 offset:672
    v_mfma_f32_16x16x32_bf16 v[72:75], v[224:227], v[160:163], v[72:75]
    v_exp_f32 v235, v127
    v_mfma_f32_16x16x32_bf16 v[104:107], v[224:227], v[164:167], v[104:107]
    ds_read_b64_tr_b16 v[224:225], v5 offset:192
    ds_read_b64_tr_b16 v[226:227], v5 offset:704
    v_mfma_f32_16x16x32_bf16 v[76:79], v[228:231], v[160:163], v[76:79]
    v_cvt_pk_bf16_f32 v158, v232, v233
    v_cvt_pk_bf16_f32 v159, v234, v235
    v_mfma_f32_16x16x32_bf16 v[108:111], v[228:231], v[164:167], v[108:111]
    ds_read_b64_tr_b16 v[228:229], v5 offset:224
    ds_read_b64_tr_b16 v[230:231], v5 offset:736
    s_nop 1
    v_mfma_f32_16x16x32_bf16 v[240:243], v[236:239], v[152:155], 0
    v_mfma_f32_16x16x32_bf16 v[244:247], v[236:239], v[156:159], 0
    s_waitcnt lgkmcnt(0)
    s_sub_u32 s30, s30, 1
    s_cmp_lg_u32 s30, 0
    s_barrier
    s_cbranch_scc1 M_loop
    s_cmp_lg_u32 s27, 0
    s_cbranch_scc1 M_last
    s_nop 5
    v_add_f32 v8, v240, v244
    v_cmp_nge_f32 vcc, s31, v8
    s_cbranch_vccnz Mrare_16
Mback_17:
    v_add_f32 v6, v6, v240
    v_add_f32 v12, v12, v244
    v_mfma_f32_16x16x32_bf16 v[112:115], v[168:171], v[16:19], 0
    v_add_u32 v5, s29, v3
    s_add_u32 s29, s29, 8448
    s_cmp_eq_u32 s29, 163584
    s_cselect_b32 s29, 121344, s29
    v_add_u32 v4, s28, v2
    s_add_u32 s28, s28, 8448
    s_cmp_eq_u32 s28, 42240
    s_cselect_b32 s28, 0, s28
    v_exp_f32 v232, v128
    v_mfma_f32_16x16x32_bf16 v[120:123], v[168:171], v[32:35], 0
    ds_read_b128 v[168:171], v4 offset:0
    v_exp_f32 v233, v129
    v_mfma_f32_16x16x32_bf16 v[112:115], v[172:175], v[20:23], v[112:115]
    v_exp_f32 v234, v130
    v_mfma_f32_16x16x32_bf16 v[120:123], v[172:175], v[36:39], v[120:123]
    ds_read_b128 v[172:175], v4 offset:64
    v_mfma_f32_16x16x32_bf16 v[112:115], v[176:179], v[24:27], v[112:115]
    v_exp_f32 v235, v131
    v_mfma_f32_16x16x32_bf16 v[120:123], v[176:179], v[40:43], v[120:123]
    ds_read_b128 v[176:179], v4 offset:128
    v_cvt_pk_bf16_f32 v160, v232, v233
    v_mfma_f32_16x16x32_bf16 v[112:115], v[180:183], v[28:31], v[112:115]
    v_exp_f32 v232, v132
    v_mfma_f32_16x16x32_bf16 v[120:123], v[180:183], v[44:47], v[120:123]
    ds_read_b128 v[180:183], v4 offset:192
    v_exp_f32 v233, v133
    v_mfma_f32_16x16x32_bf16 v[116:119], v[184:187], v[16:19], 0
    v_cvt_pk_bf16_f32 v161, v234, v235
    v_mfma_f32_16x16x32_bf16 v[124:127], v[184:187], v[32:35], 0
    ds_read_b128 v[184:187], v4 offset:512
    v_exp_f32 v234, v134
    v_mfma_f32_16x16x32_bf16 v[116:119], v[188:191], v[20:23], v[116:119]
    v_exp_f32 v235, v135
    v_mfma_f32_16x16x32_bf16 v[124:127], v[188:191], v[36:39], v[124:127]
    ds_read_b128 v[188:191], v4 offset:576
    v_mfma_f32_16x16x32_bf16 v[116:119], v[192:195], v[24:27], v[116:119]
    v_cvt_pk_bf16_f32 v162, v232, v233
    v_exp_f32 v232, v136
    v_mfma_f32_16x16x32_bf16 v[124:127], v[192:195], v[40:43], v[124:127]
    ds_read_b128 v[192:195], v4 offset:640
    v_mfma_f32_16x16x32_bf16 v[116:119], v[196:199], v[28:31], v[116:119]
    v_exp_f32 v233, v137
    v_mfma_f32_16x16x32_bf16 v[124:127], v[196:199], v[44:47], v[124:127]
    ds_read_b128 v[196:199], v4 offset:704
    v_cvt_pk_bf16_f32 v163, v234, v235
    v_mfma_f32_16x16x32_bf16 v[48:51], v[200:203], v[152:155], v[48:51]
    v_exp_f32 v234, v138
    v_mfma_f32_16x16x32_bf16 v[80:83], v[200:203], v[156:159], v[80:83]
    ds_read_b64_tr_b16 v[200:201], v5 offset:0
    ds_read_b64_tr_b16 v[202:203], v5 offset:512
    v_mfma_f32_16x16x32_bf16 v[52:55], v[204:207], v[152:155], v[52:55]
    v_exp_f32 v235, v139
    v_mfma_f32_16x16x32_bf16 v[84:87], v[204:207], v[156:159], v[84:87]
    ds_read_b64_tr_b16 v[204:205], v5 offset:32
    ds_read_b64_tr_b16 v[206:207], v5 offset:544
    v_mfma_f32_16x16x32_bf16 v[56:59], v[208:211], v[152:155], v[56:59]
    v_cvt_pk_bf16_f32 v164, v232, v233
    v_exp_f32 v232, v140
    v_mfma_f32_16x16x32_bf16 v[88:91], v[208:211], v[156:159], v[88:91]
    ds_read_b64_tr_b16 v[208:209], v5 offset:64
    ds_read_b64_tr_b16 v[210:211], v5 offset:576
    v_mfma_f32_16x16x32_bf16 v[60:63], v[212:215], v[152:155], v[60:63]
    v_exp_f32 v233, v141
    v_mfma_f32_16x16x32_bf16 v[92:95], v[212:215], v[156:159], v[92:95]
    ds_read_b64_tr_b16 v[212:213], v5 offset:96
    ds_read_b64_tr_b16 v[214:215], v5 offset:608
    v_mfma_f32_16x16x32_bf16 v[64:67], v[216:219], v[152:155], v[64:67]
    v_cvt_pk_bf16_f32 v165, v234, v235
    v_mfma_f32_16x16x32_bf16 v[96:99], v[216:219], v[156:159], v[96:99]
    ds_read_b64_tr_b16 v[216:217], v5 offset:128
    ds_read_b64_tr_b16 v[218:219], v5 offset:640
    v_mfma_f32_16x16x32_bf16 v[68:71], v[220:223], v[152:155], v[68:71]
    v_exp_f32 v234, v142
    v_mfma_f32_16x16x32_bf16 v[100:103], v[220:223], v[156:159], v[100:103]
    ds_read_b64_tr_b16 v[220:221], v5 offset:160
    ds_read_b64_tr_b16 v[222:223], v5 offset:672
    v_mfma_f32_16x16x32_bf16 v[72:75], v[224:227], v[152:155], v[72:75]
    v_exp_f32 v235, v143
    v_mfma_f32_16x16x32_bf16 v[104:107], v[224:227], v[156:159], v[104:107]
    ds_read_b64_tr_b16 v[224:225], v5 offset:192
    ds_read_b64_tr_b16 v[226:227], v5 offset:704
    v_mfma_f32_16x16x32_bf16 v[76:79], v[228:231], v[152:155], v[76:79]
    v_cvt_pk_bf16_f32 v166, v232, v233
    v_cvt_pk_bf16_f32 v167, v234, v235
    v_mfma_f32_16x16x32_bf16 v[108:111], v[228:231], v[156:159], v[108:111]
    ds_read_b64_tr_b16 v[228:229], v5 offset:224
    ds_read_b64_tr_b16 v[230:231], v5 offset:736
    s_nop 1
    v_mfma_f32_16x16x32_bf16 v[240:243], v[236:239], v[160:163], 0
    v_mfma_f32_16x16x32_bf16 v[244:247], v[236:239], v[164:167], 0
    s_waitcnt lgkmcnt(0)
    s_barrier
    s_nop 5
    v_add_f32 v8, v240, v244
    v_cmp_nge_f32 vcc, s31, v8
    s_cbranch_vccnz Mrare_18
Mback_19:
    v_add_f32 v6, v6, v240
    v_add_f32 v12, v12, v244
    v_add_u32 v5, s29, v3
    s_add_u32 s29, s29, 8448
    s_cmp_eq_u32 s29, 163584
    s_cselect_b32 s29, 121344, s29
    v_mov_b32 v1, v6
    v_mov_b32 v6, 0
    v_mov_b32 v14, v12
    v_mov_b32 v12, 0
    v_add_u32 v4, s28, v2
    s_add_u32 s28, s28, 8448
    s_cmp_eq_u32 s28, 42240
    s_cselect_b32 s28, 0, s28
    v_mfma_f32_16x16x32_bf16 v[48:51], v[200:203], v[160:163], v[48:51]
    v_max3_f32 v8, v112, v113, v114
    v_max3_f32 v8, v8, v115, v116
    v_max3_f32 v8, v8, v117, v118
    v_mfma_f32_16x16x32_bf16 v[80:83], v[200:203], v[164:167], v[80:83]
    ds_read_b64_tr_b16 v[200:201], v5 offset:0
    ds_read_b64_tr_b16 v[202:203], v5 offset:512
    v_max_f32 v8, v8, v119
    v_mov_b32 v9, v8
    s_nop 1
    v_permlane16_swap_b32 v8, v9
    s_nop 1
    v_max_f32 v8, v8, v9
    v_mfma_f32_16x16x32_bf16 v[52:55], v[204:207], v[160:163], v[52:55]
    v_mov_b32 v9, v8
    s_nop 1
    v_permlane32_swap_b32 v8, v9
    s_nop 1
    v_max_f32 v8, v8, v9
    v_sub_f32 v144, 0, v8
    v_mfma_f32_16x16x32_bf16 v[84:87], v[204:207], v[164:167], v[84:87]
    ds_read_b64_tr_b16 v[204:205], v5 offset:32
    ds_read_b64_tr_b16 v[206:207], v5 offset:544
    v_mov_b32 v145, v144
    v_mov_b32 v146, v144
    v_mfma_f32_16x16x32_bf16 v[56:59], v[208:211], v[160:163], v[56:59]
    v_mov_b32 v147, v144
    v_sub_f32 v112, v112, v8
    v_sub_f32 v113, v113, v8
    v_mfma_f32_16x16x32_bf16 v[88:91], v[208:211], v[164:167], v[88:91]
    ds_read_b64_tr_b16 v[208:209], v5 offset:64
    ds_read_b64_tr_b16 v[210:211], v5 offset:576
    v_sub_f32 v114, v114, v8
    v_sub_f32 v115, v115, v8
    v_mfma_f32_16x16x32_bf16 v[60:63], v[212:215], v[160:163], v[60:63]
    v_sub_f32 v116, v116, v8
    v_sub_f32 v117, v117, v8
    v_mfma_f32_16x16x32_bf16 v[92:95], v[212:215], v[164:167], v[92:95]
    ds_read_b64_tr_b16 v[212:213], v5 offset:96
    ds_read_b64_tr_b16 v[214:215], v5 offset:608
    v_sub_f32 v118, v118, v8
    v_sub_f32 v119, v119, v8
    v_mfma_f32_16x16x32_bf16 v[64:67], v[216:219], v[160:163], v[64:67]
    v_max3_f32 v8, v120, v121, v122
    v_max3_f32 v8, v8, v123, v124
    v_max3_f32 v8, v8, v125, v126
    v_mfma_f32_16x16x32_bf16 v[96:99], v[216:219], v[164:167], v[96:99]
    ds_read_b64_tr_b16 v[216:217], v5 offset:128
    ds_read_b64_tr_b16 v[218:219], v5 offset:640
    v_max_f32 v8, v8, v127
    v_mov_b32 v9, v8
    s_nop 1
    v_permlane16_swap_b32 v8, v9
    s_nop 1
    v_max_f32 v8, v8, v9
    v_mfma_f32_16x16x32_bf16 v[68:71], v[220:223], v[160:163], v[68:71]
    v_mov_b32 v9, v8
    s_nop 1
    v_permlane32_swap_b32 v8, v9
    s_nop 1
    v_max_f32 v8, v8, v9
    v_sub_f32 v148, 0, v8
    v_mfma_f32_16x16x32_bf16 v[100:103], v[220:223], v[164:167], v[100:103]
    ds_read_b64_tr_b16 v[220:221], v5 offset:160
    ds_read_b64_tr_b16 v[222:223], v5 offset:672
    v_mov_b32 v149, v148
    v_mov_b32 v150, v148
    v_mfma_f32_16x16x32_bf16 v[72:75], v[224:227], v[160:163], v[72:75]
    v_mov_b32 v151, v148
    v_sub_f32 v120, v120, v8
    v_sub_f32 v121, v121, v8
    v_mfma_f32_16x16x32_bf16 v[104:107], v[224:227], v[164:167], v[104:107]
    ds_read_b64_tr_b16 v[224:225], v5 offset:192
    ds_read_b64_tr_b16 v[226:227], v5 offset:704
    v_sub_f32 v122, v122, v8
    v_sub_f32 v123, v123, v8
    v_mfma_f32_16x16x32_bf16 v[76:79], v[228:231], v[160:163], v[76:79]
    v_sub_f32 v124, v124, v8
    v_sub_f32 v125, v125, v8
    v_mfma_f32_16x16x32_bf16 v[108:111], v[228:231], v[164:167], v[108:111]
    ds_read_b64_tr_b16 v[228:229], v5 offset:224
    ds_read_b64_tr_b16 v[230:231], v5 offset:736
    v_sub_f32 v126, v126, v8
    v_sub_f32 v127, v127, v8
    s_nop 1
    v_mfma_f32_16x16x32_bf16 v[128:131], v[168:171], v[16:19], v[144:147]
    v_mfma_f32_16x16x32_bf16 v[136:139], v[168:171], v[32:35], v[148:151]
    ds_read_b128 v[168:171], v4 offset:0
    v_mfma_f32_16x16x32_bf16 v[128:131], v[172:175], v[20:23], v[128:131]
    v_mfma_f32_16x16x32_bf16 v[136:139], v[172:175], v[36:39], v[136:139]
    ds_read_b128 v[172:175], v4 offset:64
    v_mfma_f32_16x16x32_bf16 v[128:131], v[176:179], v[24:27], v[128:131]
    v_mfma_f32_16x16x32_bf16 v[136:139], v[176:179], v[40:43], v[136:139]
    ds_read_b128 v[176:179], v4 offset:128
    v_mfma_f32_16x16x32_bf16 v[128:131], v[180:183], v[28:31], v[128:131]
    v_exp_f32 v232, v112
    v_mfma_f32_16x16x32_bf16 v[136:139], v[180:183], v[44:47], v[136:139]
    ds_read_b128 v[180:183], v4 offset:192
    v_exp_f32 v233, v113
    v_mfma_f32_16x16x32_bf16 v[132:135], v[184:187], v[16:19], v[144:147]
    v_exp_f32 v234, v114
    v_exp_f32 v235, v115
    v_mfma_f32_16x16x32_bf16 v[140:143], v[184:187], v[32:35], v[148:151]
    ds_read_b128 v[184:187], v4 offset:512
    v_cvt_pk_bf16_f32 v152, v232, v233
    v_mfma_f32_16x16x32_bf16 v[132:135], v[188:191], v[20:23], v[132:135]
    v_exp_f32 v232, v116
    v_exp_f32 v233, v117
    v_mfma_f32_16x16x32_bf16 v[140:143], v[188:191], v[36:39], v[140:143]
    ds_read_b128 v[188:191], v4 offset:576
    v_cvt_pk_bf16_f32 v153, v234, v235
    v_mfma_f32_16x16x32_bf16 v[132:135], v[192:195], v[24:27], v[132:135]
    v_exp_f32 v234, v118
    v_exp_f32 v235, v119
    v_mfma_f32_16x16x32_bf16 v[140:143], v[192:195], v[40:43], v[140:143]
    ds_read_b128 v[192:195], v4 offset:640
    v_cvt_pk_bf16_f32 v154, v232, v233
    v_mfma_f32_16x16x32_bf16 v[132:135], v[196:199], v[28:31], v[132:135]
    v_exp_f32 v232, v120
    v_exp_f32 v233, v121
    v_mfma_f32_16x16x32_bf16 v[140:143], v[196:199], v[44:47], v[140:143]
    ds_read_b128 v[196:199], v4 offset:704
    v_cvt_pk_bf16_f32 v155, v234, v235
    v_exp_f32 v234, v122
    v_exp_f32 v235, v123
    v_cvt_pk_bf16_f32 v156, v232, v233
    v_exp_f32 v232, v124
    v_exp_f32 v233, v125
    v_cvt_pk_bf16_f32 v157, v234, v235
    v_exp_f32 v234, v126
    v_exp_f32 v235, v127
    v_cvt_pk_bf16_f32 v158, v232, v233
    v_cvt_pk_bf16_f32 v159, v234, v235
    s_nop 1
    v_mfma_f32_16x16x32_bf16 v[240:243], v[236:239], v[152:155], 0
    v_mfma_f32_16x16x32_bf16 v[244:247], v[236:239], v[156:159], 0
    s_waitcnt lgkmcnt(0)
    s_barrier
    s_nop 5
    v_add_f32 v8, v240, v244
    v_cmp_nge_f32 vcc, s31, v8
    s_cbranch_vccnz Mrare_20
Mback_21:
    v_add_f32 v6, v6, v240
    v_add_f32 v12, v12, v244
    v_mfma_f32_16x16x32_bf16 v[112:115], v[168:171], v[16:19], v[144:147]
    v_add_u32 v5, s29, v3
    s_add_u32 s29, s29, 8448
    s_cmp_eq_u32 s29, 163584
    s_cselect_b32 s29, 121344, s29
    v_add_u32 v4, s28, v2
    s_add_u32 s28, s28, 8448
    s_cmp_eq_u32 s28, 42240
    s_cselect_b32 s28, 0, s28
    v_rcp_f32 v1, v1
    s_nop 0
    v_mul_f32 v48, v48, v1
    v_mul_f32 v49, v49, v1
    v_mul_f32 v50, v50, v1
    v_mul_f32 v51, v51, v1
    v_cvt_pk_bf16_f32 v48, v48, v49
    v_cvt_pk_bf16_f32 v49, v50, v51
    ds_write_b64 v10, v[48:49] offset:0
    v_mfma_f32_16x16x32_bf16 v[120:123], v[168:171], v[32:35], v[148:151]
    ds_read_b128 v[168:171], v4 offset:0
    v_mul_f32 v52, v52, v1
    v_mul_f32 v53, v53, v1
    v_mul_f32 v54, v54, v1
    v_mul_f32 v55, v55, v1
    v_cvt_pk_bf16_f32 v52, v52, v53
    v_cvt_pk_bf16_f32 v53, v54, v55
    ds_write_b64 v10, v[52:53] offset:512
    v_mfma_f32_16x16x32_bf16 v[112:115], v[172:175], v[20:23], v[112:115]
    v_mul_f32 v56, v56, v1
    v_mul_f32 v57, v57, v1
    v_mul_f32 v58, v58, v1
    v_mul_f32 v59, v59, v1
    v_cvt_pk_bf16_f32 v56, v56, v57
    v_cvt_pk_bf16_f32 v57, v58, v59
    ds_write_b64 v10, v[56:57] offset:9216
    v_mfma_f32_16x16x32_bf16 v[120:123], v[172:175], v[36:39], v[120:123]
    ds_read_b128 v[172:175], v4 offset:64
    v_mul_f32 v60, v60, v1
    v_mul_f32 v61, v61, v1
    v_mul_f32 v62, v62, v1
    v_mul_f32 v63, v63, v1
    v_cvt_pk_bf16_f32 v60, v60, v61
    v_cvt_pk_bf16_f32 v61, v62, v63
    ds_write_b64 v10, v[60:61] offset:9728
    v_mfma_f32_16x16x32_bf16 v[112:115], v[176:179], v[24:27], v[112:115]
    v_mul_f32 v64, v64, v1
    v_mul_f32 v65, v65, v1
    v_mul_f32 v66, v66, v1
    v_mul_f32 v67, v67, v1
    v_cvt_pk_bf16_f32 v64, v64, v65
    v_cvt_pk_bf16_f32 v65, v66, v67
    ds_write_b64 v10, v[64:65] offset:18432
    v_mfma_f32_16x16x32_bf16 v[120:123], v[176:179], v[40:43], v[120:123]
    ds_read_b128 v[176:179], v4 offset:128
    v_mul_f32 v68, v68, v1
    v_mul_f32 v69, v69, v1
    v_mul_f32 v70, v70, v1
    v_mul_f32 v71, v71, v1
    v_cvt_pk_bf16_f32 v68, v68, v69
    v_cvt_pk_bf16_f32 v69, v70, v71
    ds_write_b64 v10, v[68:69] offset:18944
    v_mfma_f32_16x16x32_bf16 v[112:115], v[180:183], v[28:31], v[112:115]
    v_mul_f32 v72, v72, v1
    v_mul_f32 v73, v73, v1
    v_mul_f32 v74, v74, v1
    v_mul_f32 v75, v75, v1
    v_cvt_pk_bf16_f32 v72, v72, v73
    v_cvt_pk_bf16_f32 v73, v74, v75
    ds_write_b64 v10, v[72:73] offset:27648
    v_mfma_f32_16x16x32_bf16 v[120:123], v[180:183], v[44:47], v[120:123]
    ds_read_b128 v[180:183], v4 offset:192
    v_mul_f32 v76, v76, v1
    v_mul_f32 v77, v77, v1
    v_mul_f32 v78, v78, v1
    v_mul_f32 v79, v79, v1
    v_cvt_pk_bf16_f32 v76, v76, v77
    v_cvt_pk_bf16_f32 v77, v78, v79
    ds_write_b64 v10, v[76:77] offset:28160
    v_mfma_f32_16x16x32_bf16 v[116:119], v[184:187], v[16:19], v[144:147]
    v_rcp_f32 v14, v14
    s_nop 0
    v_mul_f32 v80, v80, v14
    v_mul_f32 v81, v81, v14
    v_mul_f32 v82, v82, v14
    v_mul_f32 v83, v83, v14
    v_cvt_pk_bf16_f32 v80, v80, v81
    v_cvt_pk_bf16_f32 v81, v82, v83
    ds_write_b64 v10, v[80:81] offset:1024
    v_mfma_f32_16x16x32_bf16 v[124:127], v[184:187], v[32:35], v[148:151]
    ds_read_b128 v[184:187], v4 offset:512
    v_mul_f32 v84, v84, v14
    v_mul_f32 v85, v85, v14
    v_mul_f32 v86, v86, v14
    v_mul_f32 v87, v87, v14
    v_cvt_pk_bf16_f32 v84, v84, v85
    v_cvt_pk_bf16_f32 v85, v86, v87
    ds_write_b64 v10, v[84:85] offset:1536
    v_mfma_f32_16x16x32_bf16 v[116:119], v[188:191], v[20:23], v[116:119]
    v_mul_f32 v88, v88, v14
    v_mul_f32 v89, v89, v14
    v_mul_f32 v90, v90, v14
    v_mul_f32 v91, v91, v14
    v_cvt_pk_bf16_f32 v88, v88, v89
    v_cvt_pk_bf16_f32 v89, v90, v91
    ds_write_b64 v10, v[88:89] offset:10240
    v_mfma_f32_16x16x32_bf16 v[124:127], v[188:191], v[36:39], v[124:127]
    ds_read_b128 v[188:191], v4 offset:576
    v_mul_f32 v92, v92, v14
    v_mul_f32 v93, v93, v14
    v_mul_f32 v94, v94, v14
    v_mul_f32 v95, v95, v14
    v_cvt_pk_bf16_f32 v92, v92, v93
    v_cvt_pk_bf16_f32 v93, v94, v95
    ds_write_b64 v10, v[92:93] offset:10752
    v_mfma_f32_16x16x32_bf16 v[116:119], v[192:195], v[24:27], v[116:119]
    v_mul_f32 v96, v96, v14
    v_mul_f32 v97, v97, v14
    v_mul_f32 v98, v98, v14
    v_mul_f32 v99, v99, v14
    v_cvt_pk_bf16_f32 v96, v96, v97
    v_cvt_pk_bf16_f32 v97, v98, v99
    ds_write_b64 v10, v[96:97] offset:19456
    v_mfma_f32_16x16x32_bf16 v[124:127], v[192:195], v[40:43], v[124:127]
    ds_read_b128 v[192:195], v4 offset:640
    v_mul_f32 v100, v100, v14
    v_mul_f32 v101, v101, v14
    v_mul_f32 v102, v102, v14
    v_mul_f32 v103, v103, v14
    v_cvt_pk_bf16_f32 v100, v100, v101
    v_cvt_pk_bf16_f32 v101, v102, v103
    ds_write_b64 v10, v[100:101] offset:19968
    v_mfma_f32_16x16x32_bf16 v[116:119], v[196:199], v[28:31], v[116:119]
    v_mul_f32 v104, v104, v14
    v_mul_f32 v105, v105, v14
    v_mul_f32 v106, v106, v14
    v_mul_f32 v107, v107, v14
    v_cvt_pk_bf16_f32 v104, v104, v105
    v_cvt_pk_bf16_f32 v105, v106, v107
    ds_write_b64 v10, v[104:105] offset:28672
    v_mfma_f32_16x16x32_bf16 v[124:127], v[196:199], v[44:47], v[124:127]
    ds_read_b128 v[196:199], v4 offset:704
    v_mul_f32 v108, v108, v14
    v_mul_f32 v109, v109, v14
    v_mul_f32 v110, v110, v14
    v_mul_f32 v111, v111, v14
    v_cvt_pk_bf16_f32 v108, v108, v109
    v_cvt_pk_bf16_f32 v109, v110, v111
    ds_write_b64 v10, v[108:109] offset:29184
    v_mfma_f32_16x16x32_bf16 v[48:51], v[200:203], v[152:155], 0
    v_mfma_f32_16x16x32_bf16 v[80:83], v[200:203], v[156:159], 0
    ds_read_b64_tr_b16 v[200:201], v5 offset:0
    ds_read_b64_tr_b16 v[202:203], v5 offset:512
    v_mfma_f32_16x16x32_bf16 v[52:55], v[204:207], v[152:155], 0
    v_exp_f32 v232, v128
    v_mfma_f32_16x16x32_bf16 v[84:87], v[204:207], v[156:159], 0
    ds_read_b64_tr_b16 v[204:205], v5 offset:32
    ds_read_b64_tr_b16 v[206:207], v5 offset:544
    v_exp_f32 v233, v129
    v_mfma_f32_16x16x32_bf16 v[56:59], v[208:211], v[152:155], 0
    v_exp_f32 v234, v130
    v_exp_f32 v235, v131
    v_mfma_f32_16x16x32_bf16 v[88:91], v[208:211], v[156:159], 0
    ds_read_b64_tr_b16 v[208:209], v5 offset:64
    ds_read_b64_tr_b16 v[210:211], v5 offset:576
    v_cvt_pk_bf16_f32 v160, v232, v233
    v_exp_f32 v232, v132
    v_mfma_f32_16x16x32_bf16 v[60:63], v[212:215], v[152:155], 0
    v_exp_f32 v233, v133
    v_cvt_pk_bf16_f32 v161, v234, v235
    v_mfma_f32_16x16x32_bf16 v[92:95], v[212:215], v[156:159], 0
    ds_read_b64_tr_b16 v[212:213], v5 offset:96
    ds_read_b64_tr_b16 v[214:215], v5 offset:608
    v_exp_f32 v234, v134
    v_mfma_f32_16x16x32_bf16 v[64:67], v[216:219], v[152:155], 0
    v_exp_f32 v235, v135
    v_cvt_pk_bf16_f32 v162, v232, v233
    v_exp_f32 v232, v136
    v_mfma_f32_16x16x32_bf16 v[96:99], v[216:219], v[156:159], 0
    ds_read_b64_tr_b16 v[216:217], v5 offset:128
    ds_read_b64_tr_b16 v[218:219], v5 offset:640
    v_exp_f32 v233, v137
    v_mfma_f32_16x16x32_bf16 v[68:71], v[220:223], v[152:155], 0
    v_cvt_pk_bf16_f32 v163, v234, v235
    v_exp_f32 v234, v138
    v_mfma_f32_16x16x32_bf16 v[100:103], v[220:223], v[156:159], 0
    ds_read_b64_tr_b16 v[220:221], v5 offset:160
    ds_read_b64_tr_b16 v[222:223], v5 offset:672
    v_exp_f32 v235, v139
    v_mfma_f32_16x16x32_bf16 v[72:75], v[224:227], v[152:155], 0
    v_cvt_pk_bf16_f32 v164, v232, v233
    v_exp_f32 v232, v140
    v_exp_f32 v233, v141
    v_mfma_f32_16x16x32_bf16 v[104:107], v[224:227], v[156:159], 0
    ds_read_b64_tr_b16 v[224:225], v5 offset:192
    ds_read_b64_tr_b16 v[226:227], v5 offset:704
    v_cvt_pk_bf16_f32 v165, v234, v235
    v_mfma_f32_16x16x32_bf16 v[76:79], v[228:231], v[152:155], 0
    v_exp_f32 v234, v142
    v_exp_f32 v235, v143
    v_mfma_f32_16x16x32_bf16 v[108:111], v[228:231], v[156:159], 0
    ds_read_b64_tr_b16 v[228:229], v5 offset:224
    ds_read_b64_tr_b16 v[230:231], v5 offset:736
    v_cvt_pk_bf16_f32 v166, v232, v233
    v_cvt_pk_bf16_f32 v167, v234, v235
    s_nop 1
    v_mfma_f32_16x16x32_bf16 v[240:243], v[236:239], v[160:163], 0
    v_mfma_f32_16x16x32_bf16 v[244:247], v[236:239], v[164:167], 0
    s_waitcnt lgkmcnt(0)
    s_barrier
    s_nop 5
    v_add_f32 v8, v240, v244
    v_cmp_nge_f32 vcc, s31, v8
    s_cbranch_vccnz Mrare_22
Mback_23:
    v_add_f32 v6, v6, v240
    v_add_f32 v12, v12, v244
    v_mfma_f32_16x16x32_bf16 v[128:131], v[168:171], v[16:19], v[144:147]
    v_add_u32 v5, s29, v3
    s_add_u32 s29, s29, 8448
    s_cmp_eq_u32 s29, 163584
    s_cselect_b32 s29, 121344, s29
    v_add_u32 v4, s28, v2
    s_add_u32 s28, s28, 8448
    s_cmp_eq_u32 s28, 42240
    s_cselect_b32 s28, 0, s28
    v_exp_f32 v232, v112
    v_mfma_f32_16x16x32_bf16 v[136:139], v[168:171], v[32:35], v[148:151]
    ds_read_b128 v[168:171], v4 offset:0
    v_exp_f32 v233, v113
    v_mfma_f32_16x16x32_bf16 v[128:131], v[172:175], v[20:23], v[128:131]
    v_exp_f32 v234, v114
    v_mfma_f32_16x16x32_bf16 v[136:139], v[172:175], v[36:39], v[136:139]
    ds_read_b128 v[172:175], v4 offset:64
    v_mfma_f32_16x16x32_bf16 v[128:131], v[176:179], v[24:27], v[128:131]
    v_exp_f32 v235, v115
    v_mfma_f32_16x16x32_bf16 v[136:139], v[176:179], v[40:43], v[136:139]
    ds_read_b128 v[176:179], v4 offset:128
    v_cvt_pk_bf16_f32 v152, v232, v233
    v_mfma_f32_16x16x32_bf16 v[128:131], v[180:183], v[28:31], v[128:131]
    v_exp_f32 v232, v116
    v_mfma_f32_16x16x32_bf16 v[136:139], v[180:183], v[44:47], v[136:139]
    ds_read_b128 v[180:183], v4 offset:192
    v_exp_f32 v233, v117
    v_mfma_f32_16x16x32_bf16 v[132:135], v[184:187], v[16:19], v[144:147]
    v_cvt_pk_bf16_f32 v153, v234, v235
    v_mfma_f32_16x16x32_bf16 v[140:143], v[184:187], v[32:35], v[148:151]
    ds_read_b128 v[184:187], v4 offset:512
    v_exp_f32 v234, v118
    v_mfma_f32_16x16x32_bf16 v[132:135], v[188:191], v[20:23], v[132:135]
    v_exp_f32 v235, v119
    v_mfma_f32_16x16x32_bf16 v[140:143], v[188:191], v[36:39], v[140:143]
    ds_read_b128 v[188:191], v4 offset:576
    v_mfma_f32_16x16x32_bf16 v[132:135], v[192:195], v[24:27], v[132:135]
    v_cvt_pk_bf16_f32 v154, v232, v233
    v_exp_f32 v232, v120
    v_mfma_f32_16x16x32_bf16 v[140:143], v[192:195], v[40:43], v[140:143]
    ds_read_b128 v[192:195], v4 offset:640
    v_mfma_f32_16x16x32_bf16 v[132:135], v[196:199], v[28:31], v[132:135]
    v_exp_f32 v233, v121
    v_mfma_f32_16x16x32_bf16 v[140:143], v[196:199], v[44:47], v[140:143]
    ds_read_b128 v[196:199], v4 offset:704
    v_cvt_pk_bf16_f32 v155, v234, v235
    v_mfma_f32_16x16x32_bf16 v[48:51], v[200:203], v[160:163], v[48:51]
    v_exp_f32 v234, v122
    v_mfma_f32_16x16x32_bf16 v[80:83], v[200:203], v[164:167], v[80:83]
    ds_read_b64_tr_b16 v[200:201], v5 offset:0
    ds_read_b64_tr_b16 v[202:203], v5 offset:512
    v_mfma_f32_16x16x32_bf16 v[52:55], v[204:207], v[160:163], v[52:55]
    v_exp_f32 v235, v123
    v_mfma_f32_16x16x32_bf16 v[84:87], v[204:207], v[164:167], v[84:87]
    ds_read_b64_tr_b16 v[204:205], v5 offset:32
    ds_read_b64_tr_b16 v[206:207], v5 offset:544
    v_mfma_f32_16x16x32_bf16 v[56:59], v[208:211], v[160:163], v[56:59]
    v_cvt_pk_bf16_f32 v156, v232, v233
    v_exp_f32 v232, v124
    v_mfma_f32_16x16x32_bf16 v[88:91], v[208:211], v[164:167], v[88:91]
    ds_read_b64_tr_b16 v[208:209], v5 offset:64
    ds_read_b64_tr_b16 v[210:211], v5 offset:576
    v_mfma_f32_16x16x32_bf16 v[60:63], v[212:215], v[160:163], v[60:63]
    v_exp_f32 v233, v125
    v_mfma_f32_16x16x32_bf16 v[92:95], v[212:215], v[164:167], v[92:95]
    ds_read_b64_tr_b16 v[212:213], v5 offset:96
    ds_read_b64_tr_b16 v[214:215], v5 offset:608
    v_mfma_f32_16x16x32_bf16 v[64:67], v[216:219], v[160:163], v[64:67]
    v_cvt_pk_bf16_f32 v157, v234, v235
    v_mfma_f32_16x16x32_bf16 v[96:99], v[216:219], v[164:167], v[96:99]
    ds_read_b64_tr_b16 v[216:217], v5 offset:128
    ds_read_b64_tr_b16 v[218:219], v5 offset:640
    v_mfma_f32_16x16x32_bf16 v[68:71], v[220:223], v[160:163], v[68:71]
    v_exp_f32 v234, v126
    v_mfma_f32_16x16x32_bf16 v[100:103], v[220:223], v[164:167], v[100:103]
    ds_read_b64_tr_b16 v[220:221], v5 offset:160
    ds_read_b64_tr_b16 v[222:223], v5 offset:672
    v_mfma_f32_16x16x32_bf16 v[72:75], v[224:227], v[160:163], v[72:75]
    v_exp_f32 v235, v127
    v_mfma_f32_16x16x32_bf16 v[104:107], v[224:227], v[164:167], v[104:107]
    ds_read_b64_tr_b16 v[224:225], v5 offset:192
    ds_read_b64_tr_b16 v[226:227], v5 offset:704
    v_mfma_f32_16x16x32_bf16 v[76:79], v[228:231], v[160:163], v[76:79]
    v_cvt_pk_bf16_f32 v158, v232, v233
    v_cvt_pk_bf16_f32 v159, v234, v235
    v_mfma_f32_16x16x32_bf16 v[108:111], v[228:231], v[164:167], v[108:111]
    ds_read_b64_tr_b16 v[228:229], v5 offset:224
    ds_read_b64_tr_b16 v[230:231], v5 offset:736
    s_nop 1
    v_mfma_f32_16x16x32_bf16 v[240:243], v[236:239], v[152:155], 0
    v_mfma_f32_16x16x32_bf16 v[244:247], v[236:239], v[156:159], 0
    s_waitcnt lgkmcnt(0)
    s_barrier
    s_mov_b32 s30, 14
    s_mov_b32 s27, 100
    s_branch M_loop
M_last:
    s_nop 5
    v_add_f32 v8, v240, v244
    v_cmp_nge_f32 vcc, s31, v8
    s_cbranch_vccnz Mrare_24
Mback_25:
    v_add_f32 v6, v6, v240
    v_add_f32 v12, v12, v244
    v_add_u32 v5, s29, v3
    s_add_u32 s29, s29, 8448
    s_cmp_eq_u32 s29, 163584
    s_cselect_b32 s29, 121344, s29
    v_mfma_f32_16x16x32_bf16 v[48:51], v[200:203], v[152:155], v[48:51]
    v_exp_f32 v232, v128
    v_mfma_f32_16x16x32_bf16 v[80:83], v[200:203], v[156:159], v[80:83]
    ds_read_b64_tr_b16 v[200:201], v5 offset:0
    ds_read_b64_tr_b16 v[202:203], v5 offset:512
    v_exp_f32 v233, v129
    v_mfma_f32_16x16x32_bf16 v[52:55], v[204:207], v[152:155], v[52:55]
    v_exp_f32 v234, v130
    v_mfma_f32_16x16x32_bf16 v[84:87], v[204:207], v[156:159], v[84:87]
    ds_read_b64_tr_b16 v[204:205], v5 offset:32
    ds_read_b64_tr_b16 v[206:207], v5 offset:544
    v_mfma_f32_16x16x32_bf16 v[56:59], v[208:211], v[152:155], v[56:59]
    v_exp_f32 v235, v131
    v_cvt_pk_bf16_f32 v160, v232, v233
    v_mfma_f32_16x16x32_bf16 v[88:91], v[208:211], v[156:159], v[88:91]
    ds_read_b64_tr_b16 v[208:209], v5 offset:64
    ds_read_b64_tr_b16 v[210:211], v5 offset:576
    v_mfma_f32_16x16x32_bf16 v[60:63], v[212:215], v[152:155], v[60:63]
    v_exp_f32 v232, v132
    v_mfma_f32_16x16x32_bf16 v[92:95], v[212:215], v[156:159], v[92:95]
    ds_read_b64_tr_b16 v[212:213], v5 offset:96
    ds_read_b64_tr_b16 v[214:215], v5 offset:608
    v_exp_f32 v233, v133
    v_mfma_f32_16x16x32_bf16 v[64:67], v[216:219], v[152:155], v[64:67]
    v_cvt_pk_bf16_f32 v161, v234, v235
    v_mfma_f32_16x16x32_bf16 v[96:99], v[216:219], v[156:159], v[96:99]
    ds_read_b64_tr_b16 v[216:217], v5 offset:128
    ds_read_b64_tr_b16 v[218:219], v5 offset:640
    v_exp_f32 v234, v134
    v_mfma_f32_16x16x32_bf16 v[68:71], v[220:223], v[152:155], v[68:71]
    v_exp_f32 v235, v135
    v_mfma_f32_16x16x32_bf16 v[100:103], v[220:223], v[156:159], v[100:103]
    ds_read_b64_tr_b16 v[220:221], v5 offset:160
    ds_read_b64_tr_b16 v[222:223], v5 offset:672
    v_mfma_f32_16x16x32_bf16 v[72:75], v[224:227], v[152:155], v[72:75]
    v_cvt_pk_bf16_f32 v162, v232, v233
    v_exp_f32 v232, v136
    v_mfma_f32_16x16x32_bf16 v[104:107], v[224:227], v[156:159], v[104:107]
    ds_read_b64_tr_b16 v[224:225], v5 offset:192
    ds_read_b64_tr_b16 v[226:227], v5 offset:704
    v_mfma_f32_16x16x32_bf16 v[76:79], v[228:231], v[152:155], v[76:79]
    v_exp_f32 v233, v137
    v_cvt_pk_bf16_f32 v163, v234, v235
    v_mfma_f32_16x16x32_bf16 v[108:111], v[228:231], v[156:159], v[108:111]
    ds_read_b64_tr_b16 v[228:229], v5 offset:224
    ds_read_b64_tr_b16 v[230:231], v5 offset:736
    v_exp_f32 v234, v138
    v_exp_f32 v235, v139
    v_cvt_pk_bf16_f32 v164, v232, v233
    v_exp_f32 v232, v140
    v_exp_f32 v233, v141
    v_cvt_pk_bf16_f32 v165, v234, v235
    v_exp_f32 v234, v142
    v_exp_f32 v235, v143
    v_cvt_pk_bf16_f32 v166, v232, v233
    v_cvt_pk_bf16_f32 v167, v234, v235
    s_nop 1
    v_mfma_f32_16x16x32_bf16 v[240:243], v[236:239], v[160:163], 0
    v_mfma_f32_16x16x32_bf16 v[244:247], v[236:239], v[164:167], 0
    s_waitcnt lgkmcnt(0)
    s_and_b32 s44, s3, 3
    s_lshr_b32 s45, s3, 2
    s_mul_i32 s58, s45, 18432
    s_add_u32 s55, s69, s56
    s_mov_b32 s13, 0
    s_lshl_b32 s47, s71, 4
    s_mul_i32 s32, s70, 6
    s_lshl_b32 s33, s44, 1
    s_add_u32 s32, s32, s33
    s_add_u32 s32, s32, 0
    s_mul_i32 s74, s32, 40960
    s_mul_i32 s33, s32, 57
    s_lshr_b32 s33, s33, 9
    s_mul_i32 s34, s33, 9
    s_sub_u32 s32, s32, s34
    s_lshl_b32 s32, s32, 10
    s_lshl_b32 s34, s26, 3
    s_add_u32 s33, s33, s34
    s_mul_i32 s34, s33, 1179648
    s_add_u32 s32, s32, s34
    v_lshl_add_u32 v2, v0, 4, s32
    s_lshl_b32 s72, s33, 9
    s_mul_i32 s32, s70, 6
    s_lshl_b32 s33, s44, 1
    s_add_u32 s32, s32, s33
    s_add_u32 s32, s32, 1
    s_mul_i32 s75, s32, 40960
    s_mul_i32 s33, s32, 57
    s_lshr_b32 s33, s33, 9
    s_mul_i32 s34, s33, 9
    s_sub_u32 s32, s32, s34
    s_lshl_b32 s32, s32, 10
    s_lshl_b32 s34, s26, 3
    s_add_u32 s33, s33, s34
    s_mul_i32 s34, s33, 1179648
    s_add_u32 s32, s32, s34
    v_lshl_add_u32 v3, v0, 4, s32
    s_lshl_b32 s73, s33, 9
    s_cmp_ge_u32 s2, 240
    s_cbranch_scc1 EB_26
    s_cmp_eq_u32 s3, 3
    s_cbranch_scc1 EB_26
    s_add_u32 s32, s13, s55
    s_and_b32 s32, s32, 7
    s_lshl_b32 s32, s32, 1
    s_lshr_b32 s33, s13, 3
    s_add_u32 s32, s32, s33
    s_add_u32 s32, s32, s47
    s_mul_i32 s53, s32, 36864
    s_add_u32 s53, s53, s58
    s_add_u32 s13, s13, 1
    s_add_u32 s32, s53, 9216
    buffer_load_dwordx4 v[168:171], v2, s[20:23], s53 offen sc1
    buffer_load_dwordx4 v[172:175], v3, s[20:23], s53 offen sc1
    buffer_load_dwordx4 v[176:179], v2, s[20:23], s32 offen sc1
    buffer_load_dwordx4 v[180:183], v3, s[20:23], s32 offen sc1
    s_add_u32 s32, s13, s55
    s_and_b32 s32, s32, 7
    s_lshl_b32 s32, s32, 1
    s_lshr_b32 s33, s13, 3
    s_add_u32 s32, s32, s33
    s_add_u32 s32, s32, s47
    s_mul_i32 s53, s32, 36864
    s_add_u32 s53, s53, s58
    s_add_u32 s13, s13, 1
    s_add_u32 s32, s53, 9216
    buffer_load_dwordx4 v[184:187], v2, s[20:23], s53 offen sc1
    buffer_load_dwordx4 v[188:191], v3, s[20:23], s53 offen sc1
    buffer_load_dwordx4 v[192:195], v2, s[20:23], s32 offen sc1
    buffer_load_dwordx4 v[196:199], v3, s[20:23], s32 offen sc1
EB_26:
    v_subrev_u32 v10, 42240, v10
    s_barrier
    s_nop 5
    v_add_f32 v8, v240, v244
    v_cmp_nge_f32 vcc, s31, v8
    s_cbranch_vccnz Mrare_27
Mback_28:
    v_add_f32 v6, v6, v240
    v_add_f32 v12, v12, v244
    v_mfma_f32_16x16x32_bf16 v[48:51], v[200:203], v[160:163], v[48:51]
    v_mfma_f32_16x16x32_bf16 v[80:83], v[200:203], v[164:167], v[80:83]
    v_mfma_f32_16x16x32_bf16 v[52:55], v[204:207], v[160:163], v[52:55]
    v_mfma_f32_16x16x32_bf16 v[84:87], v[204:207], v[164:167], v[84:87]
    v_mfma_f32_16x16x32_bf16 v[56:59], v[208:211], v[160:163], v[56:59]
    v_mfma_f32_16x16x32_bf16 v[88:91], v[208:211], v[164:167], v[88:91]
    v_mfma_f32_16x16x32_bf16 v[60:63], v[212:215], v[160:163], v[60:63]
    v_mfma_f32_16x16x32_bf16 v[92:95], v[212:215], v[164:167], v[92:95]
    v_mfma_f32_16x16x32_bf16 v[64:67], v[216:219], v[160:163], v[64:67]
    v_mfma_f32_16x16x32_bf16 v[96:99], v[216:219], v[164:167], v[96:99]
    v_mfma_f32_16x16x32_bf16 v[68:71], v[220:223], v[160:163], v[68:71]
    v_mfma_f32_16x16x32_bf16 v[100:103], v[220:223], v[164:167], v[100:103]
    v_mfma_f32_16x16x32_bf16 v[72:75], v[224:227], v[160:163], v[72:75]
    v_mfma_f32_16x16x32_bf16 v[104:107], v[224:227], v[164:167], v[104:107]
    v_mfma_f32_16x16x32_bf16 v[76:79], v[228:231], v[160:163], v[76:79]
    v_mfma_f32_16x16x32_bf16 v[108:111], v[228:231], v[164:167], v[108:111]
    s_nop 15
    v_rcp_f32 v6, v6
    s_nop 0
    v_mul_f32 v48, v48, v6
    v_mul_f32 v49, v49, v6
    v_mul_f32 v50, v50, v6
    v_mul_f32 v51, v51, v6
    v_cvt_pk_bf16_f32 v48, v48, v49
    v_cvt_pk_bf16_f32 v49, v50, v51
    ds_write_b64 v10, v[48:49] offset:0
    v_mul_f32 v52, v52, v6
    v_mul_f32 v53, v53, v6
    v_mul_f32 v54, v54, v6
    v_mul_f32 v55, v55, v6
    v_cvt_pk_bf16_f32 v52, v52, v53
    v_cvt_pk_bf16_f32 v53, v54, v55
    ds_write_b64 v10, v[52:53] offset:512
    v_mul_f32 v56, v56, v6
    v_mul_f32 v57, v57, v6
    v_mul_f32 v58, v58, v6
    v_mul_f32 v59, v59, v6
    v_cvt_pk_bf16_f32 v56, v56, v57
    v_cvt_pk_bf16_f32 v57, v58, v59
    ds_write_b64 v10, v[56:57] offset:9216
    v_mul_f32 v60, v60, v6
    v_mul_f32 v61, v61, v6
    v_mul_f32 v62, v62, v6
    v_mul_f32 v63, v63, v6
    v_cvt_pk_bf16_f32 v60, v60, v61
    v_cvt_pk_bf16_f32 v61, v62, v63
    ds_write_b64 v10, v[60:61] offset:9728
    v_mul_f32 v64, v64, v6
    v_mul_f32 v65, v65, v6
    v_mul_f32 v66, v66, v6
    v_mul_f32 v67, v67, v6
    v_cvt_pk_bf16_f32 v64, v64, v65
    v_cvt_pk_bf16_f32 v65, v66, v67
    ds_write_b64 v10, v[64:65] offset:18432
    v_mul_f32 v68, v68, v6
    v_mul_f32 v69, v69, v6
    v_mul_f32 v70, v70, v6
    v_mul_f32 v71, v71, v6
    v_cvt_pk_bf16_f32 v68, v68, v69
    v_cvt_pk_bf16_f32 v69, v70, v71
    ds_write_b64 v10, v[68:69] offset:18944
    v_mul_f32 v72, v72, v6
    v_mul_f32 v73, v73, v6
    v_mul_f32 v74, v74, v6
    v_mul_f32 v75, v75, v6
    v_cvt_pk_bf16_f32 v72, v72, v73
    v_cvt_pk_bf16_f32 v73, v74, v75
    ds_write_b64 v10, v[72:73] offset:27648
    v_mul_f32 v76, v76, v6
    v_mul_f32 v77, v77, v6
    v_mul_f32 v78, v78, v6
    v_mul_f32 v79, v79, v6
    v_cvt_pk_bf16_f32 v76, v76, v77
    v_cvt_pk_bf16_f32 v77, v78, v79
    ds_write_b64 v10, v[76:77] offset:28160
    v_rcp_f32 v12, v12
    s_nop 0
    v_mul_f32 v80, v80, v12
    v_mul_f32 v81, v81, v12
    v_mul_f32 v82, v82, v12
    v_mul_f32 v83, v83, v12
    v_cvt_pk_bf16_f32 v80, v80, v81
    v_cvt_pk_bf16_f32 v81, v82, v83
    ds_write_b64 v10, v[80:81] offset:1024
    v_mul_f32 v84, v84, v12
    v_mul_f32 v85, v85, v12
    v_mul_f32 v86, v86, v12
    v_mul_f32 v87, v87, v12
    v_cvt_pk_bf16_f32 v84, v84, v85
    v_cvt_pk_bf16_f32 v85, v86, v87
    ds_write_b64 v10, v[84:85] offset:1536
    v_mul_f32 v88, v88, v12
    v_mul_f32 v89, v89, v12
    v_mul_f32 v90, v90, v12
    v_mul_f32 v91, v91, v12
    v_cvt_pk_bf16_f32 v88, v88, v89
    v_cvt_pk_bf16_f32 v89, v90, v91
    ds_write_b64 v10, v[88:89] offset:10240
    v_mul_f32 v92, v92, v12
    v_mul_f32 v93, v93, v12
    v_mul_f32 v94, v94, v12
    v_mul_f32 v95, v95, v12
    v_cvt_pk_bf16_f32 v92, v92, v93
    v_cvt_pk_bf16_f32 v93, v94, v95
    ds_write_b64 v10, v[92:93] offset:10752
    v_mul_f32 v96, v96, v12
    v_mul_f32 v97, v97, v12
    v_mul_f32 v98, v98, v12
    v_mul_f32 v99, v99, v12
    v_cvt_pk_bf16_f32 v96, v96, v97
    v_cvt_pk_bf16_f32 v97, v98, v99
    ds_write_b64 v10, v[96:97] offset:19456
    v_mul_f32 v100, v100, v12
    v_mul_f32 v101, v101, v12
    v_mul_f32 v102, v102, v12
    v_mul_f32 v103, v103, v12
    v_cvt_pk_bf16_f32 v100, v100, v101
    v_cvt_pk_bf16_f32 v101, v102, v103
    ds_write_b64 v10, v[100:101] offset:19968
    v_mul_f32 v104, v104, v12
    v_mul_f32 v105, v105, v12
    v_mul_f32 v106, v106, v12
    v_mul_f32 v107, v107, v12
    v_cvt_pk_bf16_f32 v104, v104, v105
    v_cvt_pk_bf16_f32 v105, v106, v107
    ds_write_b64 v10, v[104:105] offset:28672
    v_mul_f32 v108, v108, v12
    v_mul_f32 v109, v109, v12
    v_mul_f32 v110, v110, v12
    v_mul_f32 v111, v111, v12
    v_cvt_pk_bf16_f32 v108, v108, v109
    v_cvt_pk_bf16_f32 v109, v110, v111
    ds_write_b64 v10, v[108:109] offset:29184
    s_waitcnt lgkmcnt(0)
    s_setprio 0
    s_branch L_tail
Mrare_7:
    s_nop 15
    s_nop 7
    v_max3_f32 v8, v112, v113, v114
    v_max3_f32 v8, v8, v115, v116
    v_max3_f32 v8, v8, v117, v118
    v_max_f32 v8, v8, v119
    v_mov_b32 v9, v8
    s_nop 1
    v_permlane16_swap_b32 v8, v9
    s_nop 1
    v_max_f32 v8, v8, v9
    v_mov_b32 v9, v8
    s_nop 1
    v_permlane32_swap_b32 v8, v9
    s_nop 1
    v_max_f32 v8, v8, v9
    v_max_f32 v8, 0, v8
    v_sub_f32 v9, 0, v8
    v_exp_f32 v9, v9
    s_nop 0
    v_mul_f32 v6, v6, v9
    v_sub_f32 v144, v144, v8
    v_sub_f32 v145, v145, v8
    v_sub_f32 v146, v146, v8
    v_sub_f32 v147, v147, v8
    v_sub_f32 v112, v112, v8
    v_sub_f32 v113, v113, v8
    v_sub_f32 v114, v114, v8
    v_sub_f32 v115, v115, v8
    v_sub_f32 v116, v116, v8
    v_sub_f32 v117, v117, v8
    v_sub_f32 v118, v118, v8
    v_sub_f32 v119, v119, v8
    v_sub_f32 v128, v128, v8
    v_sub_f32 v129, v129, v8
    v_sub_f32 v130, v130, v8
    v_sub_f32 v131, v131, v8
    v_sub_f32 v132, v132, v8
    v_sub_f32 v133, v133, v8
    v_sub_f32 v134, v134, v8
    v_sub_f32 v135, v135, v8
    v_max3_f32 v8, v120, v121, v122
    v_max3_f32 v8, v8, v123, v124
    v_max3_f32 v8, v8, v125, v126
    v_max_f32 v8, v8, v127
    v_mov_b32 v9, v8
    s_nop 1
    v_permlane16_swap_b32 v8, v9
    s_nop 1
    v_max_f32 v8, v8, v9
    v_mov_b32 v9, v8
    s_nop 1
    v_permlane32_swap_b32 v8, v9
    s_nop 1
    v_max_f32 v8, v8, v9
    v_max_f32 v8, 0, v8
    v_sub_f32 v9, 0, v8
    v_exp_f32 v9, v9
    s_nop 0
    v_mul_f32 v12, v12, v9
    v_sub_f32 v148, v148, v8
    v_sub_f32 v149, v149, v8
    v_sub_f32 v150, v150, v8
    v_sub_f32 v151, v151, v8
    v_sub_f32 v120, v120, v8
    v_sub_f32 v121, v121, v8
    v_sub_f32 v122, v122, v8
    v_sub_f32 v123, v123, v8
    v_sub_f32 v124, v124, v8
    v_sub_f32 v125, v125, v8
    v_sub_f32 v126, v126, v8
    v_sub_f32 v127, v127, v8
    v_sub_f32 v136, v136, v8
    v_sub_f32 v137, v137, v8
    v_sub_f32 v138, v138, v8
    v_sub_f32 v139, v139, v8
    v_sub_f32 v140, v140, v8
    v_sub_f32 v141, v141, v8
    v_sub_f32 v142, v142, v8
    v_sub_f32 v143, v143, v8
    v_exp_f32 v232, v112
    s_nop 0
    v_exp_f32 v233, v113
    s_nop 0
    v_exp_f32 v234, v114
    s_nop 0
    v_exp_f32 v235, v115
    s_nop 0
    v_cvt_pk_bf16_f32 v152, v232, v233
    v_exp_f32 v232, v116
    s_nop 0
    v_exp_f32 v233, v117
    s_nop 0
    v_cvt_pk_bf16_f32 v153, v234, v235
    v_exp_f32 v234, v118
    s_nop 0
    v_exp_f32 v235, v119
    s_nop 0
    v_cvt_pk_bf16_f32 v154, v232, v233
    v_exp_f32 v232, v120
    s_nop 0
    v_exp_f32 v233, v121
    s_nop 0
    v_cvt_pk_bf16_f32 v155, v234, v235
    v_exp_f32 v234, v122
    s_nop 0
    v_exp_f32 v235, v123
    s_nop 0
    v_cvt_pk_bf16_f32 v156, v232, v233
    v_exp_f32 v232, v124
    s_nop 0
    v_exp_f32 v233, v125
    s_nop 0
    v_cvt_pk_bf16_f32 v157, v234, v235
    v_exp_f32 v234, v126
    s_nop 0
    v_exp_f32 v235, v127
    s_nop 0
    v_cvt_pk_bf16_f32 v158, v232, v233
    v_cvt_pk_bf16_f32 v159, v234, v235
    s_nop 1
    v_mfma_f32_16x16x32_bf16 v[240:243], v[236:239], v[152:155], 0
    v_mfma_f32_16x16x32_bf16 v[244:247], v[236:239], v[156:159], 0
    s_nop 8
    s_nop 1
    s_branch Mback_8
Mrare_9:
    s_nop 15
    s_nop 7
    v_max3_f32 v8, v128, v129, v130
    v_max3_f32 v8, v8, v131, v132
    v_max3_f32 v8, v8, v133, v134
    v_max_f32 v8, v8, v135
    v_mov_b32 v9, v8
    s_nop 1
    v_permlane16_swap_b32 v8, v9
    s_nop 1
    v_max_f32 v8, v8, v9
    v_mov_b32 v9, v8
    s_nop 1
    v_permlane32_swap_b32 v8, v9
    s_nop 1
    v_max_f32 v8, v8, v9
    v_max_f32 v8, 0, v8
    v_sub_f32 v9, 0, v8
    v_exp_f32 v9, v9
    s_nop 0
    v_mul_f32 v48, v48, v9
    v_mul_f32 v49, v49, v9
    v_mul_f32 v50, v50, v9
    v_mul_f32 v51, v51, v9
    v_mul_f32 v52, v52, v9
    v_mul_f32 v53, v53, v9
    v_mul_f32 v54, v54, v9
    v_mul_f32 v55, v55, v9
    v_mul_f32 v56, v56, v9
    v_mul_f32 v57, v57, v9
    v_mul_f32 v58, v58, v9
    v_mul_f32 v59, v59, v9
    v_mul_f32 v60, v60, v9
    v_mul_f32 v61, v61, v9
    v_mul_f32 v62, v62, v9
    v_mul_f32 v63, v63, v9
    v_mul_f32 v64, v64, v9
    v_mul_f32 v65, v65, v9
    v_mul_f32 v66, v66, v9
    v_mul_f32 v67, v67, v9
    v_mul_f32 v68, v68, v9
    v_mul_f32 v69, v69, v9
    v_mul_f32 v70, v70, v9
    v_mul_f32 v71, v71, v9
    v_mul_f32 v72, v72, v9
    v_mul_f32 v73, v73, v9
    v_mul_f32 v74, v74, v9
    v_mul_f32 v75, v75, v9
    v_mul_f32 v76, v76, v9
    v_mul_f32 v77, v77, v9
    v_mul_f32 v78, v78, v9
    v_mul_f32 v79, v79, v9
    v_mul_f32 v6, v6, v9
    v_sub_f32 v144, v144, v8
    v_sub_f32 v145, v145, v8
    v_sub_f32 v146, v146, v8
    v_sub_f32 v147, v147, v8
    v_sub_f32 v128, v128, v8
    v_sub_f32 v129, v129, v8
    v_sub_f32 v130, v130, v8
    v_sub_f32 v131, v131, v8
    v_sub_f32 v132, v132, v8
    v_sub_f32 v133, v133, v8
    v_sub_f32 v134, v134, v8
    v_sub_f32 v135, v135, v8
    v_sub_f32 v112, v112, v8
    v_sub_f32 v113, v113, v8
    v_sub_f32 v114, v114, v8
    v_sub_f32 v115, v115, v8
    v_sub_f32 v116, v116, v8
    v_sub_f32 v117, v117, v8
    v_sub_f32 v118, v118, v8
    v_sub_f32 v119, v119, v8
    v_max3_f32 v8, v136, v137, v138
    v_max3_f32 v8, v8, v139, v140
    v_max3_f32 v8, v8, v141, v142
    v_max_f32 v8, v8, v143
    v_mov_b32 v9, v8
    s_nop 1
    v_permlane16_swap_b32 v8, v9
    s_nop 1
    v_max_f32 v8, v8, v9
    v_mov_b32 v9, v8
    s_nop 1
    v_permlane32_swap_b32 v8, v9
    s_nop 1
    v_max_f32 v8, v8, v9
    v_max_f32 v8, 0, v8
    v_sub_f32 v9, 0, v8
    v_exp_f32 v9, v9
    s_nop 0
    v_mul_f32 v80, v80, v9
    v_mul_f32 v81, v81, v9
    v_mul_f32 v82, v82, v9
    v_mul_f32 v83, v83, v9
    v_mul_f32 v84, v84, v9
    v_mul_f32 v85, v85, v9
    v_mul_f32 v86, v86, v9
    v_mul_f32 v87, v87, v9
    v_mul_f32 v88, v88, v9
    v_mul_f32 v89, v89, v9
    v_mul_f32 v90, v90, v9
    v_mul_f32 v91, v91, v9
    v_mul_f32 v92, v92, v9
    v_mul_f32 v93, v93, v9
    v_mul_f32 v94, v94, v9
    v_mul_f32 v95, v95, v9
    v_mul_f32 v96, v96, v9
    v_mul_f32 v97, v97, v9
    v_mul_f32 v98, v98, v9
    v_mul_f32 v99, v99, v9
    v_mul_f32 v100, v100, v9
    v_mul_f32 v101, v101, v9
    v_mul_f32 v102, v102, v9
    v_mul_f32 v103, v103, v9
    v_mul_f32 v104, v104, v9
    v_mul_f32 v105, v105, v9
    v_mul_f32 v106, v106, v9
    v_mul_f32 v107, v107, v9
    v_mul_f32 v108, v108, v9
    v_mul_f32 v109, v109, v9
    v_mul_f32 v110, v110, v9
    v_mul_f32 v111, v111, v9
    v_mul_f32 v12, v12, v9
    v_sub_f32 v148, v148, v8
    v_sub_f32 v149, v149, v8
    v_sub_f32 v150, v150, v8
    v_sub_f32 v151, v151, v8
    v_sub_f32 v136, v136, v8
    v_sub_f32 v137, v137, v8
    v_sub_f32 v138, v138, v8
    v_sub_f32 v139, v139, v8
    v_sub_f32 v140, v140, v8
    v_sub_f32 v141, v141, v8
    v_sub_f32 v142, v142, v8
    v_sub_f32 v143, v143, v8
    v_sub_f32 v120, v120, v8
    v_sub_f32 v121, v121, v8
    v_sub_f32 v122, v122, v8
    v_sub_f32 v123, v123, v8
    v_sub_f32 v124, v124, v8
    v_sub_f32 v125, v125, v8
    v_sub_f32 v126, v126, v8
    v_sub_f32 v127, v127, v8
    v_exp_f32 v232, v128
    s_nop 0
    v_exp_f32 v233, v129
    s_nop 0
    v_exp_f32 v234, v130
    s_nop 0
    v_exp_f32 v235, v131
    s_nop 0
    v_cvt_pk_bf16_f32 v160, v232, v233
    v_exp_f32 v232, v132
    s_nop 0
    v_exp_f32 v233, v133
    s_nop 0
    v_cvt_pk_bf16_f32 v161, v234, v235
    v_exp_f32 v234, v134
    s_nop 0
    v_exp_f32 v235, v135
    s_nop 0
    v_cvt_pk_bf16_f32 v162, v232, v233
    v_exp_f32 v232, v136
    s_nop 0
    v_exp_f32 v233, v137
    s_nop 0
    v_cvt_pk_bf16_f32 v163, v234, v235
    v_exp_f32 v234, v138
    s_nop 0
    v_exp_f32 v235, v139
    s_nop 0
    v_cvt_pk_bf16_f32 v164, v232, v233
    v_exp_f32 v232, v140
    s_nop 0
    v_exp_f32 v233, v141
    s_nop 0
    v_cvt_pk_bf16_f32 v165, v234, v235
    v_exp_f32 v234, v142
    s_nop 0
    v_exp_f32 v235, v143
    s_nop 0
    v_cvt_pk_bf16_f32 v166, v232, v233
    v_cvt_pk_bf16_f32 v167, v234, v235
    s_nop 1
    v_mfma_f32_16x16x32_bf16 v[240:243], v[236:239], v[160:163], 0
    v_mfma_f32_16x16x32_bf16 v[244:247], v[236:239], v[164:167], 0
    s_nop 8
    s_nop 1
    s_branch Mback_10
Mrare_11:
    s_nop 15
    s_nop 7
    v_max3_f32 v8, v112, v113, v114
    v_max3_f32 v8, v8, v115, v116
    v_max3_f32 v8, v8, v117, v118
    v_max_f32 v8, v8, v119
    v_mov_b32 v9, v8
    s_nop 1
    v_permlane16_swap_b32 v8, v9
    s_nop 1
    v_max_f32 v8, v8, v9
    v_mov_b32 v9, v8
    s_nop 1
    v_permlane32_swap_b32 v8, v9
    s_nop 1
    v_max_f32 v8, v8, v9
    v_max_f32 v8, 0, v8
    v_sub_f32 v9, 0, v8
    v_exp_f32 v9, v9
    s_nop 0
    v_mul_f32 v48, v48, v9
    v_mul_f32 v49, v49, v9
    v_mul_f32 v50, v50, v9
    v_mul_f32 v51, v51, v9
    v_mul_f32 v52, v52, v9
    v_mul_f32 v53, v53, v9
    v_mul_f32 v54, v54, v9
    v_mul_f32 v55, v55, v9
    v_mul_f32 v56, v56, v9
    v_mul_f32 v57, v57, v9
    v_mul_f32 v58, v58, v9
    v_mul_f32 v59, v59, v9
    v_mul_f32 v60, v60, v9
    v_mul_f32 v61, v61, v9
    v_mul_f32 v62, v62, v9
    v_mul_f32 v63, v63, v9
    v_mul_f32 v64, v64, v9
    v_mul_f32 v65, v65, v9
    v_mul_f32 v66, v66, v9
    v_mul_f32 v67, v67, v9
    v_mul_f32 v68, v68, v9
    v_mul_f32 v69, v69, v9
    v_mul_f32 v70, v70, v9
    v_mul_f32 v71, v71, v9
    v_mul_f32 v72, v72, v9
    v_mul_f32 v73, v73, v9
    v_mul_f32 v74, v74, v9
    v_mul_f32 v75, v75, v9
    v_mul_f32 v76, v76, v9
    v_mul_f32 v77, v77, v9
    v_mul_f32 v78, v78, v9
    v_mul_f32 v79, v79, v9
    v_mul_f32 v6, v6, v9
    v_sub_f32 v144, v144, v8
    v_sub_f32 v145, v145, v8
    v_sub_f32 v146, v146, v8
    v_sub_f32 v147, v147, v8
    v_sub_f32 v112, v112, v8
    v_sub_f32 v113, v113, v8
    v_sub_f32 v114, v114, v8
    v_sub_f32 v115, v115, v8
    v_sub_f32 v116, v116, v8
    v_sub_f32 v117, v117, v8
    v_sub_f32 v118, v118, v8
    v_sub_f32 v119, v119, v8
    v_sub_f32 v128, v128, v8
    v_sub_f32 v129, v129, v8
    v_sub_f32 v130, v130, v8
    v_sub_f32 v131, v131, v8
    v_sub_f32 v132, v132, v8
    v_sub_f32 v133, v133, v8
    v_sub_f32 v134, v134, v8
    v_sub_f32 v135, v135, v8
    v_max3_f32 v8, v120, v121, v122
    v_max3_f32 v8, v8, v123, v124
    v_max3_f32 v8, v8, v125, v126
    v_max_f32 v8, v8, v127
    v_mov_b32 v9, v8
    s_nop 1
    v_permlane16_swap_b32 v8, v9
    s_nop 1
    v_max_f32 v8, v8, v9
    v_mov_b32 v9, v8
    s_nop 1
    v_permlane32_swap_b32 v8, v9
    s_nop 1
    v_max_f32 v8, v8, v9
    v_max_f32 v8, 0, v8
    v_sub_f32 v9, 0, v8
    v_exp_f32 v9, v9
    s_nop 0
    v_mul_f32 v80, v80, v9
    v_mul_f32 v81, v81, v9
    v_mul_f32 v82, v82, v9
    v_mul_f32 v83, v83, v9
    v_mul_f32 v84, v84, v9
    v_mul_f32 v85, v85, v9
    v_mul_f32 v86, v86, v9
    v_mul_f32 v87, v87, v9
    v_mul_f32 v88, v88, v9
    v_mul_f32 v89, v89, v9
    v_mul_f32 v90, v90, v9
    v_mul_f32 v91, v91, v9
    v_mul_f32 v92, v92, v9
    v_mul_f32 v93, v93, v9
    v_mul_f32 v94, v94, v9
    v_mul_f32 v95, v95, v9
    v_mul_f32 v96, v96, v9
    v_mul_f32 v97, v97, v9
    v_mul_f32 v98, v98, v9
    v_mul_f32 v99, v99, v9
    v_mul_f32 v100, v100, v9
    v_mul_f32 v101, v101, v9
    v_mul_f32 v102, v102, v9
    v_mul_f32 v103, v103, v9
    v_mul_f32 v104, v104, v9
    v_mul_f32 v105, v105, v9
    v_mul_f32 v106, v106, v9
    v_mul_f32 v107, v107, v9
    v_mul_f32 v108, v108, v9
    v_mul_f32 v109, v109, v9
    v_mul_f32 v110, v110, v9
    v_mul_f32 v111, v111, v9
    v_mul_f32 v12, v12, v9
    v_sub_f32 v148, v148, v8
    v_sub_f32 v149, v149, v8
    v_sub_f32 v150, v150, v8
    v_sub_f32 v151, v151, v8
    v_sub_f32 v120, v120, v8
    v_sub_f32 v121, v121, v8
    v_sub_f32 v122, v122, v8
    v_sub_f32 v123, v123, v8
    v_sub_f32 v124, v124, v8
    v_sub_f32 v125, v125, v8
    v_sub_f32 v126, v126, v8
    v_sub_f32 v127, v127, v8
    v_sub_f32 v136, v136, v8
    v_sub_f32 v137, v137, v8
    v_sub_f32 v138, v138, v8
    v_sub_f32 v139, v139, v8
    v_sub_f32 v140, v140, v8
    v_sub_f32 v141, v141, v8
    v_sub_f32 v142, v142, v8
    v_sub_f32 v143, v143, v8
    v_exp_f32 v232, v112
    s_nop 0
    v_exp_f32 v233, v113
    s_nop 0
    v_exp_f32 v234, v114
    s_nop 0
    v_exp_f32 v235, v115
    s_nop 0
    v_cvt_pk_bf16_f32 v152, v232, v233
    v_exp_f32 v232, v116
    s_nop 0
    v_exp_f32 v233, v117
    s_nop 0
    v_cvt_pk_bf16_f32 v153, v234, v235
    v_exp_f32 v234, v118
    s_nop 0
    v_exp_f32 v235, v119
    s_nop 0
    v_cvt_pk_bf16_f32 v154, v232, v233
    v_exp_f32 v232, v120
    s_nop 0
    v_exp_f32 v233, v121
    s_nop 0
    v_cvt_pk_bf16_f32 v155, v234, v235
    v_exp_f32 v234, v122
    s_nop 0
    v_exp_f32 v235, v123
    s_nop 0
    v_cvt_pk_bf16_f32 v156, v232, v233
    v_exp_f32 v232, v124
    s_nop 0
    v_exp_f32 v233, v125
    s_nop 0
    v_cvt_pk_bf16_f32 v157, v234, v235
    v_exp_f32 v234, v126
    s_nop 0
    v_exp_f32 v235, v127
    s_nop 0
    v_cvt_pk_bf16_f32 v158, v232, v233
    v_cvt_pk_bf16_f32 v159, v234, v235
    s_nop 1
    v_mfma_f32_16x16x32_bf16 v[240:243], v[236:239], v[152:155], 0
    v_mfma_f32_16x16x32_bf16 v[244:247], v[236:239], v[156:159], 0
    s_nop 8
    s_nop 1
    s_branch Mback_12
Mrare_13:
    s_nop 15
    s_nop 7
    v_max3_f32 v8, v128, v129, v130
    v_max3_f32 v8, v8, v131, v132
    v_max3_f32 v8, v8, v133, v134
    v_max_f32 v8, v8, v135
    v_mov_b32 v9, v8
    s_nop 1
    v_permlane16_swap_b32 v8, v9
    s_nop 1
    v_max_f32 v8, v8, v9
    v_mov_b32 v9, v8
    s_nop 1
    v_permlane32_swap_b32 v8, v9
    s_nop 1
    v_max_f32 v8, v8, v9
    v_max_f32 v8, 0, v8
    v_sub_f32 v9, 0, v8
    v_exp_f32 v9, v9
    s_nop 0
    v_mul_f32 v48, v48, v9
    v_mul_f32 v49, v49, v9
    v_mul_f32 v50, v50, v9
    v_mul_f32 v51, v51, v9
    v_mul_f32 v52, v52, v9
    v_mul_f32 v53, v53, v9
    v_mul_f32 v54, v54, v9
    v_mul_f32 v55, v55, v9
    v_mul_f32 v56, v56, v9
    v_mul_f32 v57, v57, v9
    v_mul_f32 v58, v58, v9
    v_mul_f32 v59, v59, v9
    v_mul_f32 v60, v60, v9
    v_mul_f32 v61, v61, v9
    v_mul_f32 v62, v62, v9
    v_mul_f32 v63, v63, v9
    v_mul_f32 v64, v64, v9
    v_mul_f32 v65, v65, v9
    v_mul_f32 v66, v66, v9
    v_mul_f32 v67, v67, v9
    v_mul_f32 v68, v68, v9
    v_mul_f32 v69, v69, v9
    v_mul_f32 v70, v70, v9
    v_mul_f32 v71, v71, v9
    v_mul_f32 v72, v72, v9
    v_mul_f32 v73, v73, v9
    v_mul_f32 v74, v74, v9
    v_mul_f32 v75, v75, v9
    v_mul_f32 v76, v76, v9
    v_mul_f32 v77, v77, v9
    v_mul_f32 v78, v78, v9
    v_mul_f32 v79, v79, v9
    v_mul_f32 v6, v6, v9
    v_sub_f32 v144, v144, v8
    v_sub_f32 v145, v145, v8
    v_sub_f32 v146, v146, v8
    v_sub_f32 v147, v147, v8
    v_sub_f32 v128, v128, v8
    v_sub_f32 v129, v129, v8
    v_sub_f32 v130, v130, v8
    v_sub_f32 v131, v131, v8
    v_sub_f32 v132, v132, v8
    v_sub_f32 v133, v133, v8
    v_sub_f32 v134, v134, v8
    v_sub_f32 v135, v135, v8
    v_sub_f32 v112, v112, v8
    v_sub_f32 v113, v113, v8
    v_sub_f32 v114, v114, v8
    v_sub_f32 v115, v115, v8
    v_sub_f32 v116, v116, v8
    v_sub_f32 v117, v117, v8
    v_sub_f32 v118, v118, v8
    v_sub_f32 v119, v119, v8
    v_max3_f32 v8, v136, v137, v138
    v_max3_f32 v8, v8, v139, v140
    v_max3_f32 v8, v8, v141, v142
    v_max_f32 v8, v8, v143
    v_mov_b32 v9, v8
    s_nop 1
    v_permlane16_swap_b32 v8, v9
    s_nop 1
    v_max_f32 v8, v8, v9
    v_mov_b32 v9, v8
    s_nop 1
    v_permlane32_swap_b32 v8, v9
    s_nop 1
    v_max_f32 v8, v8, v9
    v_max_f32 v8, 0, v8
    v_sub_f32 v9, 0, v8
    v_exp_f32 v9, v9
    s_nop 0
    v_mul_f32 v80, v80, v9
    v_mul_f32 v81, v81, v9
    v_mul_f32 v82, v82, v9
    v_mul_f32 v83, v83, v9
    v_mul_f32 v84, v84, v9
    v_mul_f32 v85, v85, v9
    v_mul_f32 v86, v86, v9
    v_mul_f32 v87, v87, v9
    v_mul_f32 v88, v88, v9
    v_mul_f32 v89, v89, v9
    v_mul_f32 v90, v90, v9
    v_mul_f32 v91, v91, v9
    v_mul_f32 v92, v92, v9
    v_mul_f32 v93, v93, v9
    v_mul_f32 v94, v94, v9
    v_mul_f32 v95, v95, v9
    v_mul_f32 v96, v96, v9
    v_mul_f32 v97, v97, v9
    v_mul_f32 v98, v98, v9
    v_mul_f32 v99, v99, v9
    v_mul_f32 v100, v100, v9
    v_mul_f32 v101, v101, v9
    v_mul_f32 v102, v102, v9
    v_mul_f32 v103, v103, v9
    v_mul_f32 v104, v104, v9
    v_mul_f32 v105, v105, v9
    v_mul_f32 v106, v106, v9
    v_mul_f32 v107, v107, v9
    v_mul_f32 v108, v108, v9
    v_mul_f32 v109, v109, v9
    v_mul_f32 v110, v110, v9
    v_mul_f32 v111, v111, v9
    v_mul_f32 v12, v12, v9
    v_sub_f32 v148, v148, v8
    v_sub_f32 v149, v149, v8
    v_sub_f32 v150, v150, v8
    v_sub_f32 v151, v151, v8
    v_sub_f32 v136, v136, v8
    v_sub_f32 v137, v137, v8
    v_sub_f32 v138, v138, v8
    v_sub_f32 v139, v139, v8
    v_sub_f32 v140, v140, v8
    v_sub_f32 v141, v141, v8
    v_sub_f32 v142, v142, v8
    v_sub_f32 v143, v143, v8
    v_sub_f32 v120, v120, v8
    v_sub_f32 v121, v121, v8
    v_sub_f32 v122, v122, v8
    v_sub_f32 v123, v123, v8
    v_sub_f32 v124, v124, v8
    v_sub_f32 v125, v125, v8
    v_sub_f32 v126, v126, v8
    v_sub_f32 v127, v127, v8
    v_exp_f32 v232, v128
    s_nop 0
    v_exp_f32 v233, v129
    s_nop 0
    v_exp_f32 v234, v130
    s_nop 0
    v_exp_f32 v235, v131
    s_nop 0
    v_cvt_pk_bf16_f32 v160, v232, v233
    v_exp_f32 v232, v132
    s_nop 0
    v_exp_f32 v233, v133
    s_nop 0
    v_cvt_pk_bf16_f32 v161, v234, v235
    v_exp_f32 v234, v134
    s_nop 0
    v_exp_f32 v235, v135
    s_nop 0
    v_cvt_pk_bf16_f32 v162, v232, v233
    v_exp_f32 v232, v136
    s_nop 0
    v_exp_f32 v233, v137
    s_nop 0
    v_cvt_pk_bf16_f32 v163, v234, v235
    v_exp_f32 v234, v138
    s_nop 0
    v_exp_f32 v235, v139
    s_nop 0
    v_cvt_pk_bf16_f32 v164, v232, v233
    v_exp_f32 v232, v140
    s_nop 0
    v_exp_f32 v233, v141
    s_nop 0
    v_cvt_pk_bf16_f32 v165, v234, v235
    v_exp_f32 v234, v142
    s_nop 0
    v_exp_f32 v235, v143
    s_nop 0
    v_cvt_pk_bf16_f32 v166, v232, v233
    v_cvt_pk_bf16_f32 v167, v234, v235
    s_nop 1
    v_mfma_f32_16x16x32_bf16 v[240:243], v[236:239], v[160:163], 0
    v_mfma_f32_16x16x32_bf16 v[244:247], v[236:239], v[164:167], 0
    s_nop 8
    s_nop 1
    s_branch Mback_14
Mrare_16:
    s_nop 15
    s_nop 7
    v_max3_f32 v8, v112, v113, v114
    v_max3_f32 v8, v8, v115, v116
    v_max3_f32 v8, v8, v117, v118
    v_max_f32 v8, v8, v119
    v_mov_b32 v9, v8
    s_nop 1
    v_permlane16_swap_b32 v8, v9
    s_nop 1
    v_max_f32 v8, v8, v9
    v_mov_b32 v9, v8
    s_nop 1
    v_permlane32_swap_b32 v8, v9
    s_nop 1
    v_max_f32 v8, v8, v9
    v_max_f32 v8, 0, v8
    v_sub_f32 v9, 0, v8
    v_exp_f32 v9, v9
    s_nop 0
    v_mul_f32 v48, v48, v9
    v_mul_f32 v49, v49, v9
    v_mul_f32 v50, v50, v9
    v_mul_f32 v51, v51, v9
    v_mul_f32 v52, v52, v9
    v_mul_f32 v53, v53, v9
    v_mul_f32 v54, v54, v9
    v_mul_f32 v55, v55, v9
    v_mul_f32 v56, v56, v9
    v_mul_f32 v57, v57, v9
    v_mul_f32 v58, v58, v9
    v_mul_f32 v59, v59, v9
    v_mul_f32 v60, v60, v9
    v_mul_f32 v61, v61, v9
    v_mul_f32 v62, v62, v9
    v_mul_f32 v63, v63, v9
    v_mul_f32 v64, v64, v9
    v_mul_f32 v65, v65, v9
    v_mul_f32 v66, v66, v9
    v_mul_f32 v67, v67, v9
    v_mul_f32 v68, v68, v9
    v_mul_f32 v69, v69, v9
    v_mul_f32 v70, v70, v9
    v_mul_f32 v71, v71, v9
    v_mul_f32 v72, v72, v9
    v_mul_f32 v73, v73, v9
    v_mul_f32 v74, v74, v9
    v_mul_f32 v75, v75, v9
    v_mul_f32 v76, v76, v9
    v_mul_f32 v77, v77, v9
    v_mul_f32 v78, v78, v9
    v_mul_f32 v79, v79, v9
    v_mul_f32 v6, v6, v9
    v_sub_f32 v144, v144, v8
    v_sub_f32 v145, v145, v8
    v_sub_f32 v146, v146, v8
    v_sub_f32 v147, v147, v8
    v_sub_f32 v112, v112, v8
    v_sub_f32 v113, v113, v8
    v_sub_f32 v114, v114, v8
    v_sub_f32 v115, v115, v8
    v_sub_f32 v116, v116, v8
    v_sub_f32 v117, v117, v8
    v_sub_f32 v118, v118, v8
    v_sub_f32 v119, v119, v8
    v_sub_f32 v128, v128, v8
    v_sub_f32 v129, v129, v8
    v_sub_f32 v130, v130, v8
    v_sub_f32 v131, v131, v8
    v_sub_f32 v132, v132, v8
    v_sub_f32 v133, v133, v8
    v_sub_f32 v134, v134, v8
    v_sub_f32 v135, v135, v8
    v_max3_f32 v8, v120, v121, v122
    v_max3_f32 v8, v8, v123, v124
    v_max3_f32 v8, v8, v125, v126
    v_max_f32 v8, v8, v127
    v_mov_b32 v9, v8
    s_nop 1
    v_permlane16_swap_b32 v8, v9
    s_nop 1
    v_max_f32 v8, v8, v9
    v_mov_b32 v9, v8
    s_nop 1
    v_permlane32_swap_b32 v8, v9
    s_nop 1
    v_max_f32 v8, v8, v9
    v_max_f32 v8, 0, v8
    v_sub_f32 v9, 0, v8
    v_exp_f32 v9, v9
    s_nop 0
    v_mul_f32 v80, v80, v9
    v_mul_f32 v81, v81, v9
    v_mul_f32 v82, v82, v9
    v_mul_f32 v83, v83, v9
    v_mul_f32 v84, v84, v9
    v_mul_f32 v85, v85, v9
    v_mul_f32 v86, v86, v9
    v_mul_f32 v87, v87, v9
    v_mul_f32 v88, v88, v9
    v_mul_f32 v89, v89, v9
    v_mul_f32 v90, v90, v9
    v_mul_f32 v91, v91, v9
    v_mul_f32 v92, v92, v9
    v_mul_f32 v93, v93, v9
    v_mul_f32 v94, v94, v9
    v_mul_f32 v95, v95, v9
    v_mul_f32 v96, v96, v9
    v_mul_f32 v97, v97, v9
    v_mul_f32 v98, v98, v9
    v_mul_f32 v99, v99, v9
    v_mul_f32 v100, v100, v9
    v_mul_f32 v101, v101, v9
    v_mul_f32 v102, v102, v9
    v_mul_f32 v103, v103, v9
    v_mul_f32 v104, v104, v9
    v_mul_f32 v105, v105, v9
    v_mul_f32 v106, v106, v9
    v_mul_f32 v107, v107, v9
    v_mul_f32 v108, v108, v9
    v_mul_f32 v109, v109, v9
    v_mul_f32 v110, v110, v9
    v_mul_f32 v111, v111, v9
    v_mul_f32 v12, v12, v9
    v_sub_f32 v148, v148, v8
    v_sub_f32 v149, v149, v8
    v_sub_f32 v150, v150, v8
    v_sub_f32 v151, v151, v8
    v_sub_f32 v120, v120, v8
    v_sub_f32 v121, v121, v8
    v_sub_f32 v122, v122, v8
    v_sub_f32 v123, v123, v8
    v_sub_f32 v124, v124, v8
    v_sub_f32 v125, v125, v8
    v_sub_f32 v126, v126, v8
    v_sub_f32 v127, v127, v8
    v_sub_f32 v136, v136, v8
    v_sub_f32 v137, v137, v8
    v_sub_f32 v138, v138, v8
    v_sub_f32 v139, v139, v8
    v_sub_f32 v140, v140, v8
    v_sub_f32 v141, v141, v8
    v_sub_f32 v142, v142, v8
    v_sub_f32 v143, v143, v8
    v_exp_f32 v232, v112
    s_nop 0
    v_exp_f32 v233, v113
    s_nop 0
    v_exp_f32 v234, v114
    s_nop 0
    v_exp_f32 v235, v115
    s_nop 0
    v_cvt_pk_bf16_f32 v152, v232, v233
    v_exp_f32 v232, v116
    s_nop 0
    v_exp_f32 v233, v117
    s_nop 0
    v_cvt_pk_bf16_f32 v153, v234, v235
    v_exp_f32 v234, v118
    s_nop 0
    v_exp_f32 v235, v119
    s_nop 0
    v_cvt_pk_bf16_f32 v154, v232, v233
    v_exp_f32 v232, v120
    s_nop 0
    v_exp_f32 v233, v121
    s_nop 0
    v_cvt_pk_bf16_f32 v155, v234, v235
    v_exp_f32 v234, v122
    s_nop 0
    v_exp_f32 v235, v123
    s_nop 0
    v_cvt_pk_bf16_f32 v156, v232, v233
    v_exp_f32 v232, v124
    s_nop 0
    v_exp_f32 v233, v125
    s_nop 0
    v_cvt_pk_bf16_f32 v157, v234, v235
    v_exp_f32 v234, v126
    s_nop 0
    v_exp_f32 v235, v127
    s_nop 0
    v_cvt_pk_bf16_f32 v158, v232, v233
    v_cvt_pk_bf16_f32 v159, v234, v235
    s_nop 1
    v_mfma_f32_16x16x32_bf16 v[240:243], v[236:239], v[152:155], 0
    v_mfma_f32_16x16x32_bf16 v[244:247], v[236:239], v[156:159], 0
    s_nop 8
    s_nop 1
    s_branch Mback_17
Mrare_18:
    s_nop 15
    s_nop 7
    v_max3_f32 v8, v128, v129, v130
    v_max3_f32 v8, v8, v131, v132
    v_max3_f32 v8, v8, v133, v134
    v_max_f32 v8, v8, v135
    v_mov_b32 v9, v8
    s_nop 1
    v_permlane16_swap_b32 v8, v9
    s_nop 1
    v_max_f32 v8, v8, v9
    v_mov_b32 v9, v8
    s_nop 1
    v_permlane32_swap_b32 v8, v9
    s_nop 1
    v_max_f32 v8, v8, v9
    v_max_f32 v8, 0, v8
    v_sub_f32 v9, 0, v8
    v_exp_f32 v9, v9
    s_nop 0
    v_mul_f32 v48, v48, v9
    v_mul_f32 v49, v49, v9
    v_mul_f32 v50, v50, v9
    v_mul_f32 v51, v51, v9
    v_mul_f32 v52, v52, v9
    v_mul_f32 v53, v53, v9
    v_mul_f32 v54, v54, v9
    v_mul_f32 v55, v55, v9
    v_mul_f32 v56, v56, v9
    v_mul_f32 v57, v57, v9
    v_mul_f32 v58, v58, v9
    v_mul_f32 v59, v59, v9
    v_mul_f32 v60, v60, v9
    v_mul_f32 v61, v61, v9
    v_mul_f32 v62, v62, v9
    v_mul_f32 v63, v63, v9
    v_mul_f32 v64, v64, v9
    v_mul_f32 v65, v65, v9
    v_mul_f32 v66, v66, v9
    v_mul_f32 v67, v67, v9
    v_mul_f32 v68, v68, v9
    v_mul_f32 v69, v69, v9
    v_mul_f32 v70, v70, v9
    v_mul_f32 v71, v71, v9
    v_mul_f32 v72, v72, v9
    v_mul_f32 v73, v73, v9
    v_mul_f32 v74, v74, v9
    v_mul_f32 v75, v75, v9
    v_mul_f32 v76, v76, v9
    v_mul_f32 v77, v77, v9
    v_mul_f32 v78, v78, v9
    v_mul_f32 v79, v79, v9
    v_mul_f32 v6, v6, v9
    v_sub_f32 v144, v144, v8
    v_sub_f32 v145, v145, v8
    v_sub_f32 v146, v146, v8
    v_sub_f32 v147, v147, v8
    v_sub_f32 v128, v128, v8
    v_sub_f32 v129, v129, v8
    v_sub_f32 v130, v130, v8
    v_sub_f32 v131, v131, v8
    v_sub_f32 v132, v132, v8
    v_sub_f32 v133, v133, v8
    v_sub_f32 v134, v134, v8
    v_sub_f32 v135, v135, v8
    v_max3_f32 v8, v136, v137, v138
    v_max3_f32 v8, v8, v139, v140
    v_max3_f32 v8, v8, v141, v142
    v_max_f32 v8, v8, v143
    v_mov_b32 v9, v8
    s_nop 1
    v_permlane16_swap_b32 v8, v9
    s_nop 1
    v_max_f32 v8, v8, v9
    v_mov_b32 v9, v8
    s_nop 1
    v_permlane32_swap_b32 v8, v9
    s_nop 1
    v_max_f32 v8, v8, v9
    v_max_f32 v8, 0, v8
    v_sub_f32 v9, 0, v8
    v_exp_f32 v9, v9
    s_nop 0
    v_mul_f32 v80, v80, v9
    v_mul_f32 v81, v81, v9
    v_mul_f32 v82, v82, v9
    v_mul_f32 v83, v83, v9
    v_mul_f32 v84, v84, v9
    v_mul_f32 v85, v85, v9
    v_mul_f32 v86, v86, v9
    v_mul_f32 v87, v87, v9
    v_mul_f32 v88, v88, v9
    v_mul_f32 v89, v89, v9
    v_mul_f32 v90, v90, v9
    v_mul_f32 v91, v91, v9
    v_mul_f32 v92, v92, v9
    v_mul_f32 v93, v93, v9
    v_mul_f32 v94, v94, v9
    v_mul_f32 v95, v95, v9
    v_mul_f32 v96, v96, v9
    v_mul_f32 v97, v97, v9
    v_mul_f32 v98, v98, v9
    v_mul_f32 v99, v99, v9
    v_mul_f32 v100, v100, v9
    v_mul_f32 v101, v101, v9
    v_mul_f32 v102, v102, v9
    v_mul_f32 v103, v103, v9
    v_mul_f32 v104, v104, v9
    v_mul_f32 v105, v105, v9
    v_mul_f32 v106, v106, v9
    v_mul_f32 v107, v107, v9
    v_mul_f32 v108, v108, v9
    v_mul_f32 v109, v109, v9
    v_mul_f32 v110, v110, v9
    v_mul_f32 v111, v111, v9
    v_mul_f32 v12, v12, v9
    v_sub_f32 v148, v148, v8
    v_sub_f32 v149, v149, v8
    v_sub_f32 v150, v150, v8
    v_sub_f32 v151, v151, v8
    v_sub_f32 v136, v136, v8
    v_sub_f32 v137, v137, v8
    v_sub_f32 v138, v138, v8
    v_sub_f32 v139, v139, v8
    v_sub_f32 v140, v140, v8
    v_sub_f32 v141, v141, v8
    v_sub_f32 v142, v142, v8
    v_sub_f32 v143, v143, v8
    v_exp_f32 v232, v128
    s_nop 0
    v_exp_f32 v233, v129
    s_nop 0
    v_exp_f32 v234, v130
    s_nop 0
    v_exp_f32 v235, v131
    s_nop 0
    v_cvt_pk_bf16_f32 v160, v232, v233
    v_exp_f32 v232, v132
    s_nop 0
    v_exp_f32 v233, v133
    s_nop 0
    v_cvt_pk_bf16_f32 v161, v234, v235
    v_exp_f32 v234, v134
    s_nop 0
    v_exp_f32 v235, v135
    s_nop 0
    v_cvt_pk_bf16_f32 v162, v232, v233
    v_exp_f32 v232, v136
    s_nop 0
    v_exp_f32 v233, v137
    s_nop 0
    v_cvt_pk_bf16_f32 v163, v234, v235
    v_exp_f32 v234, v138
    s_nop 0
    v_exp_f32 v235, v139
    s_nop 0
    v_cvt_pk_bf16_f32 v164, v232, v233
    v_exp_f32 v232, v140
    s_nop 0
    v_exp_f32 v233, v141
    s_nop 0
    v_cvt_pk_bf16_f32 v165, v234, v235
    v_exp_f32 v234, v142
    s_nop 0
    v_exp_f32 v235, v143
    s_nop 0
    v_cvt_pk_bf16_f32 v166, v232, v233
    v_cvt_pk_bf16_f32 v167, v234, v235
    s_nop 1
    v_mfma_f32_16x16x32_bf16 v[240:243], v[236:239], v[160:163], 0
    v_mfma_f32_16x16x32_bf16 v[244:247], v[236:239], v[164:167], 0
    s_nop 8
    s_nop 1
    s_branch Mback_19
Mrare_20:
    s_nop 15
    s_nop 7
    v_max3_f32 v8, v112, v113, v114
    v_max3_f32 v8, v8, v115, v116
    v_max3_f32 v8, v8, v117, v118
    v_max_f32 v8, v8, v119
    v_mov_b32 v9, v8
    s_nop 1
    v_permlane16_swap_b32 v8, v9
    s_nop 1
    v_max_f32 v8, v8, v9
    v_mov_b32 v9, v8
    s_nop 1
    v_permlane32_swap_b32 v8, v9
    s_nop 1
    v_max_f32 v8, v8, v9
    v_max_f32 v8, 0, v8
    v_sub_f32 v9, 0, v8
    v_exp_f32 v9, v9
    s_nop 0
    v_mul_f32 v6, v6, v9
    v_sub_f32 v144, v144, v8
    v_sub_f32 v145, v145, v8
    v_sub_f32 v146, v146, v8
    v_sub_f32 v147, v147, v8
    v_sub_f32 v112, v112, v8
    v_sub_f32 v113, v113, v8
    v_sub_f32 v114, v114, v8
    v_sub_f32 v115, v115, v8
    v_sub_f32 v116, v116, v8
    v_sub_f32 v117, v117, v8
    v_sub_f32 v118, v118, v8
    v_sub_f32 v119, v119, v8
    v_sub_f32 v128, v128, v8
    v_sub_f32 v129, v129, v8
    v_sub_f32 v130, v130, v8
    v_sub_f32 v131, v131, v8
    v_sub_f32 v132, v132, v8
    v_sub_f32 v133, v133, v8
    v_sub_f32 v134, v134, v8
    v_sub_f32 v135, v135, v8
    v_max3_f32 v8, v120, v121, v122
    v_max3_f32 v8, v8, v123, v124
    v_max3_f32 v8, v8, v125, v126
    v_max_f32 v8, v8, v127
    v_mov_b32 v9, v8
    s_nop 1
    v_permlane16_swap_b32 v8, v9
    s_nop 1
    v_max_f32 v8, v8, v9
    v_mov_b32 v9, v8
    s_nop 1
    v_permlane32_swap_b32 v8, v9
    s_nop 1
    v_max_f32 v8, v8, v9
    v_max_f32 v8, 0, v8
    v_sub_f32 v9, 0, v8
    v_exp_f32 v9, v9
    s_nop 0
    v_mul_f32 v12, v12, v9
    v_sub_f32 v148, v148, v8
    v_sub_f32 v149, v149, v8
    v_sub_f32 v150, v150, v8
    v_sub_f32 v151, v151, v8
    v_sub_f32 v120, v120, v8
    v_sub_f32 v121, v121, v8
    v_sub_f32 v122, v122, v8
    v_sub_f32 v123, v123, v8
    v_sub_f32 v124, v124, v8
    v_sub_f32 v125, v125, v8
    v_sub_f32 v126, v126, v8
    v_sub_f32 v127, v127, v8
    v_sub_f32 v136, v136, v8
    v_sub_f32 v137, v137, v8
    v_sub_f32 v138, v138, v8
    v_sub_f32 v139, v139, v8
    v_sub_f32 v140, v140, v8
    v_sub_f32 v141, v141, v8
    v_sub_f32 v142, v142, v8
    v_sub_f32 v143, v143, v8
    v_exp_f32 v232, v112
    s_nop 0
    v_exp_f32 v233, v113
    s_nop 0
    v_exp_f32 v234, v114
    s_nop 0
    v_exp_f32 v235, v115
    s_nop 0
    v_cvt_pk_bf16_f32 v152, v232, v233
    v_exp_f32 v232, v116
    s_nop 0
    v_exp_f32 v233, v117
    s_nop 0
    v_cvt_pk_bf16_f32 v153, v234, v235
    v_exp_f32 v234, v118
    s_nop 0
    v_exp_f32 v235, v119
    s_nop 0
    v_cvt_pk_bf16_f32 v154, v232, v233
    v_exp_f32 v232, v120
    s_nop 0
    v_exp_f32 v233, v121
    s_nop 0
    v_cvt_pk_bf16_f32 v155, v234, v235
    v_exp_f32 v234, v122
    s_nop 0
    v_exp_f32 v235, v123
    s_nop 0
    v_cvt_pk_bf16_f32 v156, v232, v233
    v_exp_f32 v232, v124
    s_nop 0
    v_exp_f32 v233, v125
    s_nop 0
    v_cvt_pk_bf16_f32 v157, v234, v235
    v_exp_f32 v234, v126
    s_nop 0
    v_exp_f32 v235, v127
    s_nop 0
    v_cvt_pk_bf16_f32 v158, v232, v233
    v_cvt_pk_bf16_f32 v159, v234, v235
    s_nop 1
    v_mfma_f32_16x16x32_bf16 v[240:243], v[236:239], v[152:155], 0
    v_mfma_f32_16x16x32_bf16 v[244:247], v[236:239], v[156:159], 0
    s_nop 8
    s_nop 1
    s_branch Mback_21
Mrare_22:
    s_nop 15
    s_nop 7
    v_max3_f32 v8, v128, v129, v130
    v_max3_f32 v8, v8, v131, v132
    v_max3_f32 v8, v8, v133, v134
    v_max_f32 v8, v8, v135
    v_mov_b32 v9, v8
    s_nop 1
    v_permlane16_swap_b32 v8, v9
    s_nop 1
    v_max_f32 v8, v8, v9
    v_mov_b32 v9, v8
    s_nop 1
    v_permlane32_swap_b32 v8, v9
    s_nop 1
    v_max_f32 v8, v8, v9
    v_max_f32 v8, 0, v8
    v_sub_f32 v9, 0, v8
    v_exp_f32 v9, v9
    s_nop 0
    v_mul_f32 v48, v48, v9
    v_mul_f32 v49, v49, v9
    v_mul_f32 v50, v50, v9
    v_mul_f32 v51, v51, v9
    v_mul_f32 v52, v52, v9
    v_mul_f32 v53, v53, v9
    v_mul_f32 v54, v54, v9
    v_mul_f32 v55, v55, v9
    v_mul_f32 v56, v56, v9
    v_mul_f32 v57, v57, v9
    v_mul_f32 v58, v58, v9
    v_mul_f32 v59, v59, v9
    v_mul_f32 v60, v60, v9
    v_mul_f32 v61, v61, v9
    v_mul_f32 v62, v62, v9
    v_mul_f32 v63, v63, v9
    v_mul_f32 v64, v64, v9
    v_mul_f32 v65, v65, v9
    v_mul_f32 v66, v66, v9
    v_mul_f32 v67, v67, v9
    v_mul_f32 v68, v68, v9
    v_mul_f32 v69, v69, v9
    v_mul_f32 v70, v70, v9
    v_mul_f32 v71, v71, v9
    v_mul_f32 v72, v72, v9
    v_mul_f32 v73, v73, v9
    v_mul_f32 v74, v74, v9
    v_mul_f32 v75, v75, v9
    v_mul_f32 v76, v76, v9
    v_mul_f32 v77, v77, v9
    v_mul_f32 v78, v78, v9
    v_mul_f32 v79, v79, v9
    v_mul_f32 v6, v6, v9
    v_sub_f32 v144, v144, v8
    v_sub_f32 v145, v145, v8
    v_sub_f32 v146, v146, v8
    v_sub_f32 v147, v147, v8
    v_sub_f32 v128, v128, v8
    v_sub_f32 v129, v129, v8
    v_sub_f32 v130, v130, v8
    v_sub_f32 v131, v131, v8
    v_sub_f32 v132, v132, v8
    v_sub_f32 v133, v133, v8
    v_sub_f32 v134, v134, v8
    v_sub_f32 v135, v135, v8
    v_sub_f32 v112, v112, v8
    v_sub_f32 v113, v113, v8
    v_sub_f32 v114, v114, v8
    v_sub_f32 v115, v115, v8
    v_sub_f32 v116, v116, v8
    v_sub_f32 v117, v117, v8
    v_sub_f32 v118, v118, v8
    v_sub_f32 v119, v119, v8
    v_max3_f32 v8, v136, v137, v138
    v_max3_f32 v8, v8, v139, v140
    v_max3_f32 v8, v8, v141, v142
    v_max_f32 v8, v8, v143
    v_mov_b32 v9, v8
    s_nop 1
    v_permlane16_swap_b32 v8, v9
    s_nop 1
    v_max_f32 v8, v8, v9
    v_mov_b32 v9, v8
    s_nop 1
    v_permlane32_swap_b32 v8, v9
    s_nop 1
    v_max_f32 v8, v8, v9
    v_max_f32 v8, 0, v8
    v_sub_f32 v9, 0, v8
    v_exp_f32 v9, v9
    s_nop 0
    v_mul_f32 v80, v80, v9
    v_mul_f32 v81, v81, v9
    v_mul_f32 v82, v82, v9
    v_mul_f32 v83, v83, v9
    v_mul_f32 v84, v84, v9
    v_mul_f32 v85, v85, v9
    v_mul_f32 v86, v86, v9
    v_mul_f32 v87, v87, v9
    v_mul_f32 v88, v88, v9
    v_mul_f32 v89, v89, v9
    v_mul_f32 v90, v90, v9
    v_mul_f32 v91, v91, v9
    v_mul_f32 v92, v92, v9
    v_mul_f32 v93, v93, v9
    v_mul_f32 v94, v94, v9
    v_mul_f32 v95, v95, v9
    v_mul_f32 v96, v96, v9
    v_mul_f32 v97, v97, v9
    v_mul_f32 v98, v98, v9
    v_mul_f32 v99, v99, v9
    v_mul_f32 v100, v100, v9
    v_mul_f32 v101, v101, v9
    v_mul_f32 v102, v102, v9
    v_mul_f32 v103, v103, v9
    v_mul_f32 v104, v104, v9
    v_mul_f32 v105, v105, v9
    v_mul_f32 v106, v106, v9
    v_mul_f32 v107, v107, v9
    v_mul_f32 v108, v108, v9
    v_mul_f32 v109, v109, v9
    v_mul_f32 v110, v110, v9
    v_mul_f32 v111, v111, v9
    v_mul_f32 v12, v12, v9
    v_sub_f32 v148, v148, v8
    v_sub_f32 v149, v149, v8
    v_sub_f32 v150, v150, v8
    v_sub_f32 v151, v151, v8
    v_sub_f32 v136, v136, v8
    v_sub_f32 v137, v137, v8
    v_sub_f32 v138, v138, v8
    v_sub_f32 v139, v139, v8
    v_sub_f32 v140, v140, v8
    v_sub_f32 v141, v141, v8
    v_sub_f32 v142, v142, v8
    v_sub_f32 v143, v143, v8
    v_sub_f32 v120, v120, v8
    v_sub_f32 v121, v121, v8
    v_sub_f32 v122, v122, v8
    v_sub_f32 v123, v123, v8
    v_sub_f32 v124, v124, v8
    v_sub_f32 v125, v125, v8
    v_sub_f32 v126, v126, v8
    v_sub_f32 v127, v127, v8
    v_exp_f32 v232, v128
    s_nop 0
    v_exp_f32 v233, v129
    s_nop 0
    v_exp_f32 v234, v130
    s_nop 0
    v_exp_f32 v235, v131
    s_nop 0
    v_cvt_pk_bf16_f32 v160, v232, v233
    v_exp_f32 v232, v132
    s_nop 0
    v_exp_f32 v233, v133
    s_nop 0
    v_cvt_pk_bf16_f32 v161, v234, v235
    v_exp_f32 v234, v134
    s_nop 0
    v_exp_f32 v235, v135
    s_nop 0
    v_cvt_pk_bf16_f32 v162, v232, v233
    v_exp_f32 v232, v136
    s_nop 0
    v_exp_f32 v233, v137
    s_nop 0
    v_cvt_pk_bf16_f32 v163, v234, v235
    v_exp_f32 v234, v138
    s_nop 0
    v_exp_f32 v235, v139
    s_nop 0
    v_cvt_pk_bf16_f32 v164, v232, v233
    v_exp_f32 v232, v140
    s_nop 0
    v_exp_f32 v233, v141
    s_nop 0
    v_cvt_pk_bf16_f32 v165, v234, v235
    v_exp_f32 v234, v142
    s_nop 0
    v_exp_f32 v235, v143
    s_nop 0
    v_cvt_pk_bf16_f32 v166, v232, v233
    v_cvt_pk_bf16_f32 v167, v234, v235
    s_nop 1
    v_mfma_f32_16x16x32_bf16 v[240:243], v[236:239], v[160:163], 0
    v_mfma_f32_16x16x32_bf16 v[244:247], v[236:239], v[164:167], 0
    s_nop 8
    s_nop 1
    s_branch Mback_23
Mrare_24:
    s_nop 15
    s_nop 7
    v_max3_f32 v8, v112, v113, v114
    v_max3_f32 v8, v8, v115, v116
    v_max3_f32 v8, v8, v117, v118
    v_max_f32 v8, v8, v119
    v_mov_b32 v9, v8
    s_nop 1
    v_permlane16_swap_b32 v8, v9
    s_nop 1
    v_max_f32 v8, v8, v9
    v_mov_b32 v9, v8
    s_nop 1
    v_permlane32_swap_b32 v8, v9
    s_nop 1
    v_max_f32 v8, v8, v9
    v_max_f32 v8, 0, v8
    v_sub_f32 v9, 0, v8
    v_exp_f32 v9, v9
    s_nop 0
    v_mul_f32 v48, v48, v9
    v_mul_f32 v49, v49, v9
    v_mul_f32 v50, v50, v9
    v_mul_f32 v51, v51, v9
    v_mul_f32 v52, v52, v9
    v_mul_f32 v53, v53, v9
    v_mul_f32 v54, v54, v9
    v_mul_f32 v55, v55, v9
    v_mul_f32 v56, v56, v9
    v_mul_f32 v57, v57, v9
    v_mul_f32 v58, v58, v9
    v_mul_f32 v59, v59, v9
    v_mul_f32 v60, v60, v9
    v_mul_f32 v61, v61, v9
    v_mul_f32 v62, v62, v9
    v_mul_f32 v63, v63, v9
    v_mul_f32 v64, v64, v9
    v_mul_f32 v65, v65, v9
    v_mul_f32 v66, v66, v9
    v_mul_f32 v67, v67, v9
    v_mul_f32 v68, v68, v9
    v_mul_f32 v69, v69, v9
    v_mul_f32 v70, v70, v9
    v_mul_f32 v71, v71, v9
    v_mul_f32 v72, v72, v9
    v_mul_f32 v73, v73, v9
    v_mul_f32 v74, v74, v9
    v_mul_f32 v75, v75, v9
    v_mul_f32 v76, v76, v9
    v_mul_f32 v77, v77, v9
    v_mul_f32 v78, v78, v9
    v_mul_f32 v79, v79, v9
    v_mul_f32 v6, v6, v9
    v_sub_f32 v144, v144, v8
    v_sub_f32 v145, v145, v8
    v_sub_f32 v146, v146, v8
    v_sub_f32 v147, v147, v8
    v_sub_f32 v112, v112, v8
    v_sub_f32 v113, v113, v8
    v_sub_f32 v114, v114, v8
    v_sub_f32 v115, v115, v8
    v_sub_f32 v116, v116, v8
    v_sub_f32 v117, v117, v8
    v_sub_f32 v118, v118, v8
    v_sub_f32 v119, v119, v8
    v_sub_f32 v128, v128, v8
    v_sub_f32 v129, v129, v8
    v_sub_f32 v130, v130, v8
    v_sub_f32 v131, v131, v8
    v_sub_f32 v132, v132, v8
    v_sub_f32 v133, v133, v8
    v_sub_f32 v134, v134, v8
    v_sub_f32 v135, v135, v8
    v_max3_f32 v8, v120, v121, v122
    v_max3_f32 v8, v8, v123, v124
    v_max3_f32 v8, v8, v125, v126
    v_max_f32 v8, v8, v127
    v_mov_b32 v9, v8
    s_nop 1
    v_permlane16_swap_b32 v8, v9
    s_nop 1
    v_max_f32 v8, v8, v9
    v_mov_b32 v9, v8
    s_nop 1
    v_permlane32_swap_b32 v8, v9
    s_nop 1
    v_max_f32 v8, v8, v9
    v_max_f32 v8, 0, v8
    v_sub_f32 v9, 0, v8
    v_exp_f32 v9, v9
    s_nop 0
    v_mul_f32 v80, v80, v9
    v_mul_f32 v81, v81, v9
    v_mul_f32 v82, v82, v9
    v_mul_f32 v83, v83, v9
    v_mul_f32 v84, v84, v9
    v_mul_f32 v85, v85, v9
    v_mul_f32 v86, v86, v9
    v_mul_f32 v87, v87, v9
    v_mul_f32 v88, v88, v9
    v_mul_f32 v89, v89, v9
    v_mul_f32 v90, v90, v9
    v_mul_f32 v91, v91, v9
    v_mul_f32 v92, v92, v9
    v_mul_f32 v93, v93, v9
    v_mul_f32 v94, v94, v9
    v_mul_f32 v95, v95, v9
    v_mul_f32 v96, v96, v9
    v_mul_f32 v97, v97, v9
    v_mul_f32 v98, v98, v9
    v_mul_f32 v99, v99, v9
    v_mul_f32 v100, v100, v9
    v_mul_f32 v101, v101, v9
    v_mul_f32 v102, v102, v9
    v_mul_f32 v103, v103, v9
    v_mul_f32 v104, v104, v9
    v_mul_f32 v105, v105, v9
    v_mul_f32 v106, v106, v9
    v_mul_f32 v107, v107, v9
    v_mul_f32 v108, v108, v9
    v_mul_f32 v109, v109, v9
    v_mul_f32 v110, v110, v9
    v_mul_f32 v111, v111, v9
    v_mul_f32 v12, v12, v9
    v_sub_f32 v148, v148, v8
    v_sub_f32 v149, v149, v8
    v_sub_f32 v150, v150, v8
    v_sub_f32 v151, v151, v8
    v_sub_f32 v120, v120, v8
    v_sub_f32 v121, v121, v8
    v_sub_f32 v122, v122, v8
    v_sub_f32 v123, v123, v8
    v_sub_f32 v124, v124, v8
    v_sub_f32 v125, v125, v8
    v_sub_f32 v126, v126, v8
    v_sub_f32 v127, v127, v8
    v_sub_f32 v136, v136, v8
    v_sub_f32 v137, v137, v8
    v_sub_f32 v138, v138, v8
    v_sub_f32 v139, v139, v8
    v_sub_f32 v140, v140, v8
    v_sub_f32 v141, v141, v8
    v_sub_f32 v142, v142, v8
    v_sub_f32 v143, v143, v8
    v_exp_f32 v232, v112
    s_nop 0
    v_exp_f32 v233, v113
    s_nop 0
    v_exp_f32 v234, v114
    s_nop 0
    v_exp_f32 v235, v115
    s_nop 0
    v_cvt_pk_bf16_f32 v152, v232, v233
    v_exp_f32 v232, v116
    s_nop 0
    v_exp_f32 v233, v117
    s_nop 0
    v_cvt_pk_bf16_f32 v153, v234, v235
    v_exp_f32 v234, v118
    s_nop 0
    v_exp_f32 v235, v119
    s_nop 0
    v_cvt_pk_bf16_f32 v154, v232, v233
    v_exp_f32 v232, v120
    s_nop 0
    v_exp_f32 v233, v121
    s_nop 0
    v_cvt_pk_bf16_f32 v155, v234, v235
    v_exp_f32 v234, v122
    s_nop 0
    v_exp_f32 v235, v123
    s_nop 0
    v_cvt_pk_bf16_f32 v156, v232, v233
    v_exp_f32 v232, v124
    s_nop 0
    v_exp_f32 v233, v125
    s_nop 0
    v_cvt_pk_bf16_f32 v157, v234, v235
    v_exp_f32 v234, v126
    s_nop 0
    v_exp_f32 v235, v127
    s_nop 0
    v_cvt_pk_bf16_f32 v158, v232, v233
    v_cvt_pk_bf16_f32 v159, v234, v235
    s_nop 1
    v_mfma_f32_16x16x32_bf16 v[240:243], v[236:239], v[152:155], 0
    v_mfma_f32_16x16x32_bf16 v[244:247], v[236:239], v[156:159], 0
    s_nop 8
    s_nop 1
    s_branch Mback_25
Mrare_27:
    s_nop 15
    s_nop 7
    v_max3_f32 v8, v128, v129, v130
    v_max3_f32 v8, v8, v131, v132
    v_max3_f32 v8, v8, v133, v134
    v_max_f32 v8, v8, v135
    v_mov_b32 v9, v8
    s_nop 1
    v_permlane16_swap_b32 v8, v9
    s_nop 1
    v_max_f32 v8, v8, v9
    v_mov_b32 v9, v8
    s_nop 1
    v_permlane32_swap_b32 v8, v9
    s_nop 1
    v_max_f32 v8, v8, v9
    v_max_f32 v8, 0, v8
    v_sub_f32 v9, 0, v8
    v_exp_f32 v9, v9
    s_nop 0
    v_mul_f32 v48, v48, v9
    v_mul_f32 v49, v49, v9
    v_mul_f32 v50, v50, v9
    v_mul_f32 v51, v51, v9
    v_mul_f32 v52, v52, v9
    v_mul_f32 v53, v53, v9
    v_mul_f32 v54, v54, v9
    v_mul_f32 v55, v55, v9
    v_mul_f32 v56, v56, v9
    v_mul_f32 v57, v57, v9
    v_mul_f32 v58, v58, v9
    v_mul_f32 v59, v59, v9
    v_mul_f32 v60, v60, v9
    v_mul_f32 v61, v61, v9
    v_mul_f32 v62, v62, v9
    v_mul_f32 v63, v63, v9
    v_mul_f32 v64, v64, v9
    v_mul_f32 v65, v65, v9
    v_mul_f32 v66, v66, v9
    v_mul_f32 v67, v67, v9
    v_mul_f32 v68, v68, v9
    v_mul_f32 v69, v69, v9
    v_mul_f32 v70, v70, v9
    v_mul_f32 v71, v71, v9
    v_mul_f32 v72, v72, v9
    v_mul_f32 v73, v73, v9
    v_mul_f32 v74, v74, v9
    v_mul_f32 v75, v75, v9
    v_mul_f32 v76, v76, v9
    v_mul_f32 v77, v77, v9
    v_mul_f32 v78, v78, v9
    v_mul_f32 v79, v79, v9
    v_mul_f32 v6, v6, v9
    v_sub_f32 v144, v144, v8
    v_sub_f32 v145, v145, v8
    v_sub_f32 v146, v146, v8
    v_sub_f32 v147, v147, v8
    v_sub_f32 v128, v128, v8
    v_sub_f32 v129, v129, v8
    v_sub_f32 v130, v130, v8
    v_sub_f32 v131, v131, v8
    v_sub_f32 v132, v132, v8
    v_sub_f32 v133, v133, v8
    v_sub_f32 v134, v134, v8
    v_sub_f32 v135, v135, v8
    v_max3_f32 v8, v136, v137, v138
    v_max3_f32 v8, v8, v139, v140
    v_max3_f32 v8, v8, v141, v142
    v_max_f32 v8, v8, v143
    v_mov_b32 v9, v8
    s_nop 1
    v_permlane16_swap_b32 v8, v9
    s_nop 1
    v_max_f32 v8, v8, v9
    v_mov_b32 v9, v8
    s_nop 1
    v_permlane32_swap_b32 v8, v9
    s_nop 1
    v_max_f32 v8, v8, v9
    v_max_f32 v8, 0, v8
    v_sub_f32 v9, 0, v8
    v_exp_f32 v9, v9
    s_nop 0
    v_mul_f32 v80, v80, v9
    v_mul_f32 v81, v81, v9
    v_mul_f32 v82, v82, v9
    v_mul_f32 v83, v83, v9
    v_mul_f32 v84, v84, v9
    v_mul_f32 v85, v85, v9
    v_mul_f32 v86, v86, v9
    v_mul_f32 v87, v87, v9
    v_mul_f32 v88, v88, v9
    v_mul_f32 v89, v89, v9
    v_mul_f32 v90, v90, v9
    v_mul_f32 v91, v91, v9
    v_mul_f32 v92, v92, v9
    v_mul_f32 v93, v93, v9
    v_mul_f32 v94, v94, v9
    v_mul_f32 v95, v95, v9
    v_mul_f32 v96, v96, v9
    v_mul_f32 v97, v97, v9
    v_mul_f32 v98, v98, v9
    v_mul_f32 v99, v99, v9
    v_mul_f32 v100, v100, v9
    v_mul_f32 v101, v101, v9
    v_mul_f32 v102, v102, v9
    v_mul_f32 v103, v103, v9
    v_mul_f32 v104, v104, v9
    v_mul_f32 v105, v105, v9
    v_mul_f32 v106, v106, v9
    v_mul_f32 v107, v107, v9
    v_mul_f32 v108, v108, v9
    v_mul_f32 v109, v109, v9
    v_mul_f32 v110, v110, v9
    v_mul_f32 v111, v111, v9
    v_mul_f32 v12, v12, v9
    v_sub_f32 v148, v148, v8
    v_sub_f32 v149, v149, v8
    v_sub_f32 v150, v150, v8
    v_sub_f32 v151, v151, v8
    v_sub_f32 v136, v136, v8
    v_sub_f32 v137, v137, v8
    v_sub_f32 v138, v138, v8
    v_sub_f32 v139, v139, v8
    v_sub_f32 v140, v140, v8
    v_sub_f32 v141, v141, v8
    v_sub_f32 v142, v142, v8
    v_sub_f32 v143, v143, v8
    v_exp_f32 v232, v128
    s_nop 0
    v_exp_f32 v233, v129
    s_nop 0
    v_exp_f32 v234, v130
    s_nop 0
    v_exp_f32 v235, v131
    s_nop 0
    v_cvt_pk_bf16_f32 v160, v232, v233
    v_exp_f32 v232, v132
    s_nop 0
    v_exp_f32 v233, v133
    s_nop 0
    v_cvt_pk_bf16_f32 v161, v234, v235
    v_exp_f32 v234, v134
    s_nop 0
    v_exp_f32 v235, v135
    s_nop 0
    v_cvt_pk_bf16_f32 v162, v232, v233
    v_exp_f32 v232, v136
    s_nop 0
    v_exp_f32 v233, v137
    s_nop 0
    v_cvt_pk_bf16_f32 v163, v234, v235
    v_exp_f32 v234, v138
    s_nop 0
    v_exp_f32 v235, v139
    s_nop 0
    v_cvt_pk_bf16_f32 v164, v232, v233
    v_exp_f32 v232, v140
    s_nop 0
    v_exp_f32 v233, v141
    s_nop 0
    v_cvt_pk_bf16_f32 v165, v234, v235
    v_exp_f32 v234, v142
    s_nop 0
    v_exp_f32 v235, v143
    s_nop 0
    v_cvt_pk_bf16_f32 v166, v232, v233
    v_cvt_pk_bf16_f32 v167, v234, v235
    s_nop 1
    v_mfma_f32_16x16x32_bf16 v[240:243], v[236:239], v[160:163], 0
    v_mfma_f32_16x16x32_bf16 v[244:247], v[236:239], v[164:167], 0
    s_nop 8
    s_nop 1
    s_branch Mback_28
L_rem:
    v_and_b32 v12, 15, v0
    v_lshrrev_b32 v12, 1, v12
    v_mul_u32_u24 v2, 1056, v12
    v_and_b32 v12, 1, v0
    v_lshl_add_u32 v2, v12, 8, v2
    v_lshrrev_b32 v13, 4, v0
    v_xor_b32 v12, v12, v13
    v_lshl_add_u32 v2, v12, 4, v2
    v_bfe_u32 v12, v0, 2, 2
    v_lshlrev_b32 v12, 1, v12
    v_bfe_u32 v14, v0, 4, 1
    v_add_u32 v12, v12, v14
    v_mul_u32_u24 v3, 1056, v12
    v_lshrrev_b32 v12, 5, v0
    v_lshl_add_u32 v3, v12, 8, v3
    v_and_b32 v12, 3, v0
    v_lshl_add_u32 v3, v12, 3, v3
    v_and_b32 v12, 15, v0
    s_lshl_b32 s32, s3, 5
    s_min_u32 s32, s32, 128
    v_add_u32 v14, s32, v12
    v_mul_u32_u24 v11, 272, v14
    v_lshl_add_u32 v11, v13, 4, v11
    v_add_u32 v11, 42240, v11
    v_lshlrev_b32 v10, 4, v12
    s_lshl_b32 s32, s32, 6
    s_add_u32 s32, s32, 42240
    v_add_u32 v10, s32, v10
    v_and_b32 v12, 1, v13
    v_lshl_add_u32 v10, v12, 3, v10
    v_lshrrev_b32 v12, 1, v13
    v_lshl_add_u32 v10, v12, 8, v10
    v_mov_b32 v160, 0x3f803f80
    v_mov_b32 v161, 0x3f803f80
    v_mov_b32 v162, 0x3f803f80
    v_mov_b32 v163, 0x3f803f80
    s_barrier
    ds_read_b128 v[16:19], v11 offset:0
    ds_read_b128 v[20:23], v11 offset:64
    ds_read_b128 v[24:27], v11 offset:128
    ds_read_b128 v[28:31], v11 offset:192
    v_add_u32 v4, s28, v2
    s_add_u32 s28, s28, 8448
    s_cmp_eq_u32 s28, 42240
    s_cselect_b32 s28, 0, s28
    ds_read_b128 v[92:95], v4 offset:0
    ds_read_b128 v[96:99], v4 offset:64
    ds_read_b128 v[100:103], v4 offset:128
    ds_read_b128 v[104:107], v4 offset:192
    ds_read_b128 v[108:111], v4 offset:512
    ds_read_b128 v[112:115], v4 offset:576
    ds_read_b128 v[116:119], v4 offset:640
    ds_read_b128 v[120:123], v4 offset:704
    v_add_u32 v4, s28, v2
    s_add_u32 s28, s28, 8448
    s_cmp_eq_u32 s28, 42240
    s_cselect_b32 s28, 0, s28
    v_mov_b32 v6, 0
    s_waitcnt lgkmcnt(7)
    v_mfma_f32_16x16x32_bf16 v[64:67], v[92:95], v[16:19], 0
    ds_read_b128 v[92:95], v4 offset:0
    s_waitcnt lgkmcnt(7)
    v_mfma_f32_16x16x32_bf16 v[64:67], v[96:99], v[20:23], v[64:67]
    ds_read_b128 v[96:99], v4 offset:64
    s_waitcnt lgkmcnt(7)
    v_mfma_f32_16x16x32_bf16 v[64:67], v[100:103], v[24:27], v[64:67]
    ds_read_b128 v[100:103], v4 offset:128
    s_waitcnt lgkmcnt(7)
    v_mfma_f32_16x16x32_bf16 v[64:67], v[104:107], v[28:31], v[64:67]
    ds_read_b128 v[104:107], v4 offset:192
    s_waitcnt lgkmcnt(7)
    v_mfma_f32_16x16x32_bf16 v[68:71], v[108:111], v[16:19], 0
    ds_read_b128 v[108:111], v4 offset:512
    s_waitcnt lgkmcnt(7)
    v_mfma_f32_16x16x32_bf16 v[68:71], v[112:115], v[20:23], v[68:71]
    ds_read_b128 v[112:115], v4 offset:576
    s_waitcnt lgkmcnt(7)
    v_mfma_f32_16x16x32_bf16 v[68:71], v[116:119], v[24:27], v[68:71]
    ds_read_b128 v[116:119], v4 offset:640
    s_waitcnt lgkmcnt(7)
    v_mfma_f32_16x16x32_bf16 v[68:71], v[120:123], v[28:31], v[68:71]
    ds_read_b128 v[120:123], v4 offset:704
    s_nop 15
    v_max3_f32 v8, v64, v65, v66
    v_max3_f32 v8, v8, v67, v68
    v_max3_f32 v8, v8, v69, v70
    v_max_f32 v8, v8, v71
    v_mov_b32 v9, v8
    s_nop 1
    v_permlane16_swap_b32 v8, v9
    s_nop 1
    v_max_f32 v8, v8, v9
    v_mov_b32 v9, v8
    s_nop 1
    v_permlane32_swap_b32 v8, v9
    s_nop 1
    v_max_f32 v8, v8, v9
    v_sub_f32 v80, 0, v8
    v_mov_b32 v81, v80
    v_mov_b32 v82, v80
    v_mov_b32 v83, v80
    v_sub_f32 v64, v64, v8
    v_sub_f32 v65, v65, v8
    v_sub_f32 v66, v66, v8
    v_sub_f32 v67, v67, v8
    v_sub_f32 v68, v68, v8
    v_sub_f32 v69, v69, v8
    v_sub_f32 v70, v70, v8
    v_sub_f32 v71, v71, v8
    s_waitcnt lgkmcnt(0)
    s_waitcnt vmcnt(8)
    s_barrier
    v_add_u32 v5, s29, v3
    s_add_u32 s29, s29, 8448
    s_cmp_eq_u32 s29, 163584
    s_cselect_b32 s29, 121344, s29
    v_mfma_f32_16x16x32_bf16 v[72:75], v[92:95], v[16:19], v[80:83]
    v_add_u32 v4, s28, v2
    s_add_u32 s28, s28, 8448
    s_cmp_eq_u32 s28, 42240
    s_cselect_b32 s28, 0, s28
    ds_read_b64_tr_b16 v[124:125], v5 offset:0
    ds_read_b64_tr_b16 v[126:127], v5 offset:512
    ds_read_b128 v[92:95], v4 offset:0
    v_mfma_f32_16x16x32_bf16 v[72:75], v[96:99], v[20:23], v[72:75]
    ds_read_b64_tr_b16 v[128:129], v5 offset:32
    ds_read_b64_tr_b16 v[130:131], v5 offset:544
    ds_read_b128 v[96:99], v4 offset:64
    v_exp_f32 v156, v64
    v_mfma_f32_16x16x32_bf16 v[72:75], v[100:103], v[24:27], v[72:75]
    ds_read_b64_tr_b16 v[132:133], v5 offset:64
    ds_read_b64_tr_b16 v[134:135], v5 offset:576
    ds_read_b128 v[100:103], v4 offset:128
    v_mfma_f32_16x16x32_bf16 v[72:75], v[104:107], v[28:31], v[72:75]
    ds_read_b64_tr_b16 v[136:137], v5 offset:96
    ds_read_b64_tr_b16 v[138:139], v5 offset:608
    ds_read_b128 v[104:107], v4 offset:192
    v_mfma_f32_16x16x32_bf16 v[76:79], v[108:111], v[16:19], v[80:83]
    ds_read_b64_tr_b16 v[140:141], v5 offset:128
    ds_read_b64_tr_b16 v[142:143], v5 offset:640
    ds_read_b128 v[108:111], v4 offset:512
    v_mfma_f32_16x16x32_bf16 v[76:79], v[112:115], v[20:23], v[76:79]
    ds_read_b64_tr_b16 v[144:145], v5 offset:160
    ds_read_b64_tr_b16 v[146:147], v5 offset:672
    ds_read_b128 v[112:115], v4 offset:576
    v_exp_f32 v157, v65
    v_mfma_f32_16x16x32_bf16 v[76:79], v[116:119], v[24:27], v[76:79]
    ds_read_b64_tr_b16 v[148:149], v5 offset:192
    ds_read_b64_tr_b16 v[150:151], v5 offset:704
    ds_read_b128 v[116:119], v4 offset:640
    v_mfma_f32_16x16x32_bf16 v[76:79], v[120:123], v[28:31], v[76:79]
    ds_read_b64_tr_b16 v[152:153], v5 offset:224
    ds_read_b64_tr_b16 v[154:155], v5 offset:736
    ds_read_b128 v[120:123], v4 offset:704
    v_exp_f32 v158, v66
    v_exp_f32 v159, v67
    v_cvt_pk_bf16_f32 v84, v156, v157
    v_exp_f32 v156, v68
    v_exp_f32 v157, v69
    v_cvt_pk_bf16_f32 v85, v158, v159
    v_exp_f32 v158, v70
    v_exp_f32 v159, v71
    v_cvt_pk_bf16_f32 v86, v156, v157
    v_cvt_pk_bf16_f32 v87, v158, v159
    s_nop 1
    v_mfma_f32_16x16x32_bf16 v[164:167], v[160:163], v[84:87], 0
    s_waitcnt lgkmcnt(0)
    s_waitcnt vmcnt(4)
    s_barrier
    s_nop 5
    v_cmp_nge_f32 vcc, s31, v164
    s_cbranch_vccnz Rrare_29
Rback_30:
    v_add_f32 v6, v6, v164
    v_mfma_f32_16x16x32_bf16 v[64:67], v[92:95], v[16:19], v[80:83]
    v_add_u32 v5, s29, v3
    s_add_u32 s29, s29, 8448
    s_cmp_eq_u32 s29, 163584
    s_cselect_b32 s29, 121344, s29
    v_add_u32 v4, s28, v2
    s_add_u32 s28, s28, 8448
    s_cmp_eq_u32 s28, 42240
    s_cselect_b32 s28, 0, s28
    ds_read_b128 v[92:95], v4 offset:0
    v_exp_f32 v156, v72
    v_mfma_f32_16x16x32_bf16 v[64:67], v[96:99], v[20:23], v[64:67]
    ds_read_b128 v[96:99], v4 offset:64
    v_exp_f32 v157, v73
    v_mfma_f32_16x16x32_bf16 v[64:67], v[100:103], v[24:27], v[64:67]
    ds_read_b128 v[100:103], v4 offset:128
    v_exp_f32 v158, v74
    v_mfma_f32_16x16x32_bf16 v[64:67], v[104:107], v[28:31], v[64:67]
    ds_read_b128 v[104:107], v4 offset:192
    v_exp_f32 v159, v75
    v_mfma_f32_16x16x32_bf16 v[68:71], v[108:111], v[16:19], v[80:83]
    ds_read_b128 v[108:111], v4 offset:512
    v_cvt_pk_bf16_f32 v88, v156, v157
    v_mfma_f32_16x16x32_bf16 v[68:71], v[112:115], v[20:23], v[68:71]
    ds_read_b128 v[112:115], v4 offset:576
    v_exp_f32 v156, v76
    v_mfma_f32_16x16x32_bf16 v[68:71], v[116:119], v[24:27], v[68:71]
    ds_read_b128 v[116:119], v4 offset:640
    v_exp_f32 v157, v77
    v_mfma_f32_16x16x32_bf16 v[68:71], v[120:123], v[28:31], v[68:71]
    ds_read_b128 v[120:123], v4 offset:704
    v_cvt_pk_bf16_f32 v89, v158, v159
    v_mfma_f32_16x16x32_bf16 v[32:35], v[124:127], v[84:87], 0
    ds_read_b64_tr_b16 v[124:125], v5 offset:0
    ds_read_b64_tr_b16 v[126:127], v5 offset:512
    v_mfma_f32_16x16x32_bf16 v[36:39], v[128:131], v[84:87], 0
    ds_read_b64_tr_b16 v[128:129], v5 offset:32
    ds_read_b64_tr_b16 v[130:131], v5 offset:544
    v_exp_f32 v158, v78
    v_mfma_f32_16x16x32_bf16 v[40:43], v[132:135], v[84:87], 0
    ds_read_b64_tr_b16 v[132:133], v5 offset:64
    ds_read_b64_tr_b16 v[134:135], v5 offset:576
    v_mfma_f32_16x16x32_bf16 v[44:47], v[136:139], v[84:87], 0
    ds_read_b64_tr_b16 v[136:137], v5 offset:96
    ds_read_b64_tr_b16 v[138:139], v5 offset:608
    v_exp_f32 v159, v79
    v_mfma_f32_16x16x32_bf16 v[48:51], v[140:143], v[84:87], 0
    ds_read_b64_tr_b16 v[140:141], v5 offset:128
    ds_read_b64_tr_b16 v[142:143], v5 offset:640
    v_mfma_f32_16x16x32_bf16 v[52:55], v[144:147], v[84:87], 0
    ds_read_b64_tr_b16 v[144:145], v5 offset:160
    ds_read_b64_tr_b16 v[146:147], v5 offset:672
    v_cvt_pk_bf16_f32 v90, v156, v157
    v_mfma_f32_16x16x32_bf16 v[56:59], v[148:151], v[84:87], 0
    ds_read_b64_tr_b16 v[148:149], v5 offset:192
    ds_read_b64_tr_b16 v[150:151], v5 offset:704
    v_mfma_f32_16x16x32_bf16 v[60:63], v[152:155], v[84:87], 0
    ds_read_b64_tr_b16 v[152:153], v5 offset:224
    ds_read_b64_tr_b16 v[154:155], v5 offset:736
    v_cvt_pk_bf16_f32 v91, v158, v159
    s_nop 1
    v_mfma_f32_16x16x32_bf16 v[164:167], v[160:163], v[88:91], 0
    s_waitcnt lgkmcnt(0)
    s_waitcnt vmcnt(0)
    s_barrier
    s_nop 5
    v_cmp_nge_f32 vcc, s31, v164
    s_cbranch_vccnz Rrare_31
Rback_32:
    v_add_f32 v6, v6, v164
    v_mfma_f32_16x16x32_bf16 v[72:75], v[92:95], v[16:19], v[80:83]
    v_add_u32 v5, s29, v3
    s_add_u32 s29, s29, 8448
    s_cmp_eq_u32 s29, 163584
    s_cselect_b32 s29, 121344, s29
    v_add_u32 v4, s28, v2
    s_add_u32 s28, s28, 8448
    s_cmp_eq_u32 s28, 42240
    s_cselect_b32 s28, 0, s28
    ds_read_b128 v[92:95], v4 offset:0
    v_exp_f32 v156, v64
    v_mfma_f32_16x16x32_bf16 v[72:75], v[96:99], v[20:23], v[72:75]
    ds_read_b128 v[96:99], v4 offset:64
    v_exp_f32 v157, v65
    v_mfma_f32_16x16x32_bf16 v[72:75], v[100:103], v[24:27], v[72:75]
    ds_read_b128 v[100:103], v4 offset:128
    v_exp_f32 v158, v66
    v_mfma_f32_16x16x32_bf16 v[72:75], v[104:107], v[28:31], v[72:75]
    ds_read_b128 v[104:107], v4 offset:192
    v_exp_f32 v159, v67
    v_mfma_f32_16x16x32_bf16 v[76:79], v[108:111], v[16:19], v[80:83]
    ds_read_b128 v[108:111], v4 offset:512
    v_cvt_pk_bf16_f32 v84, v156, v157
    v_mfma_f32_16x16x32_bf16 v[76:79], v[112:115], v[20:23], v[76:79]
    ds_read_b128 v[112:115], v4 offset:576
    v_exp_f32 v156, v68
    v_mfma_f32_16x16x32_bf16 v[76:79], v[116:119], v[24:27], v[76:79]
    ds_read_b128 v[116:119], v4 offset:640
    v_exp_f32 v157, v69
    v_mfma_f32_16x16x32_bf16 v[76:79], v[120:123], v[28:31], v[76:79]
    ds_read_b128 v[120:123], v4 offset:704
    v_cvt_pk_bf16_f32 v85, v158, v159
    v_mfma_f32_16x16x32_bf16 v[32:35], v[124:127], v[88:91], v[32:35]
    ds_read_b64_tr_b16 v[124:125], v5 offset:0
    ds_read_b64_tr_b16 v[126:127], v5 offset:512
    v_mfma_f32_16x16x32_bf16 v[36:39], v[128:131], v[88:91], v[36:39]
    ds_read_b64_tr_b16 v[128:129], v5 offset:32
    ds_read_b64_tr_b16 v[130:131], v5 offset:544
    v_exp_f32 v158, v70
    v_mfma_f32_16x16x32_bf16 v[40:43], v[132:135], v[88:91], v[40:43]
    ds_read_b64_tr_b16 v[132:133], v5 offset:64
    ds_read_b64_tr_b16 v[134:135], v5 offset:576
    v_mfma_f32_16x16x32_bf16 v[44:47], v[136:139], v[88:91], v[44:47]
    ds_read_b64_tr_b16 v[136:137], v5 offset:96
    ds_read_b64_tr_b16 v[138:139], v5 offset:608
    v_exp_f32 v159, v71
    v_mfma_f32_16x16x32_bf16 v[48:51], v[140:143], v[88:91], v[48:51]
    ds_read_b64_tr_b16 v[140:141], v5 offset:128
    ds_read_b64_tr_b16 v[142:143], v5 offset:640
    v_mfma_f32_16x16x32_bf16 v[52:55], v[144:147], v[88:91], v[52:55]
    ds_read_b64_tr_b16 v[144:145], v5 offset:160
    ds_read_b64_tr_b16 v[146:147], v5 offset:672
    v_cvt_pk_bf16_f32 v86, v156, v157
    v_mfma_f32_16x16x32_bf16 v[56:59], v[148:151], v[88:91], v[56:59]
    ds_read_b64_tr_b16 v[148:149], v5 offset:192
    ds_read_b64_tr_b16 v[150:151], v5 offset:704
    v_mfma_f32_16x16x32_bf16 v[60:63], v[152:155], v[88:91], v[60:63]
    ds_read_b64_tr_b16 v[152:153], v5 offset:224
    ds_read_b64_tr_b16 v[154:155], v5 offset:736
    v_cvt_pk_bf16_f32 v87, v158, v159
    s_nop 1
    v_mfma_f32_16x16x32_bf16 v[164:167], v[160:163], v[84:87], 0
    s_waitcnt lgkmcnt(0)
    s_barrier
    s_mov_b32 s30, 14
    s_mov_b32 s27, 0
R_loop:
    s_nop 5
    v_cmp_nge_f32 vcc, s31, v164
    s_cbranch_vccnz Rrare_33
Rback_34:
    v_add_f32 v6, v6, v164
    v_mfma_f32_16x16x32_bf16 v[64:67], v[92:95], v[16:19], v[80:83]
    v_add_u32 v5, s29, v3
    s_add_u32 s29, s29, 8448
    s_cmp_eq_u32 s29, 163584
    s_cselect_b32 s29, 121344, s29
    v_add_u32 v4, s28, v2
    s_add_u32 s28, s28, 8448
    s_cmp_eq_u32 s28, 42240
    s_cselect_b32 s28, 0, s28
    ds_read_b128 v[92:95], v4 offset:0
    v_exp_f32 v156, v72
    v_mfma_f32_16x16x32_bf16 v[64:67], v[96:99], v[20:23], v[64:67]
    ds_read_b128 v[96:99], v4 offset:64
    v_exp_f32 v157, v73
    v_mfma_f32_16x16x32_bf16 v[64:67], v[100:103], v[24:27], v[64:67]
    ds_read_b128 v[100:103], v4 offset:128
    v_exp_f32 v158, v74
    v_mfma_f32_16x16x32_bf16 v[64:67], v[104:107], v[28:31], v[64:67]
    ds_read_b128 v[104:107], v4 offset:192
    v_exp_f32 v159, v75
    v_mfma_f32_16x16x32_bf16 v[68:71], v[108:111], v[16:19], v[80:83]
    ds_read_b128 v[108:111], v4 offset:512
    v_cvt_pk_bf16_f32 v88, v156, v157
    v_mfma_f32_16x16x32_bf16 v[68:71], v[112:115], v[20:23], v[68:71]
    ds_read_b128 v[112:115], v4 offset:576
    v_exp_f32 v156, v76
    v_mfma_f32_16x16x32_bf16 v[68:71], v[116:119], v[24:27], v[68:71]
    ds_read_b128 v[116:119], v4 offset:640
    v_exp_f32 v157, v77
    v_mfma_f32_16x16x32_bf16 v[68:71], v[120:123], v[28:31], v[68:71]
    ds_read_b128 v[120:123], v4 offset:704
    v_cvt_pk_bf16_f32 v89, v158, v159
    v_mfma_f32_16x16x32_bf16 v[32:35], v[124:127], v[84:87], v[32:35]
    ds_read_b64_tr_b16 v[124:125], v5 offset:0
    ds_read_b64_tr_b16 v[126:127], v5 offset:512
    v_mfma_f32_16x16x32_bf16 v[36:39], v[128:131], v[84:87], v[36:39]
    ds_read_b64_tr_b16 v[128:129], v5 offset:32
    ds_read_b64_tr_b16 v[130:131], v5 offset:544
    v_exp_f32 v158, v78
    v_mfma_f32_16x16x32_bf16 v[40:43], v[132:135], v[84:87], v[40:43]
    ds_read_b64_tr_b16 v[132:133], v5 offset:64
    ds_read_b64_tr_b16 v[134:135], v5 offset:576
    v_mfma_f32_16x16x32_bf16 v[44:47], v[136:139], v[84:87], v[44:47]
    ds_read_b64_tr_b16 v[136:137], v5 offset:96
    ds_read_b64_tr_b16 v[138:139], v5 offset:608
    v_exp_f32 v159, v79
    v_mfma_f32_16x16x32_bf16 v[48:51], v[140:143], v[84:87], v[48:51]
    ds_read_b64_tr_b16 v[140:141], v5 offset:128
    ds_read_b64_tr_b16 v[142:143], v5 offset:640
    v_mfma_f32_16x16x32_bf16 v[52:55], v[144:147], v[84:87], v[52:55]
    ds_read_b64_tr_b16 v[144:145], v5 offset:160
    ds_read_b64_tr_b16 v[146:147], v5 offset:672
    v_cvt_pk_bf16_f32 v90, v156, v157
    v_mfma_f32_16x16x32_bf16 v[56:59], v[148:151], v[84:87], v[56:59]
    ds_read_b64_tr_b16 v[148:149], v5 offset:192
    ds_read_b64_tr_b16 v[150:151], v5 offset:704
    v_mfma_f32_16x16x32_bf16 v[60:63], v[152:155], v[84:87], v[60:63]
    ds_read_b64_tr_b16 v[152:153], v5 offset:224
    ds_read_b64_tr_b16 v[154:155], v5 offset:736
    v_cvt_pk_bf16_f32 v91, v158, v159
    s_nop 1
    v_mfma_f32_16x16x32_bf16 v[164:167], v[160:163], v[88:91], 0
    s_waitcnt lgkmcnt(0)
    s_barrier
    s_nop 5
    v_cmp_nge_f32 vcc, s31, v164
    s_cbranch_vccnz Rrare_35
Rback_36:
    v_add_f32 v6, v6, v164
    v_mfma_f32_16x16x32_bf16 v[72:75], v[92:95], v[16:19], v[80:83]
    v_add_u32 v5, s29, v3
    s_add_u32 s29, s29, 8448
    s_cmp_eq_u32 s29, 163584
    s_cselect_b32 s29, 121344, s29
    v_add_u32 v4, s28, v2
    s_add_u32 s28, s28, 8448
    s_cmp_eq_u32 s28, 42240
    s_cselect_b32 s28, 0, s28
    ds_read_b128 v[92:95], v4 offset:0
    v_exp_f32 v156, v64
    v_mfma_f32_16x16x32_bf16 v[72:75], v[96:99], v[20:23], v[72:75]
    ds_read_b128 v[96:99], v4 offset:64
    v_exp_f32 v157, v65
    v_mfma_f32_16x16x32_bf16 v[72:75], v[100:103], v[24:27], v[72:75]
    ds_read_b128 v[100:103], v4 offset:128
    v_exp_f32 v158, v66
    v_mfma_f32_16x16x32_bf16 v[72:75], v[104:107], v[28:31], v[72:75]
    ds_read_b128 v[104:107], v4 offset:192
    v_exp_f32 v159, v67
    v_mfma_f32_16x16x32_bf16 v[76:79], v[108:111], v[16:19], v[80:83]
    ds_read_b128 v[108:111], v4 offset:512
    v_cvt_pk_bf16_f32 v84, v156, v157
    v_mfma_f32_16x16x32_bf16 v[76:79], v[112:115], v[20:23], v[76:79]
    ds_read_b128 v[112:115], v4 offset:576
    v_exp_f32 v156, v68
    v_mfma_f32_16x16x32_bf16 v[76:79], v[116:119], v[24:27], v[76:79]
    ds_read_b128 v[116:119], v4 offset:640
    v_exp_f32 v157, v69
    v_mfma_f32_16x16x32_bf16 v[76:79], v[120:123], v[28:31], v[76:79]
    ds_read_b128 v[120:123], v4 offset:704
    v_cvt_pk_bf16_f32 v85, v158, v159
    v_mfma_f32_16x16x32_bf16 v[32:35], v[124:127], v[88:91], v[32:35]
    ds_read_b64_tr_b16 v[124:125], v5 offset:0
    ds_read_b64_tr_b16 v[126:127], v5 offset:512
    v_mfma_f32_16x16x32_bf16 v[36:39], v[128:131], v[88:91], v[36:39]
    ds_read_b64_tr_b16 v[128:129], v5 offset:32
    ds_read_b64_tr_b16 v[130:131], v5 offset:544
    v_exp_f32 v158, v70
    v_mfma_f32_16x16x32_bf16 v[40:43], v[132:135], v[88:91], v[40:43]
    ds_read_b64_tr_b16 v[132:133], v5 offset:64
    ds_read_b64_tr_b16 v[134:135], v5 offset:576
    v_mfma_f32_16x16x32_bf16 v[44:47], v[136:139], v[88:91], v[44:47]
    ds_read_b64_tr_b16 v[136:137], v5 offset:96
    ds_read_b64_tr_b16 v[138:139], v5 offset:608
    v_exp_f32 v159, v71
    v_mfma_f32_16x16x32_bf16 v[48:51], v[140:143], v[88:91], v[48:51]
    ds_read_b64_tr_b16 v[140:141], v5 offset:128
    ds_read_b64_tr_b16 v[142:143], v5 offset:640
    s_add_u32 s32, s30, s27
    s_cmp_lg_u32 s32, 1
    s_cbranch_scc1 Rq_37
    ds_read_b128 v[16:19], v11 offset:39168
    ds_read_b128 v[20:23], v11 offset:39232
    ds_read_b128 v[24:27], v11 offset:39296
    ds_read_b128 v[28:31], v11 offset:39360
Rq_37:
    v_mfma_f32_16x16x32_bf16 v[52:55], v[144:147], v[88:91], v[52:55]
    ds_read_b64_tr_b16 v[144:145], v5 offset:160
    ds_read_b64_tr_b16 v[146:147], v5 offset:672
    v_cvt_pk_bf16_f32 v86, v156, v157
    v_mfma_f32_16x16x32_bf16 v[56:59], v[148:151], v[88:91], v[56:59]
    ds_read_b64_tr_b16 v[148:149], v5 offset:192
    ds_read_b64_tr_b16 v[150:151], v5 offset:704
    v_mfma_f32_16x16x32_bf16 v[60:63], v[152:155], v[88:91], v[60:63]
    ds_read_b64_tr_b16 v[152:153], v5 offset:224
    ds_read_b64_tr_b16 v[154:155], v5 offset:736
    v_cvt_pk_bf16_f32 v87, v158, v159
    s_nop 1
    v_mfma_f32_16x16x32_bf16 v[164:167], v[160:163], v[84:87], 0
    s_waitcnt lgkmcnt(0)
    s_sub_u32 s30, s30, 1
    s_cmp_lg_u32 s30, 0
    s_barrier
    s_cbranch_scc1 R_loop
    s_cmp_lg_u32 s27, 0
    s_cbranch_scc1 R_last
    s_nop 5
    v_cmp_nge_f32 vcc, s31, v164
    s_cbranch_vccnz Rrare_38
Rback_39:
    v_add_f32 v6, v6, v164
    v_mfma_f32_16x16x32_bf16 v[64:67], v[92:95], v[16:19], 0
    v_add_u32 v5, s29, v3
    s_add_u32 s29, s29, 8448
    s_cmp_eq_u32 s29, 163584
    s_cselect_b32 s29, 121344, s29
    v_add_u32 v4, s28, v2
    s_add_u32 s28, s28, 8448
    s_cmp_eq_u32 s28, 42240
    s_cselect_b32 s28, 0, s28
    ds_read_b128 v[92:95], v4 offset:0
    v_exp_f32 v156, v72
    v_mfma_f32_16x16x32_bf16 v[64:67], v[96:99], v[20:23], v[64:67]
    ds_read_b128 v[96:99], v4 offset:64
    v_exp_f32 v157, v73
    v_mfma_f32_16x16x32_bf16 v[64:67], v[100:103], v[24:27], v[64:67]
    ds_read_b128 v[100:103], v4 offset:128
    v_exp_f32 v158, v74
    v_mfma_f32_16x16x32_bf16 v[64:67], v[104:107], v[28:31], v[64:67]
    ds_read_b128 v[104:107], v4 offset:192
    v_exp_f32 v159, v75
    v_mfma_f32_16x16x32_bf16 v[68:71], v[108:111], v[16:19], 0
    ds_read_b128 v[108:111], v4 offset:512
    v_cvt_pk_bf16_f32 v88, v156, v157
    v_mfma_f32_16x16x32_bf16 v[68:71], v[112:115], v[20:23], v[68:71]
    ds_read_b128 v[112:115], v4 offset:576
    v_exp_f32 v156, v76
    v_mfma_f32_16x16x32_bf16 v[68:71], v[116:119], v[24:27], v[68:71]
    ds_read_b128 v[116:119], v4 offset:640
    v_exp_f32 v157, v77
    v_mfma_f32_16x16x32_bf16 v[68:71], v[120:123], v[28:31], v[68:71]
    ds_read_b128 v[120:123], v4 offset:704
    v_cvt_pk_bf16_f32 v89, v158, v159
    v_mfma_f32_16x16x32_bf16 v[32:35], v[124:127], v[84:87], v[32:35]
    ds_read_b64_tr_b16 v[124:125], v5 offset:0
    ds_read_b64_tr_b16 v[126:127], v5 offset:512
    v_mfma_f32_16x16x32_bf16 v[36:39], v[128:131], v[84:87], v[36:39]
    ds_read_b64_tr_b16 v[128:129], v5 offset:32
    ds_read_b64_tr_b16 v[130:131], v5 offset:544
    v_exp_f32 v158, v78
    v_mfma_f32_16x16x32_bf16 v[40:43], v[132:135], v[84:87], v[40:43]
    ds_read_b64_tr_b16 v[132:133], v5 offset:64
    ds_read_b64_tr_b16 v[134:135], v5 offset:576
    v_mfma_f32_16x16x32_bf16 v[44:47], v[136:139], v[84:87], v[44:47]
    ds_read_b64_tr_b16 v[136:137], v5 offset:96
    ds_read_b64_tr_b16 v[138:139], v5 offset:608
    v_exp_f32 v159, v79
    v_mfma_f32_16x16x32_bf16 v[48:51], v[140:143], v[84:87], v[48:51]
    ds_read_b64_tr_b16 v[140:141], v5 offset:128
    ds_read_b64_tr_b16 v[142:143], v5 offset:640
    v_mfma_f32_16x16x32_bf16 v[52:55], v[144:147], v[84:87], v[52:55]
    ds_read_b64_tr_b16 v[144:145], v5 offset:160
    ds_read_b64_tr_b16 v[146:147], v5 offset:672
    v_cvt_pk_bf16_f32 v90, v156, v157
    v_mfma_f32_16x16x32_bf16 v[56:59], v[148:151], v[84:87], v[56:59]
    ds_read_b64_tr_b16 v[148:149], v5 offset:192
    ds_read_b64_tr_b16 v[150:151], v5 offset:704
    v_mfma_f32_16x16x32_bf16 v[60:63], v[152:155], v[84:87], v[60:63]
    ds_read_b64_tr_b16 v[152:153], v5 offset:224
    ds_read_b64_tr_b16 v[154:155], v5 offset:736
    v_cvt_pk_bf16_f32 v91, v158, v159
    s_nop 1
    v_mfma_f32_16x16x32_bf16 v[164:167], v[160:163], v[88:91], 0
    s_waitcnt lgkmcnt(0)
    s_barrier
    s_nop 5
    v_cmp_nge_f32 vcc, s31, v164
    s_cbranch_vccnz Rrare_40
Rback_41:
    v_add_f32 v6, v6, v164
    v_add_u32 v5, s29, v3
    s_add_u32 s29, s29, 8448
    s_cmp_eq_u32 s29, 163584
    s_cselect_b32 s29, 121344, s29
    v_mov_b32 v1, v6
    v_mov_b32 v6, 0
    v_add_u32 v4, s28, v2
    s_add_u32 s28, s28, 8448
    s_cmp_eq_u32 s28, 42240
    s_cselect_b32 s28, 0, s28
    v_mfma_f32_16x16x32_bf16 v[32:35], v[124:127], v[88:91], v[32:35]
    ds_read_b64_tr_b16 v[124:125], v5 offset:0
    ds_read_b64_tr_b16 v[126:127], v5 offset:512
    v_max3_f32 v8, v64, v65, v66
    v_max3_f32 v8, v8, v67, v68
    v_max3_f32 v8, v8, v69, v70
    v_mfma_f32_16x16x32_bf16 v[36:39], v[128:131], v[88:91], v[36:39]
    ds_read_b64_tr_b16 v[128:129], v5 offset:32
    ds_read_b64_tr_b16 v[130:131], v5 offset:544
    v_max_f32 v8, v8, v71
    v_mov_b32 v9, v8
    s_nop 1
    v_permlane16_swap_b32 v8, v9
    s_nop 1
    v_max_f32 v8, v8, v9
    v_mfma_f32_16x16x32_bf16 v[40:43], v[132:135], v[88:91], v[40:43]
    ds_read_b64_tr_b16 v[132:133], v5 offset:64
    ds_read_b64_tr_b16 v[134:135], v5 offset:576
    v_mov_b32 v9, v8
    s_nop 1
    v_permlane32_swap_b32 v8, v9
    s_nop 1
    v_max_f32 v8, v8, v9
    v_sub_f32 v80, 0, v8
    v_mfma_f32_16x16x32_bf16 v[44:47], v[136:139], v[88:91], v[44:47]
    ds_read_b64_tr_b16 v[136:137], v5 offset:96
    ds_read_b64_tr_b16 v[138:139], v5 offset:608
    v_mov_b32 v81, v80
    v_mov_b32 v82, v80
    v_mfma_f32_16x16x32_bf16 v[48:51], v[140:143], v[88:91], v[48:51]
    ds_read_b64_tr_b16 v[140:141], v5 offset:128
    ds_read_b64_tr_b16 v[142:143], v5 offset:640
    v_mov_b32 v83, v80
    v_sub_f32 v64, v64, v8
    v_sub_f32 v65, v65, v8
    v_mfma_f32_16x16x32_bf16 v[52:55], v[144:147], v[88:91], v[52:55]
    ds_read_b64_tr_b16 v[144:145], v5 offset:160
    ds_read_b64_tr_b16 v[146:147], v5 offset:672
    v_sub_f32 v66, v66, v8
    v_sub_f32 v67, v67, v8
    v_mfma_f32_16x16x32_bf16 v[56:59], v[148:151], v[88:91], v[56:59]
    ds_read_b64_tr_b16 v[148:149], v5 offset:192
    ds_read_b64_tr_b16 v[150:151], v5 offset:704
    v_sub_f32 v68, v68, v8
    v_sub_f32 v69, v69, v8
    v_mfma_f32_16x16x32_bf16 v[60:63], v[152:155], v[88:91], v[60:63]
    ds_read_b64_tr_b16 v[152:153], v5 offset:224
    ds_read_b64_tr_b16 v[154:155], v5 offset:736
    v_sub_f32 v70, v70, v8
    v_sub_f32 v71, v71, v8
    s_nop 1
    v_mfma_f32_16x16x32_bf16 v[72:75], v[92:95], v[16:19], v[80:83]
    ds_read_b128 v[92:95], v4 offset:0
    v_mfma_f32_16x16x32_bf16 v[72:75], v[96:99], v[20:23], v[72:75]
    ds_read_b128 v[96:99], v4 offset:64
    v_mfma_f32_16x16x32_bf16 v[72:75], v[100:103], v[24:27], v[72:75]
    ds_read_b128 v[100:103], v4 offset:128
    v_mfma_f32_16x16x32_bf16 v[72:75], v[104:107], v[28:31], v[72:75]
    ds_read_b128 v[104:107], v4 offset:192
    v_mfma_f32_16x16x32_bf16 v[76:79], v[108:111], v[16:19], v[80:83]
    ds_read_b128 v[108:111], v4 offset:512
    v_mfma_f32_16x16x32_bf16 v[76:79], v[112:115], v[20:23], v[76:79]
    ds_read_b128 v[112:115], v4 offset:576
    v_mfma_f32_16x16x32_bf16 v[76:79], v[116:119], v[24:27], v[76:79]
    ds_read_b128 v[116:119], v4 offset:640
    v_exp_f32 v156, v64
    v_mfma_f32_16x16x32_bf16 v[76:79], v[120:123], v[28:31], v[76:79]
    ds_read_b128 v[120:123], v4 offset:704
    v_exp_f32 v157, v65
    v_exp_f32 v158, v66
    v_exp_f32 v159, v67
    v_cvt_pk_bf16_f32 v84, v156, v157
    v_exp_f32 v156, v68
    v_exp_f32 v157, v69
    v_cvt_pk_bf16_f32 v85, v158, v159
    v_exp_f32 v158, v70
    v_exp_f32 v159, v71
    v_cvt_pk_bf16_f32 v86, v156, v157
    v_cvt_pk_bf16_f32 v87, v158, v159
    s_nop 1
    v_mfma_f32_16x16x32_bf16 v[164:167], v[160:163], v[84:87], 0
    s_waitcnt lgkmcnt(0)
    s_barrier
    s_nop 5
    v_cmp_nge_f32 vcc, s31, v164
    s_cbranch_vccnz Rrare_42
Rback_43:
    v_add_f32 v6, v6, v164
    v_mfma_f32_16x16x32_bf16 v[64:67], v[92:95], v[16:19], v[80:83]
    v_add_u32 v5, s29, v3
    s_add_u32 s29, s29, 8448
    s_cmp_eq_u32 s29, 163584
    s_cselect_b32 s29, 121344, s29
    v_add_u32 v4, s28, v2
    s_add_u32 s28, s28, 8448
    s_cmp_eq_u32 s28, 42240
    s_cselect_b32 s28, 0, s28
    ds_read_b128 v[92:95], v4 offset:0
    v_rcp_f32 v1, v1
    s_nop 0
    v_mul_f32 v32, v32, v1
    v_mul_f32 v33, v33, v1
    v_mul_f32 v34, v34, v1
    v_mul_f32 v35, v35, v1
    v_cvt_pk_bf16_f32 v32, v32, v33
    v_cvt_pk_bf16_f32 v33, v34, v35
    ds_write_b64 v10, v[32:33] offset:0
    v_mfma_f32_16x16x32_bf16 v[64:67], v[96:99], v[20:23], v[64:67]
    ds_read_b128 v[96:99], v4 offset:64
    v_mul_f32 v36, v36, v1
    v_mul_f32 v37, v37, v1
    v_mul_f32 v38, v38, v1
    v_mul_f32 v39, v39, v1
    v_cvt_pk_bf16_f32 v36, v36, v37
    v_cvt_pk_bf16_f32 v37, v38, v39
    ds_write_b64 v10, v[36:37] offset:512
    v_mfma_f32_16x16x32_bf16 v[64:67], v[100:103], v[24:27], v[64:67]
    ds_read_b128 v[100:103], v4 offset:128
    v_mul_f32 v40, v40, v1
    v_mul_f32 v41, v41, v1
    v_mul_f32 v42, v42, v1
    v_mul_f32 v43, v43, v1
    v_cvt_pk_bf16_f32 v40, v40, v41
    v_cvt_pk_bf16_f32 v41, v42, v43
    ds_write_b64 v10, v[40:41] offset:9216
    v_mfma_f32_16x16x32_bf16 v[64:67], v[104:107], v[28:31], v[64:67]
    ds_read_b128 v[104:107], v4 offset:192
    v_mul_f32 v44, v44, v1
    v_mul_f32 v45, v45, v1
    v_mul_f32 v46, v46, v1
    v_mul_f32 v47, v47, v1
    v_cvt_pk_bf16_f32 v44, v44, v45
    v_cvt_pk_bf16_f32 v45, v46, v47
    ds_write_b64 v10, v[44:45] offset:9728
    v_mfma_f32_16x16x32_bf16 v[68:71], v[108:111], v[16:19], v[80:83]
    ds_read_b128 v[108:111], v4 offset:512
    v_mul_f32 v48, v48, v1
    v_mul_f32 v49, v49, v1
    v_mul_f32 v50, v50, v1
    v_mul_f32 v51, v51, v1
    v_cvt_pk_bf16_f32 v48, v48, v49
    v_cvt_pk_bf16_f32 v49, v50, v51
    ds_write_b64 v10, v[48:49] offset:18432
    v_mfma_f32_16x16x32_bf16 v[68:71], v[112:115], v[20:23], v[68:71]
    ds_read_b128 v[112:115], v4 offset:576
    v_mul_f32 v52, v52, v1
    v_mul_f32 v53, v53, v1
    v_mul_f32 v54, v54, v1
    v_mul_f32 v55, v55, v1
    v_cvt_pk_bf16_f32 v52, v52, v53
    v_cvt_pk_bf16_f32 v53, v54, v55
    ds_write_b64 v10, v[52:53] offset:18944
    v_mfma_f32_16x16x32_bf16 v[68:71], v[116:119], v[24:27], v[68:71]
    ds_read_b128 v[116:119], v4 offset:640
    v_mul_f32 v56, v56, v1
    v_mul_f32 v57, v57, v1
    v_mul_f32 v58, v58, v1
    v_mul_f32 v59, v59, v1
    v_cvt_pk_bf16_f32 v56, v56, v57
    v_cvt_pk_bf16_f32 v57, v58, v59
    ds_write_b64 v10, v[56:57] offset:27648
    v_mfma_f32_16x16x32_bf16 v[68:71], v[120:123], v[28:31], v[68:71]
    ds_read_b128 v[120:123], v4 offset:704
    v_mul_f32 v60, v60, v1
    v_mul_f32 v61, v61, v1
    v_mul_f32 v62, v62, v1
    v_mul_f32 v63, v63, v1
    v_cvt_pk_bf16_f32 v60, v60, v61
    v_cvt_pk_bf16_f32 v61, v62, v63
    ds_write_b64 v10, v[60:61] offset:28160
    v_mfma_f32_16x16x32_bf16 v[32:35], v[124:127], v[84:87], 0
    ds_read_b64_tr_b16 v[124:125], v5 offset:0
    ds_read_b64_tr_b16 v[126:127], v5 offset:512
    v_mfma_f32_16x16x32_bf16 v[36:39], v[128:131], v[84:87], 0
    ds_read_b64_tr_b16 v[128:129], v5 offset:32
    ds_read_b64_tr_b16 v[130:131], v5 offset:544
    v_mfma_f32_16x16x32_bf16 v[40:43], v[132:135], v[84:87], 0
    ds_read_b64_tr_b16 v[132:133], v5 offset:64
    ds_read_b64_tr_b16 v[134:135], v5 offset:576
    v_exp_f32 v156, v72
    v_mfma_f32_16x16x32_bf16 v[44:47], v[136:139], v[84:87], 0
    ds_read_b64_tr_b16 v[136:137], v5 offset:96
    ds_read_b64_tr_b16 v[138:139], v5 offset:608
    v_exp_f32 v157, v73
    v_exp_f32 v158, v74
    v_mfma_f32_16x16x32_bf16 v[48:51], v[140:143], v[84:87], 0
    ds_read_b64_tr_b16 v[140:141], v5 offset:128
    ds_read_b64_tr_b16 v[142:143], v5 offset:640
    v_exp_f32 v159, v75
    v_cvt_pk_bf16_f32 v88, v156, v157
    v_mfma_f32_16x16x32_bf16 v[52:55], v[144:147], v[84:87], 0
    ds_read_b64_tr_b16 v[144:145], v5 offset:160
    ds_read_b64_tr_b16 v[146:147], v5 offset:672
    v_exp_f32 v156, v76
    v_exp_f32 v157, v77
    v_mfma_f32_16x16x32_bf16 v[56:59], v[148:151], v[84:87], 0
    ds_read_b64_tr_b16 v[148:149], v5 offset:192
    ds_read_b64_tr_b16 v[150:151], v5 offset:704
    v_cvt_pk_bf16_f32 v89, v158, v159
    v_exp_f32 v158, v78
    v_mfma_f32_16x16x32_bf16 v[60:63], v[152:155], v[84:87], 0
    ds_read_b64_tr_b16 v[152:153], v5 offset:224
    ds_read_b64_tr_b16 v[154:155], v5 offset:736
    v_exp_f32 v159, v79
    v_cvt_pk_bf16_f32 v90, v156, v157
    v_cvt_pk_bf16_f32 v91, v158, v159
    s_nop 1
    v_mfma_f32_16x16x32_bf16 v[164:167], v[160:163], v[88:91], 0
    s_waitcnt lgkmcnt(0)
    s_barrier
    s_nop 5
    v_cmp_nge_f32 vcc, s31, v164
    s_cbranch_vccnz Rrare_44
Rback_45:
    v_add_f32 v6, v6, v164
    v_mfma_f32_16x16x32_bf16 v[72:75], v[92:95], v[16:19], v[80:83]
    v_add_u32 v5, s29, v3
    s_add_u32 s29, s29, 8448
    s_cmp_eq_u32 s29, 163584
    s_cselect_b32 s29, 121344, s29
    v_add_u32 v4, s28, v2
    s_add_u32 s28, s28, 8448
    s_cmp_eq_u32 s28, 42240
    s_cselect_b32 s28, 0, s28
    ds_read_b128 v[92:95], v4 offset:0
    v_exp_f32 v156, v64
    v_mfma_f32_16x16x32_bf16 v[72:75], v[96:99], v[20:23], v[72:75]
    ds_read_b128 v[96:99], v4 offset:64
    v_exp_f32 v157, v65
    v_mfma_f32_16x16x32_bf16 v[72:75], v[100:103], v[24:27], v[72:75]
    ds_read_b128 v[100:103], v4 offset:128
    v_exp_f32 v158, v66
    v_mfma_f32_16x16x32_bf16 v[72:75], v[104:107], v[28:31], v[72:75]
    ds_read_b128 v[104:107], v4 offset:192
    v_exp_f32 v159, v67
    v_mfma_f32_16x16x32_bf16 v[76:79], v[108:111], v[16:19], v[80:83]
    ds_read_b128 v[108:111], v4 offset:512
    v_cvt_pk_bf16_f32 v84, v156, v157
    v_mfma_f32_16x16x32_bf16 v[76:79], v[112:115], v[20:23], v[76:79]
    ds_read_b128 v[112:115], v4 offset:576
    v_exp_f32 v156, v68
    v_mfma_f32_16x16x32_bf16 v[76:79], v[116:119], v[24:27], v[76:79]
    ds_read_b128 v[116:119], v4 offset:640
    v_exp_f32 v157, v69
    v_mfma_f32_16x16x32_bf16 v[76:79], v[120:123], v[28:31], v[76:79]
    ds_read_b128 v[120:123], v4 offset:704
    v_cvt_pk_bf16_f32 v85, v158, v159
    v_mfma_f32_16x16x32_bf16 v[32:35], v[124:127], v[88:91], v[32:35]
    ds_read_b64_tr_b16 v[124:125], v5 offset:0
    ds_read_b64_tr_b16 v[126:127], v5 offset:512
    v_mfma_f32_16x16x32_bf16 v[36:39], v[128:131], v[88:91], v[36:39]
    ds_read_b64_tr_b16 v[128:129], v5 offset:32
    ds_read_b64_tr_b16 v[130:131], v5 offset:544
    v_exp_f32 v158, v70
    v_mfma_f32_16x16x32_bf16 v[40:43], v[132:135], v[88:91], v[40:43]
    ds_read_b64_tr_b16 v[132:133], v5 offset:64
    ds_read_b64_tr_b16 v[134:135], v5 offset:576
    v_mfma_f32_16x16x32_bf16 v[44:47], v[136:139], v[88:91], v[44:47]
    ds_read_b64_tr_b16 v[136:137], v5 offset:96
    ds_read_b64_tr_b16 v[138:139], v5 offset:608
    v_exp_f32 v159, v71
    v_mfma_f32_16x16x32_bf16 v[48:51], v[140:143], v[88:91], v[48:51]
    ds_read_b64_tr_b16 v[140:141], v5 offset:128
    ds_read_b64_tr_b16 v[142:143], v5 offset:640
    v_mfma_f32_16x16x32_bf16 v[52:55], v[144:147], v[88:91], v[52:55]
    ds_read_b64_tr_b16 v[144:145], v5 offset:160
    ds_read_b64_tr_b16 v[146:147], v5 offset:672
    v_cvt_pk_bf16_f32 v86, v156, v157
    v_mfma_f32_16x16x32_bf16 v[56:59], v[148:151], v[88:91], v[56:59]
    ds_read_b64_tr_b16 v[148:149], v5 offset:192
    ds_read_b64_tr_b16 v[150:151], v5 offset:704
    v_mfma_f32_16x16x32_bf16 v[60:63], v[152:155], v[88:91], v[60:63]
    ds_read_b64_tr_b16 v[152:153], v5 offset:224
    ds_read_b64_tr_b16 v[154:155], v5 offset:736
    v_cvt_pk_bf16_f32 v87, v158, v159
    s_nop 1
    v_mfma_f32_16x16x32_bf16 v[164:167], v[160:163], v[84:87], 0
    s_waitcnt lgkmcnt(0)
    s_barrier
    s_mov_b32 s30, 14
    s_mov_b32 s27, 100
    s_branch R_loop
R_last:
    s_nop 5
    v_cmp_nge_f32 vcc, s31, v164
    s_cbranch_vccnz Rrare_46
Rback_47:
    v_add_f32 v6, v6, v164
    v_add_u32 v5, s29, v3
    s_add_u32 s29, s29, 8448
    s_cmp_eq_u32 s29, 163584
    s_cselect_b32 s29, 121344, s29
    v_mfma_f32_16x16x32_bf16 v[32:35], v[124:127], v[84:87], v[32:35]
    ds_read_b64_tr_b16 v[124:125], v5 offset:0
    ds_read_b64_tr_b16 v[126:127], v5 offset:512
    v_mfma_f32_16x16x32_bf16 v[36:39], v[128:131], v[84:87], v[36:39]
    ds_read_b64_tr_b16 v[128:129], v5 offset:32
    ds_read_b64_tr_b16 v[130:131], v5 offset:544
    v_exp_f32 v156, v72
    v_mfma_f32_16x16x32_bf16 v[40:43], v[132:135], v[84:87], v[40:43]
    ds_read_b64_tr_b16 v[132:133], v5 offset:64
    ds_read_b64_tr_b16 v[134:135], v5 offset:576
    v_mfma_f32_16x16x32_bf16 v[44:47], v[136:139], v[84:87], v[44:47]
    ds_read_b64_tr_b16 v[136:137], v5 offset:96
    ds_read_b64_tr_b16 v[138:139], v5 offset:608
    v_mfma_f32_16x16x32_bf16 v[48:51], v[140:143], v[84:87], v[48:51]
    ds_read_b64_tr_b16 v[140:141], v5 offset:128
    ds_read_b64_tr_b16 v[142:143], v5 offset:640
    v_mfma_f32_16x16x32_bf16 v[52:55], v[144:147], v[84:87], v[52:55]
    ds_read_b64_tr_b16 v[144:145], v5 offset:160
    ds_read_b64_tr_b16 v[146:147], v5 offset:672
    v_exp_f32 v157, v73
    v_mfma_f32_16x16x32_bf16 v[56:59], v[148:151], v[84:87], v[56:59]
    ds_read_b64_tr_b16 v[148:149], v5 offset:192
    ds_read_b64_tr_b16 v[150:151], v5 offset:704
    v_mfma_f32_16x16x32_bf16 v[60:63], v[152:155], v[84:87], v[60:63]
    ds_read_b64_tr_b16 v[152:153], v5 offset:224
    ds_read_b64_tr_b16 v[154:155], v5 offset:736
    v_exp_f32 v158, v74
    v_exp_f32 v159, v75
    v_cvt_pk_bf16_f32 v88, v156, v157
    v_exp_f32 v156, v76
    v_exp_f32 v157, v77
    v_cvt_pk_bf16_f32 v89, v158, v159
    v_exp_f32 v158, v78
    v_exp_f32 v159, v79
    v_cvt_pk_bf16_f32 v90, v156, v157
    v_cvt_pk_bf16_f32 v91, v158, v159
    s_nop 1
    v_mfma_f32_16x16x32_bf16 v[164:167], v[160:163], v[88:91], 0
    s_waitcnt lgkmcnt(0)
    s_waitcnt vmcnt(0)
    s_and_b32 s44, s3, 3
    s_lshr_b32 s45, s3, 2
    s_mul_i32 s58, s45, 18432
    s_add_u32 s55, s69, s56
    s_mov_b32 s13, 0
    s_lshl_b32 s47, s71, 4
    s_mul_i32 s32, s70, 6
    s_lshl_b32 s33, s44, 1
    s_add_u32 s32, s32, s33
    s_add_u32 s32, s32, 0
    s_mul_i32 s74, s32, 40960
    s_mul_i32 s33, s32, 57
    s_lshr_b32 s33, s33, 9
    s_mul_i32 s34, s33, 9
    s_sub_u32 s32, s32, s34
    s_lshl_b32 s32, s32, 10
    s_lshl_b32 s34, s26, 3
    s_add_u32 s33, s33, s34
    s_mul_i32 s34, s33, 1179648
    s_add_u32 s32, s32, s34
    v_lshl_add_u32 v2, v0, 4, s32
    s_lshl_b32 s72, s33, 9
    s_mul_i32 s32, s70, 6
    s_lshl_b32 s33, s44, 1
    s_add_u32 s32, s32, s33
    s_add_u32 s32, s32, 1
    s_mul_i32 s75, s32, 40960
    s_mul_i32 s33, s32, 57
    s_lshr_b32 s33, s33, 9
    s_mul_i32 s34, s33, 9
    s_sub_u32 s32, s32, s34
    s_lshl_b32 s32, s32, 10
    s_lshl_b32 s34, s26, 3
    s_add_u32 s33, s33, s34
    s_mul_i32 s34, s33, 1179648
    s_add_u32 s32, s32, s34
    v_lshl_add_u32 v3, v0, 4, s32
    s_lshl_b32 s73, s33, 9
    v_subrev_u32 v10, 42240, v10
    s_barrier
    s_nop 5
    v_cmp_nge_f32 vcc, s31, v164
    s_cbranch_vccnz Rrare_48
Rback_49:
    v_add_f32 v6, v6, v164
    v_mfma_f32_16x16x32_bf16 v[32:35], v[124:127], v[88:91], v[32:35]
    v_mfma_f32_16x16x32_bf16 v[36:39], v[128:131], v[88:91], v[36:39]
    v_mfma_f32_16x16x32_bf16 v[40:43], v[132:135], v[88:91], v[40:43]
    v_mfma_f32_16x16x32_bf16 v[44:47], v[136:139], v[88:91], v[44:47]
    v_mfma_f32_16x16x32_bf16 v[48:51], v[140:143], v[88:91], v[48:51]
    v_mfma_f32_16x16x32_bf16 v[52:55], v[144:147], v[88:91], v[52:55]
    v_mfma_f32_16x16x32_bf16 v[56:59], v[148:151], v[88:91], v[56:59]
    v_mfma_f32_16x16x32_bf16 v[60:63], v[152:155], v[88:91], v[60:63]
    s_nop 15
    v_rcp_f32 v6, v6
    s_nop 0
    v_mul_f32 v32, v32, v6
    v_mul_f32 v33, v33, v6
    v_mul_f32 v34, v34, v6
    v_mul_f32 v35, v35, v6
    v_cvt_pk_bf16_f32 v32, v32, v33
    v_cvt_pk_bf16_f32 v33, v34, v35
    ds_write_b64 v10, v[32:33] offset:0
    v_mul_f32 v36, v36, v6
    v_mul_f32 v37, v37, v6
    v_mul_f32 v38, v38, v6
    v_mul_f32 v39, v39, v6
    v_cvt_pk_bf16_f32 v36, v36, v37
    v_cvt_pk_bf16_f32 v37, v38, v39
    ds_write_b64 v10, v[36:37] offset:512
    v_mul_f32 v40, v40, v6
    v_mul_f32 v41, v41, v6
    v_mul_f32 v42, v42, v6
    v_mul_f32 v43, v43, v6
    v_cvt_pk_bf16_f32 v40, v40, v41
    v_cvt_pk_bf16_f32 v41, v42, v43
    ds_write_b64 v10, v[40:41] offset:9216
    v_mul_f32 v44, v44, v6
    v_mul_f32 v45, v45, v6
    v_mul_f32 v46, v46, v6
    v_mul_f32 v47, v47, v6
    v_cvt_pk_bf16_f32 v44, v44, v45
    v_cvt_pk_bf16_f32 v45, v46, v47
    ds_write_b64 v10, v[44:45] offset:9728
    v_mul_f32 v48, v48, v6
    v_mul_f32 v49, v49, v6
    v_mul_f32 v50, v50, v6
    v_mul_f32 v51, v51, v6
    v_cvt_pk_bf16_f32 v48, v48, v49
    v_cvt_pk_bf16_f32 v49, v50, v51
    ds_write_b64 v10, v[48:49] offset:18432
    v_mul_f32 v52, v52, v6
    v_mul_f32 v53, v53, v6
    v_mul_f32 v54, v54, v6
    v_mul_f32 v55, v55, v6
    v_cvt_pk_bf16_f32 v52, v52, v53
    v_cvt_pk_bf16_f32 v53, v54, v55
    ds_write_b64 v10, v[52:53] offset:18944
    v_mul_f32 v56, v56, v6
    v_mul_f32 v57, v57, v6
    v_mul_f32 v58, v58, v6
    v_mul_f32 v59, v59, v6
    v_cvt_pk_bf16_f32 v56, v56, v57
    v_cvt_pk_bf16_f32 v57, v58, v59
    ds_write_b64 v10, v[56:57] offset:27648
    v_mul_f32 v60, v60, v6
    v_mul_f32 v61, v61, v6
    v_mul_f32 v62, v62, v6
    v_mul_f32 v63, v63, v6
    v_cvt_pk_bf16_f32 v60, v60, v61
    v_cvt_pk_bf16_f32 v61, v62, v63
    ds_write_b64 v10, v[60:61] offset:28160
    s_waitcnt lgkmcnt(0)
    s_setprio 0
    s_branch L_tail
Rrare_29:
    s_nop 15
    s_nop 7
    v_max3_f32 v8, v64, v65, v66
    v_max3_f32 v8, v8, v67, v68
    v_max3_f32 v8, v8, v69, v70
    v_max_f32 v8, v8, v71
    v_mov_b32 v9, v8
    s_nop 1
    v_permlane16_swap_b32 v8, v9
    s_nop 1
    v_max_f32 v8, v8, v9
    v_mov_b32 v9, v8
    s_nop 1
    v_permlane32_swap_b32 v8, v9
    s_nop 1
    v_max_f32 v8, v8, v9
    v_max_f32 v8, 0, v8
    v_sub_f32 v9, 0, v8
    v_exp_f32 v9, v9
    s_nop 0
    v_mul_f32 v6, v6, v9
    v_sub_f32 v80, v80, v8
    v_sub_f32 v81, v81, v8
    v_sub_f32 v82, v82, v8
    v_sub_f32 v83, v83, v8
    v_sub_f32 v64, v64, v8
    v_sub_f32 v65, v65, v8
    v_sub_f32 v66, v66, v8
    v_sub_f32 v67, v67, v8
    v_sub_f32 v68, v68, v8
    v_sub_f32 v69, v69, v8
    v_sub_f32 v70, v70, v8
    v_sub_f32 v71, v71, v8
    v_sub_f32 v72, v72, v8
    v_sub_f32 v73, v73, v8
    v_sub_f32 v74, v74, v8
    v_sub_f32 v75, v75, v8
    v_sub_f32 v76, v76, v8
    v_sub_f32 v77, v77, v8
    v_sub_f32 v78, v78, v8
    v_sub_f32 v79, v79, v8
    v_exp_f32 v156, v64
    s_nop 0
    v_exp_f32 v157, v65
    s_nop 0
    v_exp_f32 v158, v66
    s_nop 0
    v_exp_f32 v159, v67
    s_nop 0
    v_cvt_pk_bf16_f32 v84, v156, v157
    v_exp_f32 v156, v68
    s_nop 0
    v_exp_f32 v157, v69
    s_nop 0
    v_cvt_pk_bf16_f32 v85, v158, v159
    v_exp_f32 v158, v70
    s_nop 0
    v_exp_f32 v159, v71
    s_nop 0
    v_cvt_pk_bf16_f32 v86, v156, v157
    v_cvt_pk_bf16_f32 v87, v158, v159
    s_nop 1
    v_mfma_f32_16x16x32_bf16 v[164:167], v[160:163], v[84:87], 0
    s_nop 8
    s_nop 1
    s_branch Rback_30
Rrare_31:
    s_nop 15
    s_nop 7
    v_max3_f32 v8, v72, v73, v74
    v_max3_f32 v8, v8, v75, v76
    v_max3_f32 v8, v8, v77, v78
    v_max_f32 v8, v8, v79
    v_mov_b32 v9, v8
    s_nop 1
    v_permlane16_swap_b32 v8, v9
    s_nop 1
    v_max_f32 v8, v8, v9
    v_mov_b32 v9, v8
    s_nop 1
    v_permlane32_swap_b32 v8, v9
    s_nop 1
    v_max_f32 v8, v8, v9
    v_max_f32 v8, 0, v8
    v_sub_f32 v9, 0, v8
    v_exp_f32 v9, v9
    s_nop 0
    v_mul_f32 v32, v32, v9
    v_mul_f32 v33, v33, v9
    v_mul_f32 v34, v34, v9
    v_mul_f32 v35, v35, v9
    v_mul_f32 v36, v36, v9
    v_mul_f32 v37, v37, v9
    v_mul_f32 v38, v38, v9
    v_mul_f32 v39, v39, v9
    v_mul_f32 v40, v40, v9
    v_mul_f32 v41, v41, v9
    v_mul_f32 v42, v42, v9
    v_mul_f32 v43, v43, v9
    v_mul_f32 v44, v44, v9
    v_mul_f32 v45, v45, v9
    v_mul_f32 v46, v46, v9
    v_mul_f32 v47, v47, v9
    v_mul_f32 v48, v48, v9
    v_mul_f32 v49, v49, v9
    v_mul_f32 v50, v50, v9
    v_mul_f32 v51, v51, v9
    v_mul_f32 v52, v52, v9
    v_mul_f32 v53, v53, v9
    v_mul_f32 v54, v54, v9
    v_mul_f32 v55, v55, v9
    v_mul_f32 v56, v56, v9
    v_mul_f32 v57, v57, v9
    v_mul_f32 v58, v58, v9
    v_mul_f32 v59, v59, v9
    v_mul_f32 v60, v60, v9
    v_mul_f32 v61, v61, v9
    v_mul_f32 v62, v62, v9
    v_mul_f32 v63, v63, v9
    v_mul_f32 v6, v6, v9
    v_sub_f32 v80, v80, v8
    v_sub_f32 v81, v81, v8
    v_sub_f32 v82, v82, v8
    v_sub_f32 v83, v83, v8
    v_sub_f32 v72, v72, v8
    v_sub_f32 v73, v73, v8
    v_sub_f32 v74, v74, v8
    v_sub_f32 v75, v75, v8
    v_sub_f32 v76, v76, v8
    v_sub_f32 v77, v77, v8
    v_sub_f32 v78, v78, v8
    v_sub_f32 v79, v79, v8
    v_sub_f32 v64, v64, v8
    v_sub_f32 v65, v65, v8
    v_sub_f32 v66, v66, v8
    v_sub_f32 v67, v67, v8
    v_sub_f32 v68, v68, v8
    v_sub_f32 v69, v69, v8
    v_sub_f32 v70, v70, v8
    v_sub_f32 v71, v71, v8
    v_exp_f32 v156, v72
    s_nop 0
    v_exp_f32 v157, v73
    s_nop 0
    v_exp_f32 v158, v74
    s_nop 0
    v_exp_f32 v159, v75
    s_nop 0
    v_cvt_pk_bf16_f32 v88, v156, v157
    v_exp_f32 v156, v76
    s_nop 0
    v_exp_f32 v157, v77
    s_nop 0
    v_cvt_pk_bf16_f32 v89, v158, v159
    v_exp_f32 v158, v78
    s_nop 0
    v_exp_f32 v159, v79
    s_nop 0
    v_cvt_pk_bf16_f32 v90, v156, v157
    v_cvt_pk_bf16_f32 v91, v158, v159
    s_nop 1
    v_mfma_f32_16x16x32_bf16 v[164:167], v[160:163], v[88:91], 0
    s_nop 8
    s_nop 1
    s_branch Rback_32
Rrare_33:
    s_nop 15
    s_nop 7
    v_max3_f32 v8, v64, v65, v66
    v_max3_f32 v8, v8, v67, v68
    v_max3_f32 v8, v8, v69, v70
    v_max_f32 v8, v8, v71
    v_mov_b32 v9, v8
    s_nop 1
    v_permlane16_swap_b32 v8, v9
    s_nop 1
    v_max_f32 v8, v8, v9
    v_mov_b32 v9, v8
    s_nop 1
    v_permlane32_swap_b32 v8, v9
    s_nop 1
    v_max_f32 v8, v8, v9
    v_max_f32 v8, 0, v8
    v_sub_f32 v9, 0, v8
    v_exp_f32 v9, v9
    s_nop 0
    v_mul_f32 v32, v32, v9
    v_mul_f32 v33, v33, v9
    v_mul_f32 v34, v34, v9
    v_mul_f32 v35, v35, v9
    v_mul_f32 v36, v36, v9
    v_mul_f32 v37, v37, v9
    v_mul_f32 v38, v38, v9
    v_mul_f32 v39, v39, v9
    v_mul_f32 v40, v40, v9
    v_mul_f32 v41, v41, v9
    v_mul_f32 v42, v42, v9
    v_mul_f32 v43, v43, v9
    v_mul_f32 v44, v44, v9
    v_mul_f32 v45, v45, v9
    v_mul_f32 v46, v46, v9
    v_mul_f32 v47, v47, v9
    v_mul_f32 v48, v48, v9
    v_mul_f32 v49, v49, v9
    v_mul_f32 v50, v50, v9
    v_mul_f32 v51, v51, v9
    v_mul_f32 v52, v52, v9
    v_mul_f32 v53, v53, v9
    v_mul_f32 v54, v54, v9
    v_mul_f32 v55, v55, v9
    v_mul_f32 v56, v56, v9
    v_mul_f32 v57, v57, v9
    v_mul_f32 v58, v58, v9
    v_mul_f32 v59, v59, v9
    v_mul_f32 v60, v60, v9
    v_mul_f32 v61, v61, v9
    v_mul_f32 v62, v62, v9
    v_mul_f32 v63, v63, v9
    v_mul_f32 v6, v6, v9
    v_sub_f32 v80, v80, v8
    v_sub_f32 v81, v81, v8
    v_sub_f32 v82, v82, v8
    v_sub_f32 v83, v83, v8
    v_sub_f32 v64, v64, v8
    v_sub_f32 v65, v65, v8
    v_sub_f32 v66, v66, v8
    v_sub_f32 v67, v67, v8
    v_sub_f32 v68, v68, v8
    v_sub_f32 v69, v69, v8
    v_sub_f32 v70, v70, v8
    v_sub_f32 v71, v71, v8
    v_sub_f32 v72, v72, v8
    v_sub_f32 v73, v73, v8
    v_sub_f32 v74, v74, v8
    v_sub_f32 v75, v75, v8
    v_sub_f32 v76, v76, v8
    v_sub_f32 v77, v77, v8
    v_sub_f32 v78, v78, v8
    v_sub_f32 v79, v79, v8
    v_exp_f32 v156, v64
    s_nop 0
    v_exp_f32 v157, v65
    s_nop 0
    v_exp_f32 v158, v66
    s_nop 0
    v_exp_f32 v159, v67
    s_nop 0
    v_cvt_pk_bf16_f32 v84, v156, v157
    v_exp_f32 v156, v68
    s_nop 0
    v_exp_f32 v157, v69
    s_nop 0
    v_cvt_pk_bf16_f32 v85, v158, v159
    v_exp_f32 v158, v70
    s_nop 0
    v_exp_f32 v159, v71
    s_nop 0
    v_cvt_pk_bf16_f32 v86, v156, v157
    v_cvt_pk_bf16_f32 v87, v158, v159
    s_nop 1
    v_mfma_f32_16x16x32_bf16 v[164:167], v[160:163], v[84:87], 0
    s_nop 8
    s_nop 1
    s_branch Rback_34
Rrare_35:
    s_nop 15
    s_nop 7
    v_max3_f32 v8, v72, v73, v74
    v_max3_f32 v8, v8, v75, v76
    v_max3_f32 v8, v8, v77, v78
    v_max_f32 v8, v8, v79
    v_mov_b32 v9, v8
    s_nop 1
    v_permlane16_swap_b32 v8, v9
    s_nop 1
    v_max_f32 v8, v8, v9
    v_mov_b32 v9, v8
    s_nop 1
    v_permlane32_swap_b32 v8, v9
    s_nop 1
    v_max_f32 v8, v8, v9
    v_max_f32 v8, 0, v8
    v_sub_f32 v9, 0, v8
    v_exp_f32 v9, v9
    s_nop 0
    v_mul_f32 v32, v32, v9
    v_mul_f32 v33, v33, v9
    v_mul_f32 v34, v34, v9
    v_mul_f32 v35, v35, v9
    v_mul_f32 v36, v36, v9
    v_mul_f32 v37, v37, v9
    v_mul_f32 v38, v38, v9
    v_mul_f32 v39, v39, v9
    v_mul_f32 v40, v40, v9
    v_mul_f32 v41, v41, v9
    v_mul_f32 v42, v42, v9
    v_mul_f32 v43, v43, v9
    v_mul_f32 v44, v44, v9
    v_mul_f32 v45, v45, v9
    v_mul_f32 v46, v46, v9
    v_mul_f32 v47, v47, v9
    v_mul_f32 v48, v48, v9
    v_mul_f32 v49, v49, v9
    v_mul_f32 v50, v50, v9
    v_mul_f32 v51, v51, v9
    v_mul_f32 v52, v52, v9
    v_mul_f32 v53, v53, v9
    v_mul_f32 v54, v54, v9
    v_mul_f32 v55, v55, v9
    v_mul_f32 v56, v56, v9
    v_mul_f32 v57, v57, v9
    v_mul_f32 v58, v58, v9
    v_mul_f32 v59, v59, v9
    v_mul_f32 v60, v60, v9
    v_mul_f32 v61, v61, v9
    v_mul_f32 v62, v62, v9
    v_mul_f32 v63, v63, v9
    v_mul_f32 v6, v6, v9
    v_sub_f32 v80, v80, v8
    v_sub_f32 v81, v81, v8
    v_sub_f32 v82, v82, v8
    v_sub_f32 v83, v83, v8
    v_sub_f32 v72, v72, v8
    v_sub_f32 v73, v73, v8
    v_sub_f32 v74, v74, v8
    v_sub_f32 v75, v75, v8
    v_sub_f32 v76, v76, v8
    v_sub_f32 v77, v77, v8
    v_sub_f32 v78, v78, v8
    v_sub_f32 v79, v79, v8
    v_sub_f32 v64, v64, v8
    v_sub_f32 v65, v65, v8
    v_sub_f32 v66, v66, v8
    v_sub_f32 v67, v67, v8
    v_sub_f32 v68, v68, v8
    v_sub_f32 v69, v69, v8
    v_sub_f32 v70, v70, v8
    v_sub_f32 v71, v71, v8
    v_exp_f32 v156, v72
    s_nop 0
    v_exp_f32 v157, v73
    s_nop 0
    v_exp_f32 v158, v74
    s_nop 0
    v_exp_f32 v159, v75
    s_nop 0
    v_cvt_pk_bf16_f32 v88, v156, v157
    v_exp_f32 v156, v76
    s_nop 0
    v_exp_f32 v157, v77
    s_nop 0
    v_cvt_pk_bf16_f32 v89, v158, v159
    v_exp_f32 v158, v78
    s_nop 0
    v_exp_f32 v159, v79
    s_nop 0
    v_cvt_pk_bf16_f32 v90, v156, v157
    v_cvt_pk_bf16_f32 v91, v158, v159
    s_nop 1
    v_mfma_f32_16x16x32_bf16 v[164:167], v[160:163], v[88:91], 0
    s_nop 8
    s_nop 1
    s_branch Rback_36
Rrare_38:
    s_nop 15
    s_nop 7
    v_max3_f32 v8, v64, v65, v66
    v_max3_f32 v8, v8, v67, v68
    v_max3_f32 v8, v8, v69, v70
    v_max_f32 v8, v8, v71
    v_mov_b32 v9, v8
    s_nop 1
    v_permlane16_swap_b32 v8, v9
    s_nop 1
    v_max_f32 v8, v8, v9
    v_mov_b32 v9, v8
    s_nop 1
    v_permlane32_swap_b32 v8, v9
    s_nop 1
    v_max_f32 v8, v8, v9
    v_max_f32 v8, 0, v8
    v_sub_f32 v9, 0, v8
    v_exp_f32 v9, v9
    s_nop 0
    v_mul_f32 v32, v32, v9
    v_mul_f32 v33, v33, v9
    v_mul_f32 v34, v34, v9
    v_mul_f32 v35, v35, v9
    v_mul_f32 v36, v36, v9
    v_mul_f32 v37, v37, v9
    v_mul_f32 v38, v38, v9
    v_mul_f32 v39, v39, v9
    v_mul_f32 v40, v40, v9
    v_mul_f32 v41, v41, v9
    v_mul_f32 v42, v42, v9
    v_mul_f32 v43, v43, v9
    v_mul_f32 v44, v44, v9
    v_mul_f32 v45, v45, v9
    v_mul_f32 v46, v46, v9
    v_mul_f32 v47, v47, v9
    v_mul_f32 v48, v48, v9
    v_mul_f32 v49, v49, v9
    v_mul_f32 v50, v50, v9
    v_mul_f32 v51, v51, v9
    v_mul_f32 v52, v52, v9
    v_mul_f32 v53, v53, v9
    v_mul_f32 v54, v54, v9
    v_mul_f32 v55, v55, v9
    v_mul_f32 v56, v56, v9
    v_mul_f32 v57, v57, v9
    v_mul_f32 v58, v58, v9
    v_mul_f32 v59, v59, v9
    v_mul_f32 v60, v60, v9
    v_mul_f32 v61, v61, v9
    v_mul_f32 v62, v62, v9
    v_mul_f32 v63, v63, v9
    v_mul_f32 v6, v6, v9
    v_sub_f32 v80, v80, v8
    v_sub_f32 v81, v81, v8
    v_sub_f32 v82, v82, v8
    v_sub_f32 v83, v83, v8
    v_sub_f32 v64, v64, v8
    v_sub_f32 v65, v65, v8
    v_sub_f32 v66, v66, v8
    v_sub_f32 v67, v67, v8
    v_sub_f32 v68, v68, v8
    v_sub_f32 v69, v69, v8
    v_sub_f32 v70, v70, v8
    v_sub_f32 v71, v71, v8
    v_sub_f32 v72, v72, v8
    v_sub_f32 v73, v73, v8
    v_sub_f32 v74, v74, v8
    v_sub_f32 v75, v75, v8
    v_sub_f32 v76, v76, v8
    v_sub_f32 v77, v77, v8
    v_sub_f32 v78, v78, v8
    v_sub_f32 v79, v79, v8
    v_exp_f32 v156, v64
    s_nop 0
    v_exp_f32 v157, v65
    s_nop 0
    v_exp_f32 v158, v66
    s_nop 0
    v_exp_f32 v159, v67
    s_nop 0
    v_cvt_pk_bf16_f32 v84, v156, v157
    v_exp_f32 v156, v68
    s_nop 0
    v_exp_f32 v157, v69
    s_nop 0
    v_cvt_pk_bf16_f32 v85, v158, v159
    v_exp_f32 v158, v70
    s_nop 0
    v_exp_f32 v159, v71
    s_nop 0
    v_cvt_pk_bf16_f32 v86, v156, v157
    v_cvt_pk_bf16_f32 v87, v158, v159
    s_nop 1
    v_mfma_f32_16x16x32_bf16 v[164:167], v[160:163], v[84:87], 0
    s_nop 8
    s_nop 1
    s_branch Rback_39
Rrare_40:
    s_nop 15
    s_nop 7
    v_max3_f32 v8, v72, v73, v74
    v_max3_f32 v8, v8, v75, v76
    v_max3_f32 v8, v8, v77, v78
    v_max_f32 v8, v8, v79
    v_mov_b32 v9, v8
    s_nop 1
    v_permlane16_swap_b32 v8, v9
    s_nop 1
    v_max_f32 v8, v8, v9
    v_mov_b32 v9, v8
    s_nop 1
    v_permlane32_swap_b32 v8, v9
    s_nop 1
    v_max_f32 v8, v8, v9
    v_max_f32 v8, 0, v8
    v_sub_f32 v9, 0, v8
    v_exp_f32 v9, v9
    s_nop 0
    v_mul_f32 v32, v32, v9
    v_mul_f32 v33, v33, v9
    v_mul_f32 v34, v34, v9
    v_mul_f32 v35, v35, v9
    v_mul_f32 v36, v36, v9
    v_mul_f32 v37, v37, v9
    v_mul_f32 v38, v38, v9
    v_mul_f32 v39, v39, v9
    v_mul_f32 v40, v40, v9
    v_mul_f32 v41, v41, v9
    v_mul_f32 v42, v42, v9
    v_mul_f32 v43, v43, v9
    v_mul_f32 v44, v44, v9
    v_mul_f32 v45, v45, v9
    v_mul_f32 v46, v46, v9
    v_mul_f32 v47, v47, v9
    v_mul_f32 v48, v48, v9
    v_mul_f32 v49, v49, v9
    v_mul_f32 v50, v50, v9
    v_mul_f32 v51, v51, v9
    v_mul_f32 v52, v52, v9
    v_mul_f32 v53, v53, v9
    v_mul_f32 v54, v54, v9
    v_mul_f32 v55, v55, v9
    v_mul_f32 v56, v56, v9
    v_mul_f32 v57, v57, v9
    v_mul_f32 v58, v58, v9
    v_mul_f32 v59, v59, v9
    v_mul_f32 v60, v60, v9
    v_mul_f32 v61, v61, v9
    v_mul_f32 v62, v62, v9
    v_mul_f32 v63, v63, v9
    v_mul_f32 v6, v6, v9
    v_sub_f32 v80, v80, v8
    v_sub_f32 v81, v81, v8
    v_sub_f32 v82, v82, v8
    v_sub_f32 v83, v83, v8
    v_sub_f32 v72, v72, v8
    v_sub_f32 v73, v73, v8
    v_sub_f32 v74, v74, v8
    v_sub_f32 v75, v75, v8
    v_sub_f32 v76, v76, v8
    v_sub_f32 v77, v77, v8
    v_sub_f32 v78, v78, v8
    v_sub_f32 v79, v79, v8
    v_exp_f32 v156, v72
    s_nop 0
    v_exp_f32 v157, v73
    s_nop 0
    v_exp_f32 v158, v74
    s_nop 0
    v_exp_f32 v159, v75
    s_nop 0
    v_cvt_pk_bf16_f32 v88, v156, v157
    v_exp_f32 v156, v76
    s_nop 0
    v_exp_f32 v157, v77
    s_nop 0
    v_cvt_pk_bf16_f32 v89, v158, v159
    v_exp_f32 v158, v78
    s_nop 0
    v_exp_f32 v159, v79
    s_nop 0
    v_cvt_pk_bf16_f32 v90, v156, v157
    v_cvt_pk_bf16_f32 v91, v158, v159
    s_nop 1
    v_mfma_f32_16x16x32_bf16 v[164:167], v[160:163], v[88:91], 0
    s_nop 8
    s_nop 1
    s_branch Rback_41
Rrare_42:
    s_nop 15
    s_nop 7
    v_max3_f32 v8, v64, v65, v66
    v_max3_f32 v8, v8, v67, v68
    v_max3_f32 v8, v8, v69, v70
    v_max_f32 v8, v8, v71
    v_mov_b32 v9, v8
    s_nop 1
    v_permlane16_swap_b32 v8, v9
    s_nop 1
    v_max_f32 v8, v8, v9
    v_mov_b32 v9, v8
    s_nop 1
    v_permlane32_swap_b32 v8, v9
    s_nop 1
    v_max_f32 v8, v8, v9
    v_max_f32 v8, 0, v8
    v_sub_f32 v9, 0, v8
    v_exp_f32 v9, v9
    s_nop 0
    v_mul_f32 v6, v6, v9
    v_sub_f32 v80, v80, v8
    v_sub_f32 v81, v81, v8
    v_sub_f32 v82, v82, v8
    v_sub_f32 v83, v83, v8
    v_sub_f32 v64, v64, v8
    v_sub_f32 v65, v65, v8
    v_sub_f32 v66, v66, v8
    v_sub_f32 v67, v67, v8
    v_sub_f32 v68, v68, v8
    v_sub_f32 v69, v69, v8
    v_sub_f32 v70, v70, v8
    v_sub_f32 v71, v71, v8
    v_sub_f32 v72, v72, v8
    v_sub_f32 v73, v73, v8
    v_sub_f32 v74, v74, v8
    v_sub_f32 v75, v75, v8
    v_sub_f32 v76, v76, v8
    v_sub_f32 v77, v77, v8
    v_sub_f32 v78, v78, v8
    v_sub_f32 v79, v79, v8
    v_exp_f32 v156, v64
    s_nop 0
    v_exp_f32 v157, v65
    s_nop 0
    v_exp_f32 v158, v66
    s_nop 0
    v_exp_f32 v159, v67
    s_nop 0
    v_cvt_pk_bf16_f32 v84, v156, v157
    v_exp_f32 v156, v68
    s_nop 0
    v_exp_f32 v157, v69
    s_nop 0
    v_cvt_pk_bf16_f32 v85, v158, v159
    v_exp_f32 v158, v70
    s_nop 0
    v_exp_f32 v159, v71
    s_nop 0
    v_cvt_pk_bf16_f32 v86, v156, v157
    v_cvt_pk_bf16_f32 v87, v158, v159
    s_nop 1
    v_mfma_f32_16x16x32_bf16 v[164:167], v[160:163], v[84:87], 0
    s_nop 8
    s_nop 1
    s_branch Rback_43
Rrare_44:
    s_nop 15
    s_nop 7
    v_max3_f32 v8, v72, v73, v74
    v_max3_f32 v8, v8, v75, v76
    v_max3_f32 v8, v8, v77, v78
    v_max_f32 v8, v8, v79
    v_mov_b32 v9, v8
    s_nop 1
    v_permlane16_swap_b32 v8, v9
    s_nop 1
    v_max_f32 v8, v8, v9
    v_mov_b32 v9, v8
    s_nop 1
    v_permlane32_swap_b32 v8, v9
    s_nop 1
    v_max_f32 v8, v8, v9
    v_max_f32 v8, 0, v8
    v_sub_f32 v9, 0, v8
    v_exp_f32 v9, v9
    s_nop 0
    v_mul_f32 v32, v32, v9
    v_mul_f32 v33, v33, v9
    v_mul_f32 v34, v34, v9
    v_mul_f32 v35, v35, v9
    v_mul_f32 v36, v36, v9
    v_mul_f32 v37, v37, v9
    v_mul_f32 v38, v38, v9
    v_mul_f32 v39, v39, v9
    v_mul_f32 v40, v40, v9
    v_mul_f32 v41, v41, v9
    v_mul_f32 v42, v42, v9
    v_mul_f32 v43, v43, v9
    v_mul_f32 v44, v44, v9
    v_mul_f32 v45, v45, v9
    v_mul_f32 v46, v46, v9
    v_mul_f32 v47, v47, v9
    v_mul_f32 v48, v48, v9
    v_mul_f32 v49, v49, v9
    v_mul_f32 v50, v50, v9
    v_mul_f32 v51, v51, v9
    v_mul_f32 v52, v52, v9
    v_mul_f32 v53, v53, v9
    v_mul_f32 v54, v54, v9
    v_mul_f32 v55, v55, v9
    v_mul_f32 v56, v56, v9
    v_mul_f32 v57, v57, v9
    v_mul_f32 v58, v58, v9
    v_mul_f32 v59, v59, v9
    v_mul_f32 v60, v60, v9
    v_mul_f32 v61, v61, v9
    v_mul_f32 v62, v62, v9
    v_mul_f32 v63, v63, v9
    v_mul_f32 v6, v6, v9
    v_sub_f32 v80, v80, v8
    v_sub_f32 v81, v81, v8
    v_sub_f32 v82, v82, v8
    v_sub_f32 v83, v83, v8
    v_sub_f32 v72, v72, v8
    v_sub_f32 v73, v73, v8
    v_sub_f32 v74, v74, v8
    v_sub_f32 v75, v75, v8
    v_sub_f32 v76, v76, v8
    v_sub_f32 v77, v77, v8
    v_sub_f32 v78, v78, v8
    v_sub_f32 v79, v79, v8
    v_sub_f32 v64, v64, v8
    v_sub_f32 v65, v65, v8
    v_sub_f32 v66, v66, v8
    v_sub_f32 v67, v67, v8
    v_sub_f32 v68, v68, v8
    v_sub_f32 v69, v69, v8
    v_sub_f32 v70, v70, v8
    v_sub_f32 v71, v71, v8
    v_exp_f32 v156, v72
    s_nop 0
    v_exp_f32 v157, v73
    s_nop 0
    v_exp_f32 v158, v74
    s_nop 0
    v_exp_f32 v159, v75
    s_nop 0
    v_cvt_pk_bf16_f32 v88, v156, v157
    v_exp_f32 v156, v76
    s_nop 0
    v_exp_f32 v157, v77
    s_nop 0
    v_cvt_pk_bf16_f32 v89, v158, v159
    v_exp_f32 v158, v78
    s_nop 0
    v_exp_f32 v159, v79
    s_nop 0
    v_cvt_pk_bf16_f32 v90, v156, v157
    v_cvt_pk_bf16_f32 v91, v158, v159
    s_nop 1
    v_mfma_f32_16x16x32_bf16 v[164:167], v[160:163], v[88:91], 0
    s_nop 8
    s_nop 1
    s_branch Rback_45
Rrare_46:
    s_nop 15
    s_nop 7
    v_max3_f32 v8, v64, v65, v66
    v_max3_f32 v8, v8, v67, v68
    v_max3_f32 v8, v8, v69, v70
    v_max_f32 v8, v8, v71
    v_mov_b32 v9, v8
    s_nop 1
    v_permlane16_swap_b32 v8, v9
    s_nop 1
    v_max_f32 v8, v8, v9
    v_mov_b32 v9, v8
    s_nop 1
    v_permlane32_swap_b32 v8, v9
    s_nop 1
    v_max_f32 v8, v8, v9
    v_max_f32 v8, 0, v8
    v_sub_f32 v9, 0, v8
    v_exp_f32 v9, v9
    s_nop 0
    v_mul_f32 v32, v32, v9
    v_mul_f32 v33, v33, v9
    v_mul_f32 v34, v34, v9
    v_mul_f32 v35, v35, v9
    v_mul_f32 v36, v36, v9
    v_mul_f32 v37, v37, v9
    v_mul_f32 v38, v38, v9
    v_mul_f32 v39, v39, v9
    v_mul_f32 v40, v40, v9
    v_mul_f32 v41, v41, v9
    v_mul_f32 v42, v42, v9
    v_mul_f32 v43, v43, v9
    v_mul_f32 v44, v44, v9
    v_mul_f32 v45, v45, v9
    v_mul_f32 v46, v46, v9
    v_mul_f32 v47, v47, v9
    v_mul_f32 v48, v48, v9
    v_mul_f32 v49, v49, v9
    v_mul_f32 v50, v50, v9
    v_mul_f32 v51, v51, v9
    v_mul_f32 v52, v52, v9
    v_mul_f32 v53, v53, v9
    v_mul_f32 v54, v54, v9
    v_mul_f32 v55, v55, v9
    v_mul_f32 v56, v56, v9
    v_mul_f32 v57, v57, v9
    v_mul_f32 v58, v58, v9
    v_mul_f32 v59, v59, v9
    v_mul_f32 v60, v60, v9
    v_mul_f32 v61, v61, v9
    v_mul_f32 v62, v62, v9
    v_mul_f32 v63, v63, v9
    v_mul_f32 v6, v6, v9
    v_sub_f32 v80, v80, v8
    v_sub_f32 v81, v81, v8
    v_sub_f32 v82, v82, v8
    v_sub_f32 v83, v83, v8
    v_sub_f32 v64, v64, v8
    v_sub_f32 v65, v65, v8
    v_sub_f32 v66, v66, v8
    v_sub_f32 v67, v67, v8
    v_sub_f32 v68, v68, v8
    v_sub_f32 v69, v69, v8
    v_sub_f32 v70, v70, v8
    v_sub_f32 v71, v71, v8
    v_sub_f32 v72, v72, v8
    v_sub_f32 v73, v73, v8
    v_sub_f32 v74, v74, v8
    v_sub_f32 v75, v75, v8
    v_sub_f32 v76, v76, v8
    v_sub_f32 v77, v77, v8
    v_sub_f32 v78, v78, v8
    v_sub_f32 v79, v79, v8
    v_exp_f32 v156, v64
    s_nop 0
    v_exp_f32 v157, v65
    s_nop 0
    v_exp_f32 v158, v66
    s_nop 0
    v_exp_f32 v159, v67
    s_nop 0
    v_cvt_pk_bf16_f32 v84, v156, v157
    v_exp_f32 v156, v68
    s_nop 0
    v_exp_f32 v157, v69
    s_nop 0
    v_cvt_pk_bf16_f32 v85, v158, v159
    v_exp_f32 v158, v70
    s_nop 0
    v_exp_f32 v159, v71
    s_nop 0
    v_cvt_pk_bf16_f32 v86, v156, v157
    v_cvt_pk_bf16_f32 v87, v158, v159
    s_nop 1
    v_mfma_f32_16x16x32_bf16 v[164:167], v[160:163], v[84:87], 0
    s_nop 8
    s_nop 1
    s_branch Rback_47
Rrare_48:
    s_nop 15
    s_nop 7
    v_max3_f32 v8, v72, v73, v74
    v_max3_f32 v8, v8, v75, v76
    v_max3_f32 v8, v8, v77, v78
    v_max_f32 v8, v8, v79
    v_mov_b32 v9, v8
    s_nop 1
    v_permlane16_swap_b32 v8, v9
    s_nop 1
    v_max_f32 v8, v8, v9
    v_mov_b32 v9, v8
    s_nop 1
    v_permlane32_swap_b32 v8, v9
    s_nop 1
    v_max_f32 v8, v8, v9
    v_max_f32 v8, 0, v8
    v_sub_f32 v9, 0, v8
    v_exp_f32 v9, v9
    s_nop 0
    v_mul_f32 v32, v32, v9
    v_mul_f32 v33, v33, v9
    v_mul_f32 v34, v34, v9
    v_mul_f32 v35, v35, v9
    v_mul_f32 v36, v36, v9
    v_mul_f32 v37, v37, v9
    v_mul_f32 v38, v38, v9
    v_mul_f32 v39, v39, v9
    v_mul_f32 v40, v40, v9
    v_mul_f32 v41, v41, v9
    v_mul_f32 v42, v42, v9
    v_mul_f32 v43, v43, v9
    v_mul_f32 v44, v44, v9
    v_mul_f32 v45, v45, v9
    v_mul_f32 v46, v46, v9
    v_mul_f32 v47, v47, v9
    v_mul_f32 v48, v48, v9
    v_mul_f32 v49, v49, v9
    v_mul_f32 v50, v50, v9
    v_mul_f32 v51, v51, v9
    v_mul_f32 v52, v52, v9
    v_mul_f32 v53, v53, v9
    v_mul_f32 v54, v54, v9
    v_mul_f32 v55, v55, v9
    v_mul_f32 v56, v56, v9
    v_mul_f32 v57, v57, v9
    v_mul_f32 v58, v58, v9
    v_mul_f32 v59, v59, v9
    v_mul_f32 v60, v60, v9
    v_mul_f32 v61, v61, v9
    v_mul_f32 v62, v62, v9
    v_mul_f32 v63, v63, v9
    v_mul_f32 v6, v6, v9
    v_sub_f32 v80, v80, v8
    v_sub_f32 v81, v81, v8
    v_sub_f32 v82, v82, v8
    v_sub_f32 v83, v83, v8
    v_sub_f32 v72, v72, v8
    v_sub_f32 v73, v73, v8
    v_sub_f32 v74, v74, v8
    v_sub_f32 v75, v75, v8
    v_sub_f32 v76, v76, v8
    v_sub_f32 v77, v77, v8
    v_sub_f32 v78, v78, v8
    v_sub_f32 v79, v79, v8
    v_exp_f32 v156, v72
    s_nop 0
    v_exp_f32 v157, v73
    s_nop 0
    v_exp_f32 v158, v74
    s_nop 0
    v_exp_f32 v159, v75
    s_nop 0
    v_cvt_pk_bf16_f32 v88, v156, v157
    v_exp_f32 v156, v76
    s_nop 0
    v_exp_f32 v157, v77
    s_nop 0
    v_cvt_pk_bf16_f32 v89, v158, v159
    v_exp_f32 v158, v78
    s_nop 0
    v_exp_f32 v159, v79
    s_nop 0
    v_cvt_pk_bf16_f32 v90, v156, v157
    v_cvt_pk_bf16_f32 v91, v158, v159
    s_nop 1
    v_mfma_f32_16x16x32_bf16 v[164:167], v[160:163], v[88:91], 0
    s_nop 8
    s_nop 1
    s_branch Rback_49
L_help:
    s_barrier
    s_and_b32 s44, s3, 3
    s_lshr_b32 s45, s3, 2
    s_mul_i32 s58, s45, 18432
    s_add_u32 s55, s69, s56
    s_mov_b32 s13, 0
    s_lshl_b32 s47, s71, 4
    s_mul_i32 s32, s70, 6
    s_lshl_b32 s33, s44, 1
    s_add_u32 s32, s32, s33
    s_add_u32 s32, s32, 0
    s_mul_i32 s74, s32, 40960
    s_mul_i32 s33, s32, 57
    s_lshr_b32 s33, s33, 9
    s_mul_i32 s34, s33, 9
    s_sub_u32 s32, s32, s34
    s_lshl_b32 s32, s32, 10
    s_lshl_b32 s34, s26, 3
    s_add_u32 s33, s33, s34
    s_mul_i32 s34, s33, 1179648
    s_add_u32 s32, s32, s34
    v_lshl_add_u32 v2, v0, 4, s32
    s_lshl_b32 s72, s33, 9
    s_mul_i32 s32, s70, 6
    s_lshl_b32 s33, s44, 1
    s_add_u32 s32, s32, s33
    s_add_u32 s32, s32, 1
    s_mul_i32 s75, s32, 40960
    s_mul_i32 s33, s32, 57
    s_lshr_b32 s33, s33, 9
    s_mul_i32 s34, s33, 9
    s_sub_u32 s32, s32, s34
    s_lshl_b32 s32, s32, 10
    s_lshl_b32 s34, s26, 3
    s_add_u32 s33, s33, s34
    s_mul_i32 s34, s33, 1179648
    s_add_u32 s32, s32, s34
    v_lshl_add_u32 v3, v0, 4, s32
    s_lshl_b32 s73, s33, 9
    v_and_b32 v12, 15, v0
    v_lshrrev_b32 v14, 4, v0
    v_and_b32 v1, 1, v14
    v_lshrrev_b32 v9, 1, v14
    v_mul_u32_u24 v4, 5120, v1
    v_mul_u32_u24 v8, 20480, v9
    v_add_u32 v4, v4, v8
    v_lshl_add_u32 v4, v12, 4, v4
    v_mul_u32_u24 v10, 2560, v12
    v_lshl_add_u32 v10, v14, 3, v10
    v_lshlrev_b32 v12, 2, v12
    v_add_u32 v11, s75, v10
    v_add_u32 v10, s74, v10
    v_lshlrev_b32 v13, 4, v0
    v_mov_b32 v8, s72
    v_mov_b32 v9, s73
    v_cmp_eq_u32 vcc, 1, v1
    s_lshl_b32 s32, s71, 3
    s_mov_b32 s12, 0x00ff00ff
    v_cndmask_b32 v8, v8, v9, vcc
    v_add_u32 v12, v12, v8
    s_lshl_b32 s12, s12, s32
    v_bfe_u32 v5, v0, 2, 2
    v_bfe_u32 v8, v0, 4, 1
    v_lshl_add_u32 v5, v8, 2, v5
    v_mul_u32_u24 v5, 1056, v5
    v_lshrrev_b32 v8, 5, v0
    v_lshl_add_u32 v5, v8, 9, v5
    v_and_b32 v8, 3, v0
    v_lshl_add_u32 v5, v8, 3, v5
    s_mul_i32 s32, s45, 16896
    v_add_u32 v5, s32, v5
    s_mov_b32 s46, 0
    s_cmp_lg_u32 s3, 6
    s_cbranch_scc1 W2_50
    s_waitcnt vmcnt(8)
W2_50:
    s_waitcnt vmcnt(12)
    s_barrier
    v_mov_b32 v9, 0
    buffer_load_dword v8, v9, s[64:67], 0 offen sc1
    s_add_u32 s32, s37, s38
    s_and_b32 s32, s32, 0x3ffff
    s_and_b32 s33, s37, 0xfffc0000
    s_mov_b32 m0, s39
    s_or_b32 s32, s32, s33
    buffer_load_dwordx4 v15, s[8:11], s32 offen nt lds
    s_add_u32 m0, m0, s42
    s_add_u32 s32, s32, s43
    buffer_load_dwordx4 v15, s[8:11], s32 offen nt lds
    s_add_u32 m0, m0, s42
    s_add_u32 s32, s32, s43
    buffer_load_dwordx4 v15, s[8:11], s32 offen nt lds
    s_add_u32 m0, m0, s42
    s_add_u32 s32, s32, s43
    buffer_load_dwordx4 v15, s[8:11], s32 offen nt lds
    s_cmp_lg_u32 s3, 6
    s_cbranch_scc1 K8_51
    s_add_u32 m0, m0, s42
    s_add_u32 s32, s32, s43
    buffer_load_dwordx4 v15, s[8:11], s32 offen nt lds
    s_add_u32 m0, m0, s42
    s_add_u32 s32, s32, s43
    buffer_load_dwordx4 v15, s[8:11], s32 offen nt lds
    s_add_u32 m0, m0, s42
    s_add_u32 s32, s32, s43
    buffer_load_dwordx4 v15, s[8:11], s32 offen nt lds
    s_add_u32 m0, m0, s42
    s_add_u32 s32, s32, s43
    buffer_load_dwordx4 v15, s[8:11], s32 offen nt lds
K8_51:
    s_add_u32 s37, s37, 8192
    s_add_u32 s39, s39, 8448
    s_cmp_eq_u32 s39, s41
    s_cselect_b32 s39, s40, s39
    s_cmp_lt_u32 s3, 6
    s_cbranch_scc1 H_s1
    s_add_u32 s32, s37, s38
    s_and_b32 s32, s32, 0x3ffff
    s_and_b32 s33, s37, 0xfffc0000
    s_mov_b32 m0, s39
    s_or_b32 s32, s32, s33
    buffer_load_dwordx4 v15, s[8:11], s32 offen nt lds
    s_add_u32 m0, m0, s42
    s_add_u32 s32, s32, s43
    buffer_load_dwordx4 v15, s[8:11], s32 offen nt lds
    s_add_u32 m0, m0, s42
    s_add_u32 s32, s32, s43
    buffer_load_dwordx4 v15, s[8:11], s32 offen nt lds
    s_add_u32 m0, m0, s42
    s_add_u32 s32, s32, s43
    buffer_load_dwordx4 v15, s[8:11], s32 offen nt lds
    s_cmp_lg_u32 s3, 6
    s_cbranch_scc1 K8_52
    s_add_u32 m0, m0, s42
    s_add_u32 s32, s32, s43
    buffer_load_dwordx4 v15, s[8:11], s32 offen nt lds
    s_add_u32 m0, m0, s42
    s_add_u32 s32, s32, s43
    buffer_load_dwordx4 v15, s[8:11], s32 offen nt lds
    s_add_u32 m0, m0, s42
    s_add_u32 s32, s32, s43
    buffer_load_dwordx4 v15, s[8:11], s32 offen nt lds
    s_add_u32 m0, m0, s42
    s_add_u32 s32, s32, s43
    buffer_load_dwordx4 v15, s[8:11], s32 offen nt lds
K8_52:
    s_add_u32 s37, s37, 8192
    s_add_u32 s39, s39, 8448
    s_cmp_eq_u32 s39, s41
    s_cselect_b32 s39, s40, s39
H_s1:
    s_cmp_eq_u32 s3, 6
    s_cbranch_scc1 W2_53
    s_waitcnt vmcnt(12)
W2_53:
    s_waitcnt vmcnt(20)
    s_barrier
    s_mov_b32 s30, 33
H_l1:
    s_add_u32 s32, s37, s38
    s_and_b32 s32, s32, 0x3ffff
    s_and_b32 s33, s37, 0xfffc0000
    s_mov_b32 m0, s39
    s_or_b32 s32, s32, s33
    buffer_load_dwordx4 v15, s[8:11], s32 offen nt lds
    s_add_u32 m0, m0, s42
    s_add_u32 s32, s32, s43
    buffer_load_dwordx4 v15, s[8:11], s32 offen nt lds
    s_add_u32 m0, m0, s42
    s_add_u32 s32, s32, s43
    buffer_load_dwordx4 v15, s[8:11], s32 offen nt lds
    s_add_u32 m0, m0, s42
    s_add_u32 s32, s32, s43
    buffer_load_dwordx4 v15, s[8:11], s32 offen nt lds
    s_cmp_lg_u32 s3, 6
    s_cbranch_scc1 K8_54
    s_add_u32 m0, m0, s42
    s_add_u32 s32, s32, s43
    buffer_load_dwordx4 v15, s[8:11], s32 offen nt lds
    s_add_u32 m0, m0, s42
    s_add_u32 s32, s32, s43
    buffer_load_dwordx4 v15, s[8:11], s32 offen nt lds
    s_add_u32 m0, m0, s42
    s_add_u32 s32, s32, s43
    buffer_load_dwordx4 v15, s[8:11], s32 offen nt lds
    s_add_u32 m0, m0, s42
    s_add_u32 s32, s32, s43
    buffer_load_dwordx4 v15, s[8:11], s32 offen nt lds
K8_54:
    s_add_u32 s37, s37, 8192
    s_add_u32 s39, s39, 8448
    s_cmp_eq_u32 s39, s41
    s_cselect_b32 s39, s40, s39
    s_cmp_eq_u32 s3, 6
    s_cbranch_scc1 W2_55
    s_waitcnt vmcnt(12)
W2_55:
    s_waitcnt vmcnt(24)
    s_sub_u32 s30, s30, 1
    s_cmp_lg_u32 s30, 0
    s_barrier
    s_cbranch_scc1 H_l1
    s_mul_i32 s32, s44, 12288
    s_add_u32 s52, s36, s32
    s_add_u32 s32, s32, 42240
    v_add_u32 v14, s32, v13
    s_mov_b32 s30, 6
H_d:
    ds_read_b128 v[112:115], v14
    ds_read_b128 v[116:119], v14 offset:1024
    s_add_u32 s32, s37, s38
    s_and_b32 s32, s32, 0x3ffff
    s_and_b32 s33, s37, 0xfffc0000
    s_mov_b32 m0, s39
    s_or_b32 s32, s32, s33
    buffer_load_dwordx4 v15, s[8:11], s32 offen nt lds
    s_add_u32 m0, m0, s42
    s_add_u32 s32, s32, s43
    buffer_load_dwordx4 v15, s[8:11], s32 offen nt lds
    s_add_u32 m0, m0, s42
    s_add_u32 s32, s32, s43
    buffer_load_dwordx4 v15, s[8:11], s32 offen nt lds
    s_add_u32 m0, m0, s42
    s_add_u32 s32, s32, s43
    buffer_load_dwordx4 v15, s[8:11], s32 offen nt lds
    s_cmp_lg_u32 s3, 6
    s_cbranch_scc1 K8_56
    s_add_u32 m0, m0, s42
    s_add_u32 s32, s32, s43
    buffer_load_dwordx4 v15, s[8:11], s32 offen nt lds
    s_add_u32 m0, m0, s42
    s_add_u32 s32, s32, s43
    buffer_load_dwordx4 v15, s[8:11], s32 offen nt lds
    s_add_u32 m0, m0, s42
    s_add_u32 s32, s32, s43
    buffer_load_dwordx4 v15, s[8:11], s32 offen nt lds
    s_add_u32 m0, m0, s42
    s_add_u32 s32, s32, s43
    buffer_load_dwordx4 v15, s[8:11], s32 offen nt lds
K8_56:
    s_add_u32 s37, s37, 8192
    s_add_u32 s39, s39, 8448
    s_cmp_eq_u32 s39, s41
    s_cselect_b32 s39, s40, s39
    s_waitcnt lgkmcnt(0)
    buffer_store_dwordx4 v[112:115], v13, s[20:23], s52 offen sc1
    buffer_store_dwordx4 v[116:119], v13, s[20:23], s52 offen offset:1024 sc1
    v_add_u32 v14, 2048, v14
    s_add_u32 s52, s52, 2048
    s_cmp_eq_u32 s3, 6
    s_cbranch_scc1 W2_57
    s_waitcnt vmcnt(14)
W2_57:
    s_waitcnt vmcnt(26)
    s_sub_u32 s30, s30, 1
    s_cmp_lg_u32 s30, 0
    s_barrier
    s_cbranch_scc1 H_d
    s_add_u32 s32, s37, s38
    s_and_b32 s32, s32, 0x3ffff
    s_and_b32 s33, s37, 0xfffc0000
    s_mov_b32 m0, s39
    s_or_b32 s32, s32, s33
    buffer_load_dwordx4 v15, s[8:11], s32 offen nt lds
    s_add_u32 m0, m0, s42
    s_add_u32 s32, s32, s43
    buffer_load_dwordx4 v15, s[8:11], s32 offen nt lds
    s_add_u32 m0, m0, s42
    s_add_u32 s32, s32, s43
    buffer_load_dwordx4 v15, s[8:11], s32 offen nt lds
    s_add_u32 m0, m0, s42
    s_add_u32 s32, s32, s43
    buffer_load_dwordx4 v15, s[8:11], s32 offen nt lds
    s_cmp_lg_u32 s3, 6
    s_cbranch_scc1 K8_58
    s_add_u32 m0, m0, s42
    s_add_u32 s32, s32, s43
    buffer_load_dwordx4 v15, s[8:11], s32 offen nt lds
    s_add_u32 m0, m0, s42
    s_add_u32 s32, s32, s43
    buffer_load_dwordx4 v15, s[8:11], s32 offen nt lds
    s_add_u32 m0, m0, s42
    s_add_u32 s32, s32, s43
    buffer_load_dwordx4 v15, s[8:11], s32 offen nt lds
    s_add_u32 m0, m0, s42
    s_add_u32 s32, s32, s43
    buffer_load_dwordx4 v15, s[8:11], s32 offen nt lds
K8_58:
    s_add_u32 s37, s37, 8192
    s_add_u32 s39, s39, 8448
    s_cmp_eq_u32 s39, s41
    s_cselect_b32 s39, s40, s39
    s_cmp_eq_u32 s3, 6
    s_cbranch_scc1 W2_59
    s_waitcnt vmcnt(18)
W2_59:
    s_waitcnt vmcnt(30)
    s_barrier
    s_add_u32 s32, s37, s38
    s_and_b32 s32, s32, 0x3ffff
    s_and_b32 s33, s37, 0xfffc0000
    s_mov_b32 m0, s39
    s_or_b32 s32, s32, s33
    buffer_load_dwordx4 v15, s[8:11], s32 offen nt lds
    s_add_u32 m0, m0, s42
    s_add_u32 s32, s32, s43
    buffer_load_dwordx4 v15, s[8:11], s32 offen nt lds
    s_add_u32 m0, m0, s42
    s_add_u32 s32, s32, s43
    buffer_load_dwordx4 v15, s[8:11], s32 offen nt lds
    s_add_u32 m0, m0, s42
    s_add_u32 s32, s32, s43
    buffer_load_dwordx4 v15, s[8:11], s32 offen nt lds
    s_cmp_lg_u32 s3, 6
    s_cbranch_scc1 K8_60
    s_add_u32 m0, m0, s42
    s_add_u32 s32, s32, s43
    buffer_load_dwordx4 v15, s[8:11], s32 offen nt lds
    s_add_u32 m0, m0, s42
    s_add_u32 s32, s32, s43
    buffer_load_dwordx4 v15, s[8:11], s32 offen nt lds
    s_add_u32 m0, m0, s42
    s_add_u32 s32, s32, s43
    buffer_load_dwordx4 v15, s[8:11], s32 offen nt lds
    s_add_u32 m0, m0, s42
    s_add_u32 s32, s32, s43
    buffer_load_dwordx4 v15, s[8:11], s32 offen nt lds
K8_60:
    s_add_u32 s37, s37, 8192
    s_add_u32 s39, s39, 8448
    s_cmp_eq_u32 s39, s41
    s_cselect_b32 s39, s40, s39
    s_cmp_eq_u32 s3, 6
    s_cbranch_scc1 W2_61
    s_waitcnt vmcnt(16)
W2_61:
    s_waitcnt vmcnt(28)
    s_barrier
    s_add_u32 s32, s37, s38
    s_and_b32 s32, s32, 0x3ffff
    s_and_b32 s33, s37, 0xfffc0000
    s_mov_b32 m0, s39
    s_or_b32 s32, s32, s33
    buffer_load_dwordx4 v15, s[8:11], s32 offen nt lds
    s_add_u32 m0, m0, s42
    s_add_u32 s32, s32, s43
    buffer_load_dwordx4 v15, s[8:11], s32 offen nt lds
    s_add_u32 m0, m0, s42
    s_add_u32 s32, s32, s43
    buffer_load_dwordx4 v15, s[8:11], s32 offen nt lds
    s_add_u32 m0, m0, s42
    s_add_u32 s32, s32, s43
    buffer_load_dwordx4 v15, s[8:11], s32 offen nt lds
    s_cmp_lg_u32 s3, 6
    s_cbranch_scc1 K8_62
    s_add_u32 m0, m0, s42
    s_add_u32 s32, s32, s43
    buffer_load_dwordx4 v15, s[8:11], s32 offen nt lds
    s_add_u32 m0, m0, s42
    s_add_u32 s32, s32, s43
    buffer_load_dwordx4 v15, s[8:11], s32 offen nt lds
    s_add_u32 m0, m0, s42
    s_add_u32 s32, s32, s43
    buffer_load_dwordx4 v15, s[8:11], s32 offen nt lds
    s_add_u32 m0, m0, s42
    s_add_u32 s32, s32, s43
    buffer_load_dwordx4 v15, s[8:11], s32 offen nt lds
K8_62:
    s_add_u32 s37, s37, 8192
    s_add_u32 s39, s39, 8448
    s_cmp_eq_u32 s39, s41
    s_cselect_b32 s39, s40, s39
    s_cmp_eq_u32 s3, 6
    s_cbranch_scc1 W2_63
    s_waitcnt vmcnt(14)
W2_63:
    s_waitcnt vmcnt(26)
    s_barrier
    s_add_u32 s32, s37, s38
    s_and_b32 s32, s32, 0x3ffff
    s_and_b32 s33, s37, 0xfffc0000
    s_mov_b32 m0, s39
    s_or_b32 s32, s32, s33
    buffer_load_dwordx4 v15, s[8:11], s32 offen nt lds
    s_add_u32 m0, m0, s42
    s_add_u32 s32, s32, s43
    buffer_load_dwordx4 v15, s[8:11], s32 offen nt lds
    s_add_u32 m0, m0, s42
    s_add_u32 s32, s32, s43
    buffer_load_dwordx4 v15, s[8:11], s32 offen nt lds
    s_add_u32 m0, m0, s42
    s_add_u32 s32, s32, s43
    buffer_load_dwordx4 v15, s[8:11], s32 offen nt lds
    s_cmp_lg_u32 s3, 6
    s_cbranch_scc1 K8_64
    s_add_u32 m0, m0, s42
    s_add_u32 s32, s32, s43
    buffer_load_dwordx4 v15, s[8:11], s32 offen nt lds
    s_add_u32 m0, m0, s42
    s_add_u32 s32, s32, s43
    buffer_load_dwordx4 v15, s[8:11], s32 offen nt lds
    s_add_u32 m0, m0, s42
    s_add_u32 s32, s32, s43
    buffer_load_dwordx4 v15, s[8:11], s32 offen nt lds
    s_add_u32 m0, m0, s42
    s_add_u32 s32, s32, s43
    buffer_load_dwordx4 v15, s[8:11], s32 offen nt lds
K8_64:
    s_add_u32 s37, s37, 8192
    s_add_u32 s39, s39, 8448
    s_cmp_eq_u32 s39, s41
    s_cselect_b32 s39, s40, s39
    s_cmp_eq_u32 s3, 6
    s_cbranch_scc1 W2_65
    s_waitcnt vmcnt(12)
W2_65:
    s_waitcnt vmcnt(24)
    s_barrier
    s_add_u32 s32, s37, s38
    s_and_b32 s32, s32, 0x3ffff
    s_and_b32 s33, s37, 0xfffc0000
    s_mov_b32 m0, s39
    s_or_b32 s32, s32, s33
    buffer_load_dwordx4 v15, s[8:11], s32 offen nt lds
    s_add_u32 m0, m0, s42
    s_add_u32 s32, s32, s43
    buffer_load_dwordx4 v15, s[8:11], s32 offen nt lds
    s_add_u32 m0, m0, s42
    s_add_u32 s32, s32, s43
    buffer_load_dwordx4 v15, s[8:11], s32 offen nt lds
    s_add_u32 m0, m0, s42
    s_add_u32 s32, s32, s43
    buffer_load_dwordx4 v15, s[8:11], s32 offen nt lds
    s_cmp_lg_u32 s3, 6
    s_cbranch_scc1 K8_66
    s_add_u32 m0, m0, s42
    s_add_u32 s32, s32, s43
    buffer_load_dwordx4 v15, s[8:11], s32 offen nt lds
    s_add_u32 m0, m0, s42
    s_add_u32 s32, s32, s43
    buffer_load_dwordx4 v15, s[8:11], s32 offen nt lds
    s_add_u32 m0, m0, s42
    s_add_u32 s32, s32, s43
    buffer_load_dwordx4 v15, s[8:11], s32 offen nt lds
    s_add_u32 m0, m0, s42
    s_add_u32 s32, s32, s43
    buffer_load_dwordx4 v15, s[8:11], s32 offen nt lds
K8_66:
    s_add_u32 s37, s37, 8192
    s_add_u32 s39, s39, 8448
    s_cmp_eq_u32 s39, s41
    s_cselect_b32 s39, s40, s39
    v_readfirstlane_b32 s14, v8
    s_mov_b32 s33, 0x8000
    s_cmp_lg_u32 s14, 0
    s_cbranch_scc1 H_nd
H_nl:
    buffer_load_dword v8, v9, s[64:67], 0 offen sc1
    s_waitcnt vmcnt(0)
    v_readfirstlane_b32 s14, v8
    s_cmp_lg_u32 s14, 0
    s_cbranch_scc1 H_nd
    s_sleep 8
    s_sub_u32 s33, s33, 1
    s_cmp_lg_u32 s33, 0
    s_cbranch_scc1 H_nl
H_nd:
    v_mov_b32 v9, 163584
    ds_write_b32 v9, v8
    s_cmp_lg_u32 s3, 4
    s_cbranch_scc1 pub_67
    v_mov_b32 v8, s14
    v_mov_b32 v9, 0
    s_mov_b64 exec, 1
    buffer_store_dword v8, v9, s[20:23], s57 offen offset:0 sc1
    s_mov_b64 exec, -1
pub_67:
    s_cmp_eq_u32 s3, 6
    s_cbranch_scc1 W2_68
    s_waitcnt vmcnt(12)
W2_68:
    s_waitcnt vmcnt(24)
    s_waitcnt lgkmcnt(0)
    s_barrier
    s_mov_b32 s30, 13
H_l2:
    s_add_u32 s32, s37, s38
    s_and_b32 s32, s32, 0x3ffff
    s_and_b32 s33, s37, 0xfffc0000
    s_mov_b32 m0, s39
    s_or_b32 s32, s32, s33
    buffer_load_dwordx4 v15, s[8:11], s32 offen nt lds
    s_add_u32 m0, m0, s42
    s_add_u32 s32, s32, s43
    buffer_load_dwordx4 v15, s[8:11], s32 offen nt lds
    s_add_u32 m0, m0, s42
    s_add_u32 s32, s32, s43
    buffer_load_dwordx4 v15, s[8:11], s32 offen nt lds
    s_add_u32 m0, m0, s42
    s_add_u32 s32, s32, s43
    buffer_load_dwordx4 v15, s[8:11], s32 offen nt lds
    s_cmp_lg_u32 s3, 6
    s_cbranch_scc1 K8_69
    s_add_u32 m0, m0, s42
    s_add_u32 s32, s32, s43
    buffer_load_dwordx4 v15, s[8:11], s32 offen nt lds
    s_add_u32 m0, m0, s42
    s_add_u32 s32, s32, s43
    buffer_load_dwordx4 v15, s[8:11], s32 offen nt lds
    s_add_u32 m0, m0, s42
    s_add_u32 s32, s32, s43
    buffer_load_dwordx4 v15, s[8:11], s32 offen nt lds
    s_add_u32 m0, m0, s42
    s_add_u32 s32, s32, s43
    buffer_load_dwordx4 v15, s[8:11], s32 offen nt lds
K8_69:
    s_add_u32 s37, s37, 8192
    s_add_u32 s39, s39, 8448
    s_cmp_eq_u32 s39, s41
    s_cselect_b32 s39, s40, s39
    s_cmp_eq_u32 s3, 6
    s_cbranch_scc1 W2_70
    s_waitcnt vmcnt(12)
W2_70:
    s_waitcnt vmcnt(24)
    s_sub_u32 s30, s30, 1
    s_cmp_lg_u32 s30, 0
    s_barrier
    s_cbranch_scc1 H_l2
    s_add_u32 s32, s37, s38
    s_and_b32 s32, s32, 0x3ffff
    s_and_b32 s33, s37, 0xfffc0000
    s_mov_b32 m0, s39
    s_or_b32 s32, s32, s33
    buffer_load_dwordx4 v15, s[8:11], s32 offen nt lds
    s_add_u32 m0, m0, s42
    s_add_u32 s32, s32, s43
    buffer_load_dwordx4 v15, s[8:11], s32 offen nt lds
    s_add_u32 m0, m0, s42
    s_add_u32 s32, s32, s43
    buffer_load_dwordx4 v15, s[8:11], s32 offen nt lds
    s_add_u32 m0, m0, s42
    s_add_u32 s32, s32, s43
    buffer_load_dwordx4 v15, s[8:11], s32 offen nt lds
    s_add_u32 s37, s37, 8192
    s_add_u32 s39, s39, 8448
    s_cmp_eq_u32 s39, s41
    s_cselect_b32 s39, s40, s39
    s_mov_b32 s34, 18874368
    buffer_load_dword v8, v12, s[20:23], s34 offen sc1
    s_waitcnt vmcnt(12)
    s_barrier
    s_add_u32 s32, s37, s38
    s_and_b32 s32, s32, 0x3ffff
    s_and_b32 s33, s37, 0xfffc0000
    s_mov_b32 m0, s39
    s_or_b32 s32, s32, s33
    buffer_load_dwordx4 v15, s[8:11], s32 offen nt lds
    s_add_u32 m0, m0, s42
    s_add_u32 s32, s32, s43
    buffer_load_dwordx4 v15, s[8:11], s32 offen nt lds
    s_add_u32 m0, m0, s42
    s_add_u32 s32, s32, s43
    buffer_load_dwordx4 v15, s[8:11], s32 offen nt lds
    s_add_u32 m0, m0, s42
    s_add_u32 s32, s32, s43
    buffer_load_dwordx4 v15, s[8:11], s32 offen nt lds
    s_add_u32 s37, s37, 8192
    s_add_u32 s39, s39, 8448
    s_cmp_eq_u32 s39, s41
    s_cselect_b32 s39, s40, s39
    s_waitcnt vmcnt(12)
    s_barrier
    s_add_u32 s32, s37, s38
    s_and_b32 s32, s32, 0x3ffff
    s_and_b32 s33, s37, 0xfffc0000
    s_mov_b32 m0, s39
    s_or_b32 s32, s32, s33
    buffer_load_dwordx4 v15, s[8:11], s32 offen nt lds
    s_add_u32 m0, m0, s42
    s_add_u32 s32, s32, s43
    buffer_load_dwordx4 v15, s[8:11], s32 offen nt lds
    s_add_u32 m0, m0, s42
    s_add_u32 s32, s32, s43
    buffer_load_dwordx4 v15, s[8:11], s32 offen nt lds
    s_add_u32 m0, m0, s42
    s_add_u32 s32, s32, s43
    buffer_load_dwordx4 v15, s[8:11], s32 offen nt lds
    s_add_u32 s37, s37, 8192
    s_add_u32 s39, s39, 8448
    s_cmp_eq_u32 s39, s41
    s_cselect_b32 s39, s40, s39
    s_waitcnt vmcnt(12)
    s_barrier
    s_waitcnt vmcnt(8)
    s_cmp_ge_u32 s2, 240
    s_cbranch_scc1 H_ni
    s_mov_b32 s33, 0x8000
    s_mov_b32 s34, 18874368
    s_waitcnt vmcnt(8)
    v_cmp_ne_u32 vcc, s14, v8
    s_and_b32 vcc_lo, vcc_lo, s12
    s_cbranch_scc0 polld_72
poll_71:
    buffer_load_dword v8, v12, s[20:23], s34 offen sc1
    s_waitcnt vmcnt(0)
    v_cmp_ne_u32 vcc, s14, v8
    s_and_b32 vcc_lo, vcc_lo, s12
    s_cbranch_scc0 polld_72
    s_sleep 8
    s_sub_u32 s33, s33, 1
    s_cmp_lg_u32 s33, 0
    s_cbranch_scc1 poll_71
polld_72:
    s_cmp_eq_u32 s3, 6
    s_cbranch_scc1 H_nw
    s_mul_i32 s48, s44, 16896
    s_mul_i32 s50, s44, 81920
    s_lshl_b32 s32, s69, 8
    s_add_u32 s50, s50, s32
    s_add_u32 s32, s46, s55
    s_and_b32 s32, s32, 7
    s_lshl_b32 s32, s32, 1
    s_lshr_b32 s33, s46, 3
    s_add_u32 s32, s32, s33
    s_add_u32 s32, s32, s47
    s_mul_i32 s54, s32, 163840
    s_add_u32 s54, s54, s50
    s_add_u32 s46, s46, 1
    s_add_u32 m0, s48, 42240
    s_add_u32 s32, s54, 0
    buffer_load_dwordx4 v4, s[80:83], s32 offen lds
    s_add_u32 m0, s48, 43296
    s_add_u32 s32, s54, 1280
    buffer_load_dwordx4 v4, s[80:83], s32 offen lds
    s_add_u32 m0, s48, 44352
    s_add_u32 s32, s54, 2560
    buffer_load_dwordx4 v4, s[80:83], s32 offen lds
    s_add_u32 m0, s48, 45408
    s_add_u32 s32, s54, 3840
    buffer_load_dwordx4 v4, s[80:83], s32 offen lds
    s_add_u32 m0, s48, 46464
    s_add_u32 s32, s54, 10240
    buffer_load_dwordx4 v4, s[80:83], s32 offen lds
    s_add_u32 m0, s48, 47520
    s_add_u32 s32, s54, 11520
    buffer_load_dwordx4 v4, s[80:83], s32 offen lds
    s_add_u32 m0, s48, 48576
    s_add_u32 s32, s54, 12800
    buffer_load_dwordx4 v4, s[80:83], s32 offen lds
    s_add_u32 m0, s48, 49632
    s_add_u32 s32, s54, 14080
    buffer_load_dwordx4 v4, s[80:83], s32 offen lds
    s_add_u32 m0, s48, 50688
    s_add_u32 s32, s54, 40960
    buffer_load_dwordx4 v4, s[80:83], s32 offen lds
    s_add_u32 m0, s48, 51744
    s_add_u32 s32, s54, 42240
    buffer_load_dwordx4 v4, s[80:83], s32 offen lds
    s_add_u32 m0, s48, 52800
    s_add_u32 s32, s54, 43520
    buffer_load_dwordx4 v4, s[80:83], s32 offen lds
    s_add_u32 m0, s48, 53856
    s_add_u32 s32, s54, 44800
    buffer_load_dwordx4 v4, s[80:83], s32 offen lds
    s_add_u32 m0, s48, 54912
    s_add_u32 s32, s54, 51200
    buffer_load_dwordx4 v4, s[80:83], s32 offen lds
    s_add_u32 m0, s48, 55968
    s_add_u32 s32, s54, 52480
    buffer_load_dwordx4 v4, s[80:83], s32 offen lds
    s_add_u32 m0, s48, 57024
    s_add_u32 s32, s54, 53760
    buffer_load_dwordx4 v4, s[80:83], s32 offen lds
    s_add_u32 m0, s48, 58080
    s_add_u32 s32, s54, 55040
    buffer_load_dwordx4 v4, s[80:83], s32 offen lds
H_nw:
    s_waitcnt vmcnt(20)
    s_barrier
    s_cmp_eq_u32 s3, 6
    s_cbranch_scc0 H_nw3
    s_waitcnt vmcnt(0)
    s_branch H_nw2
H_nw3:
    s_add_u32 s32, s46, s55
    s_and_b32 s32, s32, 7
    s_lshl_b32 s32, s32, 1
    s_lshr_b32 s33, s46, 3
    s_add_u32 s32, s32, s33
    s_add_u32 s32, s32, s47
    s_mul_i32 s54, s32, 163840
    s_add_u32 s54, s54, s50
    s_add_u32 s46, s46, 1
    s_add_u32 m0, s48, 76032
    s_add_u32 s32, s54, 0
    buffer_load_dwordx4 v4, s[80:83], s32 offen lds
    s_add_u32 m0, s48, 77088
    s_add_u32 s32, s54, 1280
    buffer_load_dwordx4 v4, s[80:83], s32 offen lds
    s_add_u32 m0, s48, 78144
    s_add_u32 s32, s54, 2560
    buffer_load_dwordx4 v4, s[80:83], s32 offen lds
    s_add_u32 m0, s48, 79200
    s_add_u32 s32, s54, 3840
    buffer_load_dwordx4 v4, s[80:83], s32 offen lds
    s_add_u32 m0, s48, 80256
    s_add_u32 s32, s54, 10240
    buffer_load_dwordx4 v4, s[80:83], s32 offen lds
    s_add_u32 m0, s48, 81312
    s_add_u32 s32, s54, 11520
    buffer_load_dwordx4 v4, s[80:83], s32 offen lds
    s_add_u32 m0, s48, 82368
    s_add_u32 s32, s54, 12800
    buffer_load_dwordx4 v4, s[80:83], s32 offen lds
    s_add_u32 m0, s48, 83424
    s_add_u32 s32, s54, 14080
    buffer_load_dwordx4 v4, s[80:83], s32 offen lds
    s_add_u32 m0, s48, 84480
    s_add_u32 s32, s54, 40960
    buffer_load_dwordx4 v4, s[80:83], s32 offen lds
    s_add_u32 m0, s48, 85536
    s_add_u32 s32, s54, 42240
    buffer_load_dwordx4 v4, s[80:83], s32 offen lds
    s_add_u32 m0, s48, 86592
    s_add_u32 s32, s54, 43520
    buffer_load_dwordx4 v4, s[80:83], s32 offen lds
    s_add_u32 m0, s48, 87648
    s_add_u32 s32, s54, 44800
    buffer_load_dwordx4 v4, s[80:83], s32 offen lds
    s_add_u32 m0, s48, 88704
    s_add_u32 s32, s54, 51200
    buffer_load_dwordx4 v4, s[80:83], s32 offen lds
    s_add_u32 m0, s48, 89760
    s_add_u32 s32, s54, 52480
    buffer_load_dwordx4 v4, s[80:83], s32 offen lds
    s_add_u32 m0, s48, 90816
    s_add_u32 s32, s54, 53760
    buffer_load_dwordx4 v4, s[80:83], s32 offen lds
    s_add_u32 m0, s48, 91872
    s_add_u32 s32, s54, 55040
    buffer_load_dwordx4 v4, s[80:83], s32 offen lds
    s_waitcnt vmcnt(32)
H_nw2:
    s_barrier
    s_add_u32 s32, s13, s55
    s_and_b32 s32, s32, 7
    s_lshl_b32 s32, s32, 1
    s_lshr_b32 s33, s13, 3
    s_add_u32 s32, s32, s33
    s_add_u32 s32, s32, s47
    s_mul_i32 s53, s32, 36864
    s_add_u32 s53, s53, s58
    s_add_u32 s13, s13, 1
    s_add_u32 s32, s53, 9216
    buffer_load_dwordx4 v[168:171], v2, s[20:23], s53 offen sc1
    buffer_load_dwordx4 v[172:175], v3, s[20:23], s53 offen sc1
    buffer_load_dwordx4 v[176:179], v2, s[20:23], s32 offen sc1
    buffer_load_dwordx4 v[180:183], v3, s[20:23], s32 offen sc1
    s_add_u32 s32, s13, s55
    s_and_b32 s32, s32, 7
    s_lshl_b32 s32, s32, 1
    s_lshr_b32 s33, s13, 3
    s_add_u32 s32, s32, s33
    s_add_u32 s32, s32, s47
    s_mul_i32 s53, s32, 36864
    s_add_u32 s53, s53, s58
    s_add_u32 s13, s13, 1
    s_add_u32 s32, s53, 9216
    buffer_load_dwordx4 v[184:187], v2, s[20:23], s53 offen sc1
    buffer_load_dwordx4 v[188:191], v3, s[20:23], s53 offen sc1
    buffer_load_dwordx4 v[192:195], v2, s[20:23], s32 offen sc1
    buffer_load_dwordx4 v[196:199], v3, s[20:23], s32 offen sc1
    s_waitcnt vmcnt(24)
    s_barrier
    s_waitcnt vmcnt(8)
    s_branch L_tail2
H_ni:
    s_waitcnt vmcnt(4)
    s_barrier
    s_waitcnt vmcnt(0)
    s_barrier
    s_barrier
    s_branch L_tail2
L_tail:
    v_and_b32 v12, 15, v0
    v_lshrrev_b32 v14, 4, v0
    v_and_b32 v1, 1, v14
    v_lshrrev_b32 v9, 1, v14
    v_mul_u32_u24 v4, 5120, v1
    v_mul_u32_u24 v8, 20480, v9
    v_add_u32 v4, v4, v8
    v_lshl_add_u32 v4, v12, 4, v4
    v_mul_u32_u24 v10, 2560, v12
    v_lshl_add_u32 v10, v14, 3, v10
    v_lshlrev_b32 v12, 2, v12
    v_add_u32 v11, s75, v10
    v_add_u32 v10, s74, v10
    v_lshlrev_b32 v13, 4, v0
    v_mov_b32 v8, s72
    v_mov_b32 v9, s73
    v_cmp_eq_u32 vcc, 1, v1
    s_lshl_b32 s32, s71, 3
    s_mov_b32 s12, 0x00ff00ff
    v_cndmask_b32 v8, v8, v9, vcc
    v_add_u32 v12, v12, v8
    s_lshl_b32 s12, s12, s32
    v_bfe_u32 v5, v0, 2, 2
    v_bfe_u32 v8, v0, 4, 1
    v_lshl_add_u32 v5, v8, 2, v5
    v_mul_u32_u24 v5, 1056, v5
    v_lshrrev_b32 v8, 5, v0
    v_lshl_add_u32 v5, v8, 9, v5
    v_and_b32 v8, 3, v0
    v_lshl_add_u32 v5, v8, 3, v5
    s_mul_i32 s32, s45, 16896
    v_add_u32 v5, s32, v5
    s_mov_b32 s46, 0
    s_mul_i32 s48, s45, 16896
    s_mul_i32 s50, s45, 81920
    s_lshl_b32 s32, s69, 8
    s_add_u32 s50, s50, s32
    s_mov_b32 s46, 2
L_tail2:
    s_barrier
    v_mov_b32 v9, 163584
    ds_read_b32 v8, v9
    s_add_u32 s36, s36, 36864
    s_add_u32 s32, s3, 0
    s_min_u32 s32, s32, 35
    s_lshl_b32 s32, s32, 10
    v_add_u32 v14, s32, v13
    ds_read_b128 v[112:115], v14
    s_add_u32 s60, s32, s36
    s_add_u32 s32, s3, 8
    s_min_u32 s32, s32, 35
    s_lshl_b32 s32, s32, 10
    v_add_u32 v14, s32, v13
    ds_read_b128 v[116:119], v14
    s_add_u32 s61, s32, s36
    s_add_u32 s32, s3, 16
    s_min_u32 s32, s32, 35
    s_lshl_b32 s32, s32, 10
    v_add_u32 v14, s32, v13
    ds_read_b128 v[120:123], v14
    s_add_u32 s62, s32, s36
    s_add_u32 s32, s3, 24
    s_min_u32 s32, s32, 35
    s_lshl_b32 s32, s32, 10
    v_add_u32 v14, s32, v13
    ds_read_b128 v[124:127], v14
    s_add_u32 s63, s32, s36
    s_add_u32 s32, s3, 32
    s_min_u32 s32, s32, 35
    s_lshl_b32 s32, s32, 10
    v_add_u32 v14, s32, v13
    ds_read_b128 v[128:131], v14
    s_add_u32 s51, s32, s36
    s_waitcnt lgkmcnt(0)
    v_readfirstlane_b32 s14, v8
    buffer_store_dwordx4 v[112:115], v13, s[20:23], s60 offen sc1
    buffer_store_dwordx4 v[116:119], v13, s[20:23], s61 offen sc1
    buffer_store_dwordx4 v[120:123], v13, s[20:23], s62 offen sc1
    buffer_store_dwordx4 v[124:127], v13, s[20:23], s63 offen sc1
    buffer_store_dwordx4 v[128:131], v13, s[20:23], s51 offen sc1
    s_cmp_ge_u32 s2, 240
    s_cbranch_scc1 T_ni
    s_cmp_eq_u32 s44, 3
    s_cbranch_scc1 T_ld
    s_lshl_b32 s32, s71, 7
    s_xor_b32 s33, s32, 128
    v_add_u32 v15, s33, v5
    v_add_u32 v5, s32, v5
    v_add_u32 v6, 42240, v5
    v_add_u32 v7, 42240, v15
    ds_read_b64_tr_b16 v[80:81], v6 offset:0
    ds_read_b64_tr_b16 v[82:83], v6 offset:256
    ds_read_b64_tr_b16 v[84:85], v6 offset:32
    ds_read_b64_tr_b16 v[86:87], v6 offset:288
    ds_read_b64_tr_b16 v[88:89], v6 offset:64
    ds_read_b64_tr_b16 v[90:91], v6 offset:320
    ds_read_b64_tr_b16 v[92:93], v6 offset:96
    ds_read_b64_tr_b16 v[94:95], v6 offset:352
    ds_read_b64_tr_b16 v[96:97], v7 offset:0
    ds_read_b64_tr_b16 v[98:99], v7 offset:256
    ds_read_b64_tr_b16 v[100:101], v7 offset:32
    ds_read_b64_tr_b16 v[102:103], v7 offset:288
    ds_read_b64_tr_b16 v[104:105], v7 offset:64
    ds_read_b64_tr_b16 v[106:107], v7 offset:320
    ds_read_b64_tr_b16 v[108:109], v7 offset:96
    ds_read_b64_tr_b16 v[110:111], v7 offset:352
    v_mov_b32 v16, 0
    v_mov_b32 v17, 0
    v_mov_b32 v18, 0
    v_mov_b32 v19, 0
    v_mov_b32 v20, 0
    v_mov_b32 v21, 0
    v_mov_b32 v22, 0
    v_mov_b32 v23, 0
    v_mov_b32 v24, 0
    v_mov_b32 v25, 0
    v_mov_b32 v26, 0
    v_mov_b32 v27, 0
    v_mov_b32 v28, 0
    v_mov_b32 v29, 0
    v_mov_b32 v30, 0
    v_mov_b32 v31, 0
    v_mov_b32 v32, 0
    v_mov_b32 v33, 0
    v_mov_b32 v34, 0
    v_mov_b32 v35, 0
    v_mov_b32 v36, 0
    v_mov_b32 v37, 0
    v_mov_b32 v38, 0
    v_mov_b32 v39, 0
    v_mov_b32 v40, 0
    v_mov_b32 v41, 0
    v_mov_b32 v42, 0
    v_mov_b32 v43, 0
    v_mov_b32 v44, 0
    v_mov_b32 v45, 0
    v_mov_b32 v46, 0
    v_mov_b32 v47, 0
    v_mov_b32 v48, 0
    v_mov_b32 v49, 0
    v_mov_b32 v50, 0
    v_mov_b32 v51, 0
    v_mov_b32 v52, 0
    v_mov_b32 v53, 0
    v_mov_b32 v54, 0
    v_mov_b32 v55, 0
    v_mov_b32 v56, 0
    v_mov_b32 v57, 0
    v_mov_b32 v58, 0
    v_mov_b32 v59, 0
    v_mov_b32 v60, 0
    v_mov_b32 v61, 0
    v_mov_b32 v62, 0
    v_mov_b32 v63, 0
    v_mov_b32 v64, 0
    v_mov_b32 v65, 0
    v_mov_b32 v66, 0
    v_mov_b32 v67, 0
    v_mov_b32 v68, 0
    v_mov_b32 v69, 0
    v_mov_b32 v70, 0
    v_mov_b32 v71, 0
    v_mov_b32 v72, 0
    v_mov_b32 v73, 0
    v_mov_b32 v74, 0
    v_mov_b32 v75, 0
    v_mov_b32 v76, 0
    v_mov_b32 v77, 0
    v_mov_b32 v78, 0
    v_mov_b32 v79, 0
    s_mov_b32 s49, 0
    s_waitcnt vmcnt(5) lgkmcnt(0)
    s_barrier
T_loop:
    s_waitcnt lgkmcnt(12)
    v_mfma_f32_16x16x32_bf16 v[16:19], v[80:83], v[168:171], v[16:19]
    v_add_u32 v6, 50688, v5
    v_add_u32 v7, 50688, v15
    v_mfma_f32_16x16x32_bf16 v[20:23], v[80:83], v[172:175], v[20:23]
    ds_read_b64_tr_b16 v[80:81], v6 offset:0
    s_add_u32 s32, s13, s55
    v_mfma_f32_16x16x32_bf16 v[24:27], v[84:87], v[168:171], v[24:27]
    ds_read_b64_tr_b16 v[82:83], v6 offset:256
    s_and_b32 s32, s32, 7
    v_mfma_f32_16x16x32_bf16 v[28:31], v[84:87], v[172:175], v[28:31]
    ds_read_b64_tr_b16 v[84:85], v6 offset:32
    s_lshl_b32 s32, s32, 1
    s_lshr_b32 s33, s13, 3
    s_waitcnt lgkmcnt(11)
    v_mfma_f32_16x16x32_bf16 v[32:35], v[88:91], v[168:171], v[32:35]
    ds_read_b64_tr_b16 v[86:87], v6 offset:288
    s_add_u32 s32, s32, s33
    v_mfma_f32_16x16x32_bf16 v[36:39], v[88:91], v[172:175], v[36:39]
    ds_read_b64_tr_b16 v[88:89], v6 offset:64
    s_add_u32 s32, s32, s47
    v_mfma_f32_16x16x32_bf16 v[40:43], v[92:95], v[168:171], v[40:43]
    ds_read_b64_tr_b16 v[90:91], v6 offset:320
    s_mul_i32 s53, s32, 36864
    v_mfma_f32_16x16x32_bf16 v[44:47], v[92:95], v[172:175], v[44:47]
    ds_read_b64_tr_b16 v[92:93], v6 offset:96
    s_add_u32 s53, s53, s58
    s_cmp_ge_u32 s13, 16
    s_waitcnt lgkmcnt(11)
    v_mfma_f32_16x16x32_bf16 v[48:51], v[96:99], v[168:171], v[48:51]
    ds_read_b64_tr_b16 v[94:95], v6 offset:352
    s_cselect_b32 s53, 0x7f000000, s53
    v_mfma_f32_16x16x32_bf16 v[52:55], v[96:99], v[172:175], v[52:55]
    ds_read_b64_tr_b16 v[96:97], v7 offset:0
    s_add_u32 s13, s13, 1
    v_mfma_f32_16x16x32_bf16 v[56:59], v[100:103], v[168:171], v[56:59]
    ds_read_b64_tr_b16 v[98:99], v7 offset:256
    s_add_u32 s32, s53, 9216
    v_mfma_f32_16x16x32_bf16 v[60:63], v[100:103], v[172:175], v[60:63]
    ds_read_b64_tr_b16 v[100:101], v7 offset:32
    buffer_load_dwordx4 v[200:203], v2, s[20:23], s53 offen sc1
    buffer_load_dwordx4 v[204:207], v3, s[20:23], s53 offen sc1
    s_waitcnt lgkmcnt(11)
    v_mfma_f32_16x16x32_bf16 v[64:67], v[104:107], v[168:171], v[64:67]
    ds_read_b64_tr_b16 v[102:103], v7 offset:288
    buffer_load_dwordx4 v[208:211], v2, s[20:23], s32 offen sc1
    v_mfma_f32_16x16x32_bf16 v[68:71], v[104:107], v[172:175], v[68:71]
    ds_read_b64_tr_b16 v[104:105], v7 offset:64
    buffer_load_dwordx4 v[212:215], v3, s[20:23], s32 offen sc1
    v_mfma_f32_16x16x32_bf16 v[72:75], v[108:111], v[168:171], v[72:75]
    ds_read_b64_tr_b16 v[106:107], v7 offset:320
    v_mfma_f32_16x16x32_bf16 v[76:79], v[108:111], v[172:175], v[76:79]
    ds_read_b64_tr_b16 v[108:109], v7 offset:96
    ds_read_b64_tr_b16 v[110:111], v7 offset:352
    s_waitcnt lgkmcnt(12)
    v_mfma_f32_16x16x32_bf16 v[16:19], v[80:83], v[176:179], v[16:19]
    v_add_u32 v6, 76032, v5
    v_add_u32 v7, 76032, v15
    v_mfma_f32_16x16x32_bf16 v[20:23], v[80:83], v[180:183], v[20:23]
    ds_read_b64_tr_b16 v[80:81], v6 offset:0
    v_mfma_f32_16x16x32_bf16 v[24:27], v[84:87], v[176:179], v[24:27]
    ds_read_b64_tr_b16 v[82:83], v6 offset:256
    v_mfma_f32_16x16x32_bf16 v[28:31], v[84:87], v[180:183], v[28:31]
    ds_read_b64_tr_b16 v[84:85], v6 offset:32
    s_waitcnt lgkmcnt(11)
    v_mfma_f32_16x16x32_bf16 v[32:35], v[88:91], v[176:179], v[32:35]
    ds_read_b64_tr_b16 v[86:87], v6 offset:288
    v_mfma_f32_16x16x32_bf16 v[36:39], v[88:91], v[180:183], v[36:39]
    ds_read_b64_tr_b16 v[88:89], v6 offset:64
    v_mfma_f32_16x16x32_bf16 v[40:43], v[92:95], v[176:179], v[40:43]
    ds_read_b64_tr_b16 v[90:91], v6 offset:320
    v_mfma_f32_16x16x32_bf16 v[44:47], v[92:95], v[180:183], v[44:47]
    ds_read_b64_tr_b16 v[92:93], v6 offset:96
    s_waitcnt lgkmcnt(11)
    v_mfma_f32_16x16x32_bf16 v[48:51], v[96:99], v[176:179], v[48:51]
    ds_read_b64_tr_b16 v[94:95], v6 offset:352
    v_mfma_f32_16x16x32_bf16 v[52:55], v[96:99], v[180:183], v[52:55]
    ds_read_b64_tr_b16 v[96:97], v7 offset:0
    v_mfma_f32_16x16x32_bf16 v[56:59], v[100:103], v[176:179], v[56:59]
    ds_read_b64_tr_b16 v[98:99], v7 offset:256
    v_mfma_f32_16x16x32_bf16 v[60:63], v[100:103], v[180:183], v[60:63]
    ds_read_b64_tr_b16 v[100:101], v7 offset:32
    s_waitcnt lgkmcnt(11)
    v_mfma_f32_16x16x32_bf16 v[64:67], v[104:107], v[176:179], v[64:67]
    ds_read_b64_tr_b16 v[102:103], v7 offset:288
    v_mfma_f32_16x16x32_bf16 v[68:71], v[104:107], v[180:183], v[68:71]
    ds_read_b64_tr_b16 v[104:105], v7 offset:64
    v_mfma_f32_16x16x32_bf16 v[72:75], v[108:111], v[176:179], v[72:75]
    ds_read_b64_tr_b16 v[106:107], v7 offset:320
    v_mfma_f32_16x16x32_bf16 v[76:79], v[108:111], v[180:183], v[76:79]
    ds_read_b64_tr_b16 v[108:109], v7 offset:96
    ds_read_b64_tr_b16 v[110:111], v7 offset:352
    s_waitcnt vmcnt(4)
    s_barrier
    s_cmp_lg_u32 s49, 0
    s_cbranch_scc1 Tp_73
    s_cmp_lg_u32 s3, 4
    s_cbranch_scc1 pub_74
    v_mov_b32 v8, s14
    v_mov_b32 v9, 0
    s_mov_b64 exec, 1
    buffer_store_dword v8, v9, s[20:23], s57 offen offset:256 sc1
    s_mov_b64 exec, -1
pub_74:
Tp_73:
    s_waitcnt lgkmcnt(12)
    v_mfma_f32_16x16x32_bf16 v[16:19], v[80:83], v[184:187], v[16:19]
    v_add_u32 v6, 84480, v5
    v_add_u32 v7, 84480, v15
    v_mfma_f32_16x16x32_bf16 v[20:23], v[80:83], v[188:191], v[20:23]
    ds_read_b64_tr_b16 v[80:81], v6 offset:0
    s_add_u32 s32, s13, s55
    v_mfma_f32_16x16x32_bf16 v[24:27], v[84:87], v[184:187], v[24:27]
    ds_read_b64_tr_b16 v[82:83], v6 offset:256
    s_and_b32 s32, s32, 7
    v_mfma_f32_16x16x32_bf16 v[28:31], v[84:87], v[188:191], v[28:31]
    ds_read_b64_tr_b16 v[84:85], v6 offset:32
    s_lshl_b32 s32, s32, 1
    s_lshr_b32 s33, s13, 3
    s_waitcnt lgkmcnt(11)
    v_mfma_f32_16x16x32_bf16 v[32:35], v[88:91], v[184:187], v[32:35]
    ds_read_b64_tr_b16 v[86:87], v6 offset:288
    s_add_u32 s32, s32, s33
    v_mfma_f32_16x16x32_bf16 v[36:39], v[88:91], v[188:191], v[36:39]
    ds_read_b64_tr_b16 v[88:89], v6 offset:64
    s_add_u32 s32, s32, s47
    v_mfma_f32_16x16x32_bf16 v[40:43], v[92:95], v[184:187], v[40:43]
    ds_read_b64_tr_b16 v[90:91], v6 offset:320
    s_mul_i32 s53, s32, 36864
    v_mfma_f32_16x16x32_bf16 v[44:47], v[92:95], v[188:191], v[44:47]
    ds_read_b64_tr_b16 v[92:93], v6 offset:96
    s_add_u32 s53, s53, s58
    s_cmp_ge_u32 s13, 16
    s_waitcnt lgkmcnt(11)
    v_mfma_f32_16x16x32_bf16 v[48:51], v[96:99], v[184:187], v[48:51]
    ds_read_b64_tr_b16 v[94:95], v6 offset:352
    s_cselect_b32 s53, 0x7f000000, s53
    v_mfma_f32_16x16x32_bf16 v[52:55], v[96:99], v[188:191], v[52:55]
    ds_read_b64_tr_b16 v[96:97], v7 offset:0
    s_add_u32 s13, s13, 1
    v_mfma_f32_16x16x32_bf16 v[56:59], v[100:103], v[184:187], v[56:59]
    ds_read_b64_tr_b16 v[98:99], v7 offset:256
    s_add_u32 s32, s53, 9216
    v_mfma_f32_16x16x32_bf16 v[60:63], v[100:103], v[188:191], v[60:63]
    ds_read_b64_tr_b16 v[100:101], v7 offset:32
    buffer_load_dwordx4 v[216:219], v2, s[20:23], s53 offen sc1
    buffer_load_dwordx4 v[220:223], v3, s[20:23], s53 offen sc1
    s_waitcnt lgkmcnt(11)
    v_mfma_f32_16x16x32_bf16 v[64:67], v[104:107], v[184:187], v[64:67]
    ds_read_b64_tr_b16 v[102:103], v7 offset:288
    buffer_load_dwordx4 v[224:227], v2, s[20:23], s32 offen sc1
    v_mfma_f32_16x16x32_bf16 v[68:71], v[104:107], v[188:191], v[68:71]
    ds_read_b64_tr_b16 v[104:105], v7 offset:64
    buffer_load_dwordx4 v[228:231], v3, s[20:23], s32 offen sc1
    v_mfma_f32_16x16x32_bf16 v[72:75], v[108:111], v[184:187], v[72:75]
    ds_read_b64_tr_b16 v[106:107], v7 offset:320
    v_mfma_f32_16x16x32_bf16 v[76:79], v[108:111], v[188:191], v[76:79]
    ds_read_b64_tr_b16 v[108:109], v7 offset:96
    ds_read_b64_tr_b16 v[110:111], v7 offset:352
    s_waitcnt lgkmcnt(12)
    v_mfma_f32_16x16x32_bf16 v[16:19], v[80:83], v[192:195], v[16:19]
    v_add_u32 v6, 109824, v5
    v_add_u32 v7, 109824, v15
    v_mfma_f32_16x16x32_bf16 v[20:23], v[80:83], v[196:199], v[20:23]
    ds_read_b64_tr_b16 v[80:81], v6 offset:0
    v_mfma_f32_16x16x32_bf16 v[24:27], v[84:87], v[192:195], v[24:27]
    ds_read_b64_tr_b16 v[82:83], v6 offset:256
    v_mfma_f32_16x16x32_bf16 v[28:31], v[84:87], v[196:199], v[28:31]
    ds_read_b64_tr_b16 v[84:85], v6 offset:32
    s_waitcnt lgkmcnt(11)
    v_mfma_f32_16x16x32_bf16 v[32:35], v[88:91], v[192:195], v[32:35]
    ds_read_b64_tr_b16 v[86:87], v6 offset:288
    v_mfma_f32_16x16x32_bf16 v[36:39], v[88:91], v[196:199], v[36:39]
    ds_read_b64_tr_b16 v[88:89], v6 offset:64
    v_mfma_f32_16x16x32_bf16 v[40:43], v[92:95], v[192:195], v[40:43]
    ds_read_b64_tr_b16 v[90:91], v6 offset:320
    v_mfma_f32_16x16x32_bf16 v[44:47], v[92:95], v[196:199], v[44:47]
    ds_read_b64_tr_b16 v[92:93], v6 offset:96
    s_waitcnt lgkmcnt(11)
    v_mfma_f32_16x16x32_bf16 v[48:51], v[96:99], v[192:195], v[48:51]
    ds_read_b64_tr_b16 v[94:95], v6 offset:352
    v_mfma_f32_16x16x32_bf16 v[52:55], v[96:99], v[196:199], v[52:55]
    ds_read_b64_tr_b16 v[96:97], v7 offset:0
    v_mfma_f32_16x16x32_bf16 v[56:59], v[100:103], v[192:195], v[56:59]
    ds_read_b64_tr_b16 v[98:99], v7 offset:256
    v_mfma_f32_16x16x32_bf16 v[60:63], v[100:103], v[196:199], v[60:63]
    ds_read_b64_tr_b16 v[100:101], v7 offset:32
    s_waitcnt lgkmcnt(11)
    v_mfma_f32_16x16x32_bf16 v[64:67], v[104:107], v[192:195], v[64:67]
    ds_read_b64_tr_b16 v[102:103], v7 offset:288
    v_mfma_f32_16x16x32_bf16 v[68:71], v[104:107], v[196:199], v[68:71]
    ds_read_b64_tr_b16 v[104:105], v7 offset:64
    v_mfma_f32_16x16x32_bf16 v[72:75], v[108:111], v[192:195], v[72:75]
    ds_read_b64_tr_b16 v[106:107], v7 offset:320
    v_mfma_f32_16x16x32_bf16 v[76:79], v[108:111], v[196:199], v[76:79]
    ds_read_b64_tr_b16 v[108:109], v7 offset:96
    ds_read_b64_tr_b16 v[110:111], v7 offset:352
    s_waitcnt vmcnt(4)
    s_barrier
    s_cmp_lg_u32 s49, 4
    s_cbranch_scc1 Tp_75
    s_mov_b32 s33, 0x8000
    s_mov_b32 s34, 18874624
poll_76:
    buffer_load_dword v8, v12, s[20:23], s34 offen sc1
    s_waitcnt vmcnt(0)
    v_cmp_ne_u32 vcc, s14, v8
    s_and_b32 vcc_lo, vcc_lo, s12
    s_cbranch_scc0 polld_77
    s_sleep 8
    s_sub_u32 s33, s33, 1
    s_cmp_lg_u32 s33, 0
    s_cbranch_scc1 poll_76
polld_77:
Tp_75:
    s_waitcnt lgkmcnt(12)
    v_mfma_f32_16x16x32_bf16 v[16:19], v[80:83], v[200:203], v[16:19]
    v_add_u32 v6, 118272, v5
    v_add_u32 v7, 118272, v15
    v_mfma_f32_16x16x32_bf16 v[20:23], v[80:83], v[204:207], v[20:23]
    ds_read_b64_tr_b16 v[80:81], v6 offset:0
    s_add_u32 s32, s13, s55
    v_mfma_f32_16x16x32_bf16 v[24:27], v[84:87], v[200:203], v[24:27]
    ds_read_b64_tr_b16 v[82:83], v6 offset:256
    s_and_b32 s32, s32, 7
    v_mfma_f32_16x16x32_bf16 v[28:31], v[84:87], v[204:207], v[28:31]
    ds_read_b64_tr_b16 v[84:85], v6 offset:32
    s_lshl_b32 s32, s32, 1
    s_lshr_b32 s33, s13, 3
    s_waitcnt lgkmcnt(11)
    v_mfma_f32_16x16x32_bf16 v[32:35], v[88:91], v[200:203], v[32:35]
    ds_read_b64_tr_b16 v[86:87], v6 offset:288
    s_add_u32 s32, s32, s33
    v_mfma_f32_16x16x32_bf16 v[36:39], v[88:91], v[204:207], v[36:39]
    ds_read_b64_tr_b16 v[88:89], v6 offset:64
    s_add_u32 s32, s32, s47
    v_mfma_f32_16x16x32_bf16 v[40:43], v[92:95], v[200:203], v[40:43]
    ds_read_b64_tr_b16 v[90:91], v6 offset:320
    s_mul_i32 s53, s32, 36864
    v_mfma_f32_16x16x32_bf16 v[44:47], v[92:95], v[204:207], v[44:47]
    ds_read_b64_tr_b16 v[92:93], v6 offset:96
    s_add_u32 s53, s53, s58
    s_cmp_ge_u32 s13, 16
    s_waitcnt lgkmcnt(11)
    v_mfma_f32_16x16x32_bf16 v[48:51], v[96:99], v[200:203], v[48:51]
    ds_read_b64_tr_b16 v[94:95], v6 offset:352
    s_cselect_b32 s53, 0x7f000000, s53
    v_mfma_f32_16x16x32_bf16 v[52:55], v[96:99], v[204:207], v[52:55]
    ds_read_b64_tr_b16 v[96:97], v7 offset:0
    s_add_u32 s13, s13, 1
    v_mfma_f32_16x16x32_bf16 v[56:59], v[100:103], v[200:203], v[56:59]
    ds_read_b64_tr_b16 v[98:99], v7 offset:256
    s_add_u32 s32, s53, 9216
    v_mfma_f32_16x16x32_bf16 v[60:63], v[100:103], v[204:207], v[60:63]
    ds_read_b64_tr_b16 v[100:101], v7 offset:32
    buffer_load_dwordx4 v[168:171], v2, s[20:23], s53 offen sc1
    buffer_load_dwordx4 v[172:175], v3, s[20:23], s53 offen sc1
    s_waitcnt lgkmcnt(11)
    v_mfma_f32_16x16x32_bf16 v[64:67], v[104:107], v[200:203], v[64:67]
    ds_read_b64_tr_b16 v[102:103], v7 offset:288
    buffer_load_dwordx4 v[176:179], v2, s[20:23], s32 offen sc1
    v_mfma_f32_16x16x32_bf16 v[68:71], v[104:107], v[204:207], v[68:71]
    ds_read_b64_tr_b16 v[104:105], v7 offset:64
    buffer_load_dwordx4 v[180:183], v3, s[20:23], s32 offen sc1
    v_mfma_f32_16x16x32_bf16 v[72:75], v[108:111], v[200:203], v[72:75]
    ds_read_b64_tr_b16 v[106:107], v7 offset:320
    v_mfma_f32_16x16x32_bf16 v[76:79], v[108:111], v[204:207], v[76:79]
    ds_read_b64_tr_b16 v[108:109], v7 offset:96
    ds_read_b64_tr_b16 v[110:111], v7 offset:352
    s_waitcnt lgkmcnt(12)
    v_mfma_f32_16x16x32_bf16 v[16:19], v[80:83], v[208:211], v[16:19]
    v_add_u32 v6, 0, v5
    v_add_u32 v7, 0, v15
    v_mfma_f32_16x16x32_bf16 v[20:23], v[80:83], v[212:215], v[20:23]
    ds_read_b64_tr_b16 v[80:81], v6 offset:0
    v_mfma_f32_16x16x32_bf16 v[24:27], v[84:87], v[208:211], v[24:27]
    ds_read_b64_tr_b16 v[82:83], v6 offset:256
    v_mfma_f32_16x16x32_bf16 v[28:31], v[84:87], v[212:215], v[28:31]
    ds_read_b64_tr_b16 v[84:85], v6 offset:32
    s_waitcnt lgkmcnt(11)
    v_mfma_f32_16x16x32_bf16 v[32:35], v[88:91], v[208:211], v[32:35]
    ds_read_b64_tr_b16 v[86:87], v6 offset:288
    v_mfma_f32_16x16x32_bf16 v[36:39], v[88:91], v[212:215], v[36:39]
    ds_read_b64_tr_b16 v[88:89], v6 offset:64
    v_mfma_f32_16x16x32_bf16 v[40:43], v[92:95], v[208:211], v[40:43]
    ds_read_b64_tr_b16 v[90:91], v6 offset:320
    v_mfma_f32_16x16x32_bf16 v[44:47], v[92:95], v[212:215], v[44:47]
    ds_read_b64_tr_b16 v[92:93], v6 offset:96
    s_waitcnt lgkmcnt(11)
    v_mfma_f32_16x16x32_bf16 v[48:51], v[96:99], v[208:211], v[48:51]
    ds_read_b64_tr_b16 v[94:95], v6 offset:352
    v_mfma_f32_16x16x32_bf16 v[52:55], v[96:99], v[212:215], v[52:55]
    ds_read_b64_tr_b16 v[96:97], v7 offset:0
    v_mfma_f32_16x16x32_bf16 v[56:59], v[100:103], v[208:211], v[56:59]
    ds_read_b64_tr_b16 v[98:99], v7 offset:256
    v_mfma_f32_16x16x32_bf16 v[60:63], v[100:103], v[212:215], v[60:63]
    ds_read_b64_tr_b16 v[100:101], v7 offset:32
    s_waitcnt lgkmcnt(11)
    v_mfma_f32_16x16x32_bf16 v[64:67], v[104:107], v[208:211], v[64:67]
    ds_read_b64_tr_b16 v[102:103], v7 offset:288
    v_mfma_f32_16x16x32_bf16 v[68:71], v[104:107], v[212:215], v[68:71]
    ds_read_b64_tr_b16 v[104:105], v7 offset:64
    v_mfma_f32_16x16x32_bf16 v[72:75], v[108:111], v[208:211], v[72:75]
    ds_read_b64_tr_b16 v[106:107], v7 offset:320
    v_mfma_f32_16x16x32_bf16 v[76:79], v[108:111], v[212:215], v[76:79]
    ds_read_b64_tr_b16 v[108:109], v7 offset:96
    ds_read_b64_tr_b16 v[110:111], v7 offset:352
    s_waitcnt vmcnt(4)
    s_barrier
    s_waitcnt lgkmcnt(12)
    v_mfma_f32_16x16x32_bf16 v[16:19], v[80:83], v[216:219], v[16:19]
    v_add_u32 v6, 8448, v5
    v_add_u32 v7, 8448, v15
    v_mfma_f32_16x16x32_bf16 v[20:23], v[80:83], v[220:223], v[20:23]
    ds_read_b64_tr_b16 v[80:81], v6 offset:0
    s_add_u32 s32, s13, s55
    v_mfma_f32_16x16x32_bf16 v[24:27], v[84:87], v[216:219], v[24:27]
    ds_read_b64_tr_b16 v[82:83], v6 offset:256
    s_and_b32 s32, s32, 7
    v_mfma_f32_16x16x32_bf16 v[28:31], v[84:87], v[220:223], v[28:31]
    ds_read_b64_tr_b16 v[84:85], v6 offset:32
    s_lshl_b32 s32, s32, 1
    s_lshr_b32 s33, s13, 3
    s_waitcnt lgkmcnt(11)
    v_mfma_f32_16x16x32_bf16 v[32:35], v[88:91], v[216:219], v[32:35]
    ds_read_b64_tr_b16 v[86:87], v6 offset:288
    s_add_u32 s32, s32, s33
    v_mfma_f32_16x16x32_bf16 v[36:39], v[88:91], v[220:223], v[36:39]
    ds_read_b64_tr_b16 v[88:89], v6 offset:64
    s_add_u32 s32, s32, s47
    v_mfma_f32_16x16x32_bf16 v[40:43], v[92:95], v[216:219], v[40:43]
    ds_read_b64_tr_b16 v[90:91], v6 offset:320
    s_mul_i32 s53, s32, 36864
    v_mfma_f32_16x16x32_bf16 v[44:47], v[92:95], v[220:223], v[44:47]
    ds_read_b64_tr_b16 v[92:93], v6 offset:96
    s_add_u32 s53, s53, s58
    s_cmp_ge_u32 s13, 16
    s_waitcnt lgkmcnt(11)
    v_mfma_f32_16x16x32_bf16 v[48:51], v[96:99], v[216:219], v[48:51]
    ds_read_b64_tr_b16 v[94:95], v6 offset:352
    s_cselect_b32 s53, 0x7f000000, s53
    v_mfma_f32_16x16x32_bf16 v[52:55], v[96:99], v[220:223], v[52:55]
    ds_read_b64_tr_b16 v[96:97], v7 offset:0
    s_add_u32 s13, s13, 1
    v_mfma_f32_16x16x32_bf16 v[56:59], v[100:103], v[216:219], v[56:59]
    ds_read_b64_tr_b16 v[98:99], v7 offset:256
    s_add_u32 s32, s53, 9216
    v_mfma_f32_16x16x32_bf16 v[60:63], v[100:103], v[220:223], v[60:63]
    ds_read_b64_tr_b16 v[100:101], v7 offset:32
    buffer_load_dwordx4 v[184:187], v2, s[20:23], s53 offen sc1
    buffer_load_dwordx4 v[188:191], v3, s[20:23], s53 offen sc1
    s_waitcnt lgkmcnt(11)
    v_mfma_f32_16x16x32_bf16 v[64:67], v[104:107], v[216:219], v[64:67]
    ds_read_b64_tr_b16 v[102:103], v7 offset:288
    buffer_load_dwordx4 v[192:195], v2, s[20:23], s32 offen sc1
    v_mfma_f32_16x16x32_bf16 v[68:71], v[104:107], v[220:223], v[68:71]
    ds_read_b64_tr_b16 v[104:105], v7 offset:64
    buffer_load_dwordx4 v[196:199], v3, s[20:23], s32 offen sc1
    v_mfma_f32_16x16x32_bf16 v[72:75], v[108:111], v[216:219], v[72:75]
    ds_read_b64_tr_b16 v[106:107], v7 offset:320
    v_mfma_f32_16x16x32_bf16 v[76:79], v[108:111], v[220:223], v[76:79]
    ds_read_b64_tr_b16 v[108:109], v7 offset:96
    ds_read_b64_tr_b16 v[110:111], v7 offset:352
    s_waitcnt lgkmcnt(12)
    v_mfma_f32_16x16x32_bf16 v[16:19], v[80:83], v[224:227], v[16:19]
    v_add_u32 v6, 42240, v5
    v_add_u32 v7, 42240, v15
    v_mfma_f32_16x16x32_bf16 v[20:23], v[80:83], v[228:231], v[20:23]
    ds_read_b64_tr_b16 v[80:81], v6 offset:0
    v_mfma_f32_16x16x32_bf16 v[24:27], v[84:87], v[224:227], v[24:27]
    ds_read_b64_tr_b16 v[82:83], v6 offset:256
    v_mfma_f32_16x16x32_bf16 v[28:31], v[84:87], v[228:231], v[28:31]
    ds_read_b64_tr_b16 v[84:85], v6 offset:32
    s_waitcnt lgkmcnt(11)
    v_mfma_f32_16x16x32_bf16 v[32:35], v[88:91], v[224:227], v[32:35]
    ds_read_b64_tr_b16 v[86:87], v6 offset:288
    v_mfma_f32_16x16x32_bf16 v[36:39], v[88:91], v[228:231], v[36:39]
    ds_read_b64_tr_b16 v[88:89], v6 offset:64
    v_mfma_f32_16x16x32_bf16 v[40:43], v[92:95], v[224:227], v[40:43]
    ds_read_b64_tr_b16 v[90:91], v6 offset:320
    v_mfma_f32_16x16x32_bf16 v[44:47], v[92:95], v[228:231], v[44:47]
    ds_read_b64_tr_b16 v[92:93], v6 offset:96
    s_waitcnt lgkmcnt(11)
    v_mfma_f32_16x16x32_bf16 v[48:51], v[96:99], v[224:227], v[48:51]
    ds_read_b64_tr_b16 v[94:95], v6 offset:352
    v_mfma_f32_16x16x32_bf16 v[52:55], v[96:99], v[228:231], v[52:55]
    ds_read_b64_tr_b16 v[96:97], v7 offset:0
    v_mfma_f32_16x16x32_bf16 v[56:59], v[100:103], v[224:227], v[56:59]
    ds_read_b64_tr_b16 v[98:99], v7 offset:256
    v_mfma_f32_16x16x32_bf16 v[60:63], v[100:103], v[228:231], v[60:63]
    ds_read_b64_tr_b16 v[100:101], v7 offset:32
    s_waitcnt lgkmcnt(11)
    v_mfma_f32_16x16x32_bf16 v[64:67], v[104:107], v[224:227], v[64:67]
    ds_read_b64_tr_b16 v[102:103], v7 offset:288
    v_mfma_f32_16x16x32_bf16 v[68:71], v[104:107], v[228:231], v[68:71]
    ds_read_b64_tr_b16 v[104:105], v7 offset:64
    v_mfma_f32_16x16x32_bf16 v[72:75], v[108:111], v[224:227], v[72:75]
    ds_read_b64_tr_b16 v[106:107], v7 offset:320
    v_mfma_f32_16x16x32_bf16 v[76:79], v[108:111], v[228:231], v[76:79]
    ds_read_b64_tr_b16 v[108:109], v7 offset:96
    ds_read_b64_tr_b16 v[110:111], v7 offset:352
    s_waitcnt vmcnt(4)
    s_add_u32 s49, s49, 4
    s_cmp_lt_u32 s49, 16
    s_barrier
    s_cbranch_scc1 T_loop
    s_waitcnt lgkmcnt(0)
    s_lshl_b32 s32, s3, 13
    v_add_u32 v14, s32, v13
    s_xor_b32 s32, s32, 32768
    v_add_u32 v9, s32, v13
    s_cmp_eq_u32 s45, 1
    s_cbranch_scc1 T_gb
    ds_write_b128 v14, v[16:19] offset:0
    ds_write_b128 v14, v[20:23] offset:1024
    ds_write_b128 v14, v[24:27] offset:2048
    ds_write_b128 v14, v[28:31] offset:3072
    ds_write_b128 v14, v[32:35] offset:4096
    ds_write_b128 v14, v[36:39] offset:5120
    ds_write_b128 v14, v[40:43] offset:6144
    ds_write_b128 v14, v[44:47] offset:7168
    s_waitcnt lgkmcnt(0)
    s_barrier
    ds_read_b128 v[112:115], v9 offset:0
    ds_read_b128 v[116:119], v9 offset:1024
    ds_read_b128 v[120:123], v9 offset:2048
    ds_read_b128 v[124:127], v9 offset:3072
    ds_read_b128 v[128:131], v9 offset:4096
    ds_read_b128 v[132:135], v9 offset:5120
    ds_read_b128 v[136:139], v9 offset:6144
    ds_read_b128 v[140:143], v9 offset:7168
    s_mul_i32 s32, s2, 24576
    s_lshl_b32 s33, s44, 13
    s_add_u32 s32, s32, s33
    s_add_u32 s32, s32, 18939904
    s_add_u32 s34, s32, 4096
    s_waitcnt lgkmcnt(7)
    v_add_f32 v48, v48, v112
    v_add_f32 v49, v49, v113
    v_add_f32 v50, v50, v114
    v_add_f32 v51, v51, v115
    buffer_store_dwordx4 v[48:51], v13, s[20:23], s32 offen offset:0 sc1
    s_waitcnt lgkmcnt(6)
    v_add_f32 v52, v52, v116
    v_add_f32 v53, v53, v117
    v_add_f32 v54, v54, v118
    v_add_f32 v55, v55, v119
    buffer_store_dwordx4 v[52:55], v13, s[20:23], s32 offen offset:1024 sc1
    s_waitcnt lgkmcnt(5)
    v_add_f32 v56, v56, v120
    v_add_f32 v57, v57, v121
    v_add_f32 v58, v58, v122
    v_add_f32 v59, v59, v123
    buffer_store_dwordx4 v[56:59], v13, s[20:23], s32 offen offset:2048 sc1
    s_waitcnt lgkmcnt(4)
    v_add_f32 v60, v60, v124
    v_add_f32 v61, v61, v125
    v_add_f32 v62, v62, v126
    v_add_f32 v63, v63, v127
    buffer_store_dwordx4 v[60:63], v13, s[20:23], s32 offen offset:3072 sc1
    s_waitcnt lgkmcnt(3)
    v_add_f32 v64, v64, v128
    v_add_f32 v65, v65, v129
    v_add_f32 v66, v66, v130
    v_add_f32 v67, v67, v131
    buffer_store_dwordx4 v[64:67], v13, s[20:23], s34 offen offset:0 sc1
    s_waitcnt lgkmcnt(2)
    v_add_f32 v68, v68, v132
    v_add_f32 v69, v69, v133
    v_add_f32 v70, v70, v134
    v_add_f32 v71, v71, v135
    buffer_store_dwordx4 v[68:71], v13, s[20:23], s34 offen offset:1024 sc1
    s_waitcnt lgkmcnt(1)
    v_add_f32 v72, v72, v136
    v_add_f32 v73, v73, v137
    v_add_f32 v74, v74, v138
    v_add_f32 v75, v75, v139
    buffer_store_dwordx4 v[72:75], v13, s[20:23], s34 offen offset:2048 sc1
    s_waitcnt lgkmcnt(0)
    v_add_f32 v76, v76, v140
    v_add_f32 v77, v77, v141
    v_add_f32 v78, v78, v142
    v_add_f32 v79, v79, v143
    buffer_store_dwordx4 v[76:79], v13, s[20:23], s34 offen offset:3072 sc1
    s_lshl_b32 s57, s2, 7
    s_lshl_b32 s33, s44, 2
    s_add_u32 s57, s57, s33
    s_add_u32 s57, s57, 18882560
    v_mov_b32 v8, s14
    v_mov_b32 v9, 0
    s_mov_b64 exec, 1
    s_waitcnt vmcnt(0)
    buffer_store_dword v8, v9, s[20:23], s57 offen sc1
    s_endpgm
T_gb:
    ds_write_b128 v14, v[48:51] offset:0
    ds_write_b128 v14, v[52:55] offset:1024
    ds_write_b128 v14, v[56:59] offset:2048
    ds_write_b128 v14, v[60:63] offset:3072
    ds_write_b128 v14, v[64:67] offset:4096
    ds_write_b128 v14, v[68:71] offset:5120
    ds_write_b128 v14, v[72:75] offset:6144
    ds_write_b128 v14, v[76:79] offset:7168
    s_waitcnt lgkmcnt(0)
    s_barrier
    ds_read_b128 v[112:115], v9 offset:0
    ds_read_b128 v[116:119], v9 offset:1024
    ds_read_b128 v[120:123], v9 offset:2048
    ds_read_b128 v[124:127], v9 offset:3072
    ds_read_b128 v[128:131], v9 offset:4096
    ds_read_b128 v[132:135], v9 offset:5120
    ds_read_b128 v[136:139], v9 offset:6144
    ds_read_b128 v[140:143], v9 offset:7168
    s_waitcnt lgkmcnt(0)
    v_add_f32 v16, v16, v112
    v_add_f32 v17, v17, v113
    v_add_f32 v18, v18, v114
    v_add_f32 v19, v19, v115
    v_add_f32 v20, v20, v116
    v_add_f32 v21, v21, v117
    v_add_f32 v22, v22, v118
    v_add_f32 v23, v23, v119
    v_add_f32 v24, v24, v120
    v_add_f32 v25, v25, v121
    v_add_f32 v26, v26, v122
    v_add_f32 v27, v27, v123
    v_add_f32 v28, v28, v124
    v_add_f32 v29, v29, v125
    v_add_f32 v30, v30, v126
    v_add_f32 v31, v31, v127
    v_add_f32 v32, v32, v128
    v_add_f32 v33, v33, v129
    v_add_f32 v34, v34, v130
    v_add_f32 v35, v35, v131
    v_add_f32 v36, v36, v132
    v_add_f32 v37, v37, v133
    v_add_f32 v38, v38, v134
    v_add_f32 v39, v39, v135
    v_add_f32 v40, v40, v136
    v_add_f32 v41, v41, v137
    v_add_f32 v42, v42, v138
    v_add_f32 v43, v43, v139
    v_add_f32 v44, v44, v140
    v_add_f32 v45, v45, v141
    v_add_f32 v46, v46, v142
    v_add_f32 v47, v47, v143
    s_xor_b32 s52, s2, 2
    s_lshl_b32 s34, s52, 7
    s_lshl_b32 s33, s44, 2
    s_add_u32 s34, s34, s33
    s_add_u32 s34, s34, 18882560
    s_mov_b32 s33, 0x8000
    v_mov_b32 v9, 0
HX_p:
    buffer_load_dword v8, v9, s[20:23], s34 offen sc1
    s_waitcnt vmcnt(0)
    v_cmp_ne_u32 vcc, s14, v8
    s_cbranch_vccz HX_d
    s_sleep 2
    s_sub_u32 s33, s33, 1
    s_cmp_lg_u32 s33, 0
    s_cbranch_scc1 HX_p
HX_d:
    s_mul_i32 s32, s52, 24576
    s_lshl_b32 s33, s44, 13
    s_add_u32 s32, s32, s33
    s_add_u32 s32, s32, 18939904
    s_add_u32 s34, s32, 4096
    buffer_load_dwordx4 v[112:115], v13, s[20:23], s32 offen offset:0 sc1
    buffer_load_dwordx4 v[116:119], v13, s[20:23], s32 offen offset:1024 sc1
    buffer_load_dwordx4 v[120:123], v13, s[20:23], s32 offen offset:2048 sc1
    buffer_load_dwordx4 v[124:127], v13, s[20:23], s32 offen offset:3072 sc1
    buffer_load_dwordx4 v[128:131], v13, s[20:23], s34 offen offset:0 sc1
    buffer_load_dwordx4 v[132:135], v13, s[20:23], s34 offen offset:1024 sc1
    buffer_load_dwordx4 v[136:139], v13, s[20:23], s34 offen offset:2048 sc1
    buffer_load_dwordx4 v[140:143], v13, s[20:23], s34 offen offset:3072 sc1
    s_mul_i32 s32, s26, 1280
    s_lshl_b32 s33, s69, 8
    s_add_u32 s32, s32, s33
    s_lshl_b32 s33, s71, 7
    s_add_u32 s32, s32, s33
    s_waitcnt vmcnt(7)
    v_add_f32 v16, v16, v112
    v_add_f32 v17, v17, v113
    v_add_f32 v18, v18, v114
    v_add_f32 v19, v19, v115
    v_cvt_pk_bf16_f32 v16, v16, v17
    v_cvt_pk_bf16_f32 v17, v18, v19
    buffer_store_dwordx2 v[16:17], v10, s[76:79], s32 offen offset:0
    s_waitcnt vmcnt(7)
    v_add_f32 v20, v20, v116
    v_add_f32 v21, v21, v117
    v_add_f32 v22, v22, v118
    v_add_f32 v23, v23, v119
    v_cvt_pk_bf16_f32 v20, v20, v21
    v_cvt_pk_bf16_f32 v21, v22, v23
    buffer_store_dwordx2 v[20:21], v11, s[76:79], s32 offen offset:0
    s_waitcnt vmcnt(7)
    v_add_f32 v24, v24, v120
    v_add_f32 v25, v25, v121
    v_add_f32 v26, v26, v122
    v_add_f32 v27, v27, v123
    v_cvt_pk_bf16_f32 v24, v24, v25
    v_cvt_pk_bf16_f32 v25, v26, v27
    buffer_store_dwordx2 v[24:25], v10, s[76:79], s32 offen offset:32
    s_waitcnt vmcnt(7)
    v_add_f32 v28, v28, v124
    v_add_f32 v29, v29, v125
    v_add_f32 v30, v30, v126
    v_add_f32 v31, v31, v127
    v_cvt_pk_bf16_f32 v28, v28, v29
    v_cvt_pk_bf16_f32 v29, v30, v31
    buffer_store_dwordx2 v[28:29], v11, s[76:79], s32 offen offset:32
    s_waitcnt vmcnt(7)
    v_add_f32 v32, v32, v128
    v_add_f32 v33, v33, v129
    v_add_f32 v34, v34, v130
    v_add_f32 v35, v35, v131
    v_cvt_pk_bf16_f32 v32, v32, v33
    v_cvt_pk_bf16_f32 v33, v34, v35
    buffer_store_dwordx2 v[32:33], v10, s[76:79], s32 offen offset:64
    s_waitcnt vmcnt(7)
    v_add_f32 v36, v36, v132
    v_add_f32 v37, v37, v133
    v_add_f32 v38, v38, v134
    v_add_f32 v39, v39, v135
    v_cvt_pk_bf16_f32 v36, v36, v37
    v_cvt_pk_bf16_f32 v37, v38, v39
    buffer_store_dwordx2 v[36:37], v11, s[76:79], s32 offen offset:64
    s_waitcnt vmcnt(7)
    v_add_f32 v40, v40, v136
    v_add_f32 v41, v41, v137
    v_add_f32 v42, v42, v138
    v_add_f32 v43, v43, v139
    v_cvt_pk_bf16_f32 v40, v40, v41
    v_cvt_pk_bf16_f32 v41, v42, v43
    buffer_store_dwordx2 v[40:41], v10, s[76:79], s32 offen offset:96
    s_waitcnt vmcnt(7)
    v_add_f32 v44, v44, v140
    v_add_f32 v45, v45, v141
    v_add_f32 v46, v46, v142
    v_add_f32 v47, v47, v143
    v_cvt_pk_bf16_f32 v44, v44, v45
    v_cvt_pk_bf16_f32 v45, v46, v47
    buffer_store_dwordx2 v[44:45], v11, s[76:79], s32 offen offset:96
    s_endpgm
T_ld:
    s_add_u32 s32, s46, s55
    s_and_b32 s32, s32, 7
    s_lshl_b32 s32, s32, 1
    s_lshr_b32 s33, s46, 3
    s_add_u32 s32, s32, s33
    s_add_u32 s32, s32, s47
    s_mul_i32 s54, s32, 163840
    s_add_u32 s54, s54, s50
    s_add_u32 s46, s46, 1
    s_add_u32 m0, s48, 109824
    s_add_u32 s32, s54, 0
    buffer_load_dwordx4 v4, s[80:83], s32 offen lds
    s_add_u32 m0, s48, 110880
    s_add_u32 s32, s54, 1280
    buffer_load_dwordx4 v4, s[80:83], s32 offen lds
    s_add_u32 m0, s48, 111936
    s_add_u32 s32, s54, 2560
    buffer_load_dwordx4 v4, s[80:83], s32 offen lds
    s_add_u32 m0, s48, 112992
    s_add_u32 s32, s54, 3840
    buffer_load_dwordx4 v4, s[80:83], s32 offen lds
    s_add_u32 m0, s48, 114048
    s_add_u32 s32, s54, 10240
    buffer_load_dwordx4 v4, s[80:83], s32 offen lds
    s_add_u32 m0, s48, 115104
    s_add_u32 s32, s54, 11520
    buffer_load_dwordx4 v4, s[80:83], s32 offen lds
    s_add_u32 m0, s48, 116160
    s_add_u32 s32, s54, 12800
    buffer_load_dwordx4 v4, s[80:83], s32 offen lds
    s_add_u32 m0, s48, 117216
    s_add_u32 s32, s54, 14080
    buffer_load_dwordx4 v4, s[80:83], s32 offen lds
    s_add_u32 m0, s48, 118272
    s_add_u32 s32, s54, 40960
    buffer_load_dwordx4 v4, s[80:83], s32 offen lds
    s_add_u32 m0, s48, 119328
    s_add_u32 s32, s54, 42240
    buffer_load_dwordx4 v4, s[80:83], s32 offen lds
    s_add_u32 m0, s48, 120384
    s_add_u32 s32, s54, 43520
    buffer_load_dwordx4 v4, s[80:83], s32 offen lds
    s_add_u32 m0, s48, 121440
    s_add_u32 s32, s54, 44800
    buffer_load_dwordx4 v4, s[80:83], s32 offen lds
    s_add_u32 m0, s48, 122496
    s_add_u32 s32, s54, 51200
    buffer_load_dwordx4 v4, s[80:83], s32 offen lds
    s_add_u32 m0, s48, 123552
    s_add_u32 s32, s54, 52480
    buffer_load_dwordx4 v4, s[80:83], s32 offen lds
    s_add_u32 m0, s48, 124608
    s_add_u32 s32, s54, 53760
    buffer_load_dwordx4 v4, s[80:83], s32 offen lds
    s_add_u32 m0, s48, 125664
    s_add_u32 s32, s54, 55040
    buffer_load_dwordx4 v4, s[80:83], s32 offen lds
    s_barrier
    s_mov_b32 s49, 0
TL_loop:
    s_cmp_ge_u32 s46, 16
    s_cbranch_scc1 TLs_78
    s_add_u32 s32, s46, s55
    s_and_b32 s32, s32, 7
    s_lshl_b32 s32, s32, 1
    s_lshr_b32 s33, s46, 3
    s_add_u32 s32, s32, s33
    s_add_u32 s32, s32, s47
    s_mul_i32 s54, s32, 163840
    s_add_u32 s54, s54, s50
    s_add_u32 s46, s46, 1
    s_add_u32 m0, s48, 0
    s_add_u32 s32, s54, 0
    buffer_load_dwordx4 v4, s[80:83], s32 offen lds
    s_add_u32 m0, s48, 1056
    s_add_u32 s32, s54, 1280
    buffer_load_dwordx4 v4, s[80:83], s32 offen lds
    s_add_u32 m0, s48, 2112
    s_add_u32 s32, s54, 2560
    buffer_load_dwordx4 v4, s[80:83], s32 offen lds
    s_add_u32 m0, s48, 3168
    s_add_u32 s32, s54, 3840
    buffer_load_dwordx4 v4, s[80:83], s32 offen lds
    s_add_u32 m0, s48, 4224
    s_add_u32 s32, s54, 10240
    buffer_load_dwordx4 v4, s[80:83], s32 offen lds
    s_add_u32 m0, s48, 5280
    s_add_u32 s32, s54, 11520
    buffer_load_dwordx4 v4, s[80:83], s32 offen lds
    s_add_u32 m0, s48, 6336
    s_add_u32 s32, s54, 12800
    buffer_load_dwordx4 v4, s[80:83], s32 offen lds
    s_add_u32 m0, s48, 7392
    s_add_u32 s32, s54, 14080
    buffer_load_dwordx4 v4, s[80:83], s32 offen lds
    s_add_u32 m0, s48, 8448
    s_add_u32 s32, s54, 40960
    buffer_load_dwordx4 v4, s[80:83], s32 offen lds
    s_add_u32 m0, s48, 9504
    s_add_u32 s32, s54, 42240
    buffer_load_dwordx4 v4, s[80:83], s32 offen lds
    s_add_u32 m0, s48, 10560
    s_add_u32 s32, s54, 43520
    buffer_load_dwordx4 v4, s[80:83], s32 offen lds
    s_add_u32 m0, s48, 11616
    s_add_u32 s32, s54, 44800
    buffer_load_dwordx4 v4, s[80:83], s32 offen lds
    s_add_u32 m0, s48, 12672
    s_add_u32 s32, s54, 51200
    buffer_load_dwordx4 v4, s[80:83], s32 offen lds
    s_add_u32 m0, s48, 13728
    s_add_u32 s32, s54, 52480
    buffer_load_dwordx4 v4, s[80:83], s32 offen lds
    s_add_u32 m0, s48, 14784
    s_add_u32 s32, s54, 53760
    buffer_load_dwordx4 v4, s[80:83], s32 offen lds
    s_add_u32 m0, s48, 15840
    s_add_u32 s32, s54, 55040
    buffer_load_dwordx4 v4, s[80:83], s32 offen lds
    s_waitcnt vmcnt(16)
    s_branch TLw_79
TLs_78:
    s_waitcnt vmcnt(0)
TLw_79:
    s_barrier
    s_cmp_ge_u32 s46, 16
    s_cbranch_scc1 TLs_80
    s_add_u32 s32, s46, s55
    s_and_b32 s32, s32, 7
    s_lshl_b32 s32, s32, 1
    s_lshr_b32 s33, s46, 3
    s_add_u32 s32, s32, s33
    s_add_u32 s32, s32, s47
    s_mul_i32 s54, s32, 163840
    s_add_u32 s54, s54, s50
    s_add_u32 s46, s46, 1
    s_add_u32 m0, s48, 42240
    s_add_u32 s32, s54, 0
    buffer_load_dwordx4 v4, s[80:83], s32 offen lds
    s_add_u32 m0, s48, 43296
    s_add_u32 s32, s54, 1280
    buffer_load_dwordx4 v4, s[80:83], s32 offen lds
    s_add_u32 m0, s48, 44352
    s_add_u32 s32, s54, 2560
    buffer_load_dwordx4 v4, s[80:83], s32 offen lds
    s_add_u32 m0, s48, 45408
    s_add_u32 s32, s54, 3840
    buffer_load_dwordx4 v4, s[80:83], s32 offen lds
    s_add_u32 m0, s48, 46464
    s_add_u32 s32, s54, 10240
    buffer_load_dwordx4 v4, s[80:83], s32 offen lds
    s_add_u32 m0, s48, 47520
    s_add_u32 s32, s54, 11520
    buffer_load_dwordx4 v4, s[80:83], s32 offen lds
    s_add_u32 m0, s48, 48576
    s_add_u32 s32, s54, 12800
    buffer_load_dwordx4 v4, s[80:83], s32 offen lds
    s_add_u32 m0, s48, 49632
    s_add_u32 s32, s54, 14080
    buffer_load_dwordx4 v4, s[80:83], s32 offen lds
    s_add_u32 m0, s48, 50688
    s_add_u32 s32, s54, 40960
    buffer_load_dwordx4 v4, s[80:83], s32 offen lds
    s_add_u32 m0, s48, 51744
    s_add_u32 s32, s54, 42240
    buffer_load_dwordx4 v4, s[80:83], s32 offen lds
    s_add_u32 m0, s48, 52800
    s_add_u32 s32, s54, 43520
    buffer_load_dwordx4 v4, s[80:83], s32 offen lds
    s_add_u32 m0, s48, 53856
    s_add_u32 s32, s54, 44800
    buffer_load_dwordx4 v4, s[80:83], s32 offen lds
    s_add_u32 m0, s48, 54912
    s_add_u32 s32, s54, 51200
    buffer_load_dwordx4 v4, s[80:83], s32 offen lds
    s_add_u32 m0, s48, 55968
    s_add_u32 s32, s54, 52480
    buffer_load_dwordx4 v4, s[80:83], s32 offen lds
    s_add_u32 m0, s48, 57024
    s_add_u32 s32, s54, 53760
    buffer_load_dwordx4 v4, s[80:83], s32 offen lds
    s_add_u32 m0, s48, 58080
    s_add_u32 s32, s54, 55040
    buffer_load_dwordx4 v4, s[80:83], s32 offen lds
    s_waitcnt vmcnt(16)
    s_branch TLw_81
TLs_80:
    s_waitcnt vmcnt(0)
TLw_81:
    s_barrier
    s_cmp_ge_u32 s46, 16
    s_cbranch_scc1 TLs_82
    s_add_u32 s32, s46, s55
    s_and_b32 s32, s32, 7
    s_lshl_b32 s32, s32, 1
    s_lshr_b32 s33, s46, 3
    s_add_u32 s32, s32, s33
    s_add_u32 s32, s32, s47
    s_mul_i32 s54, s32, 163840
    s_add_u32 s54, s54, s50
    s_add_u32 s46, s46, 1
    s_add_u32 m0, s48, 76032
    s_add_u32 s32, s54, 0
    buffer_load_dwordx4 v4, s[80:83], s32 offen lds
    s_add_u32 m0, s48, 77088
    s_add_u32 s32, s54, 1280
    buffer_load_dwordx4 v4, s[80:83], s32 offen lds
    s_add_u32 m0, s48, 78144
    s_add_u32 s32, s54, 2560
    buffer_load_dwordx4 v4, s[80:83], s32 offen lds
    s_add_u32 m0, s48, 79200
    s_add_u32 s32, s54, 3840
    buffer_load_dwordx4 v4, s[80:83], s32 offen lds
    s_add_u32 m0, s48, 80256
    s_add_u32 s32, s54, 10240
    buffer_load_dwordx4 v4, s[80:83], s32 offen lds
    s_add_u32 m0, s48, 81312
    s_add_u32 s32, s54, 11520
    buffer_load_dwordx4 v4, s[80:83], s32 offen lds
    s_add_u32 m0, s48, 82368
    s_add_u32 s32, s54, 12800
    buffer_load_dwordx4 v4, s[80:83], s32 offen lds
    s_add_u32 m0, s48, 83424
    s_add_u32 s32, s54, 14080
    buffer_load_dwordx4 v4, s[80:83], s32 offen lds
    s_add_u32 m0, s48, 84480
    s_add_u32 s32, s54, 40960
    buffer_load_dwordx4 v4, s[80:83], s32 offen lds
    s_add_u32 m0, s48, 85536
    s_add_u32 s32, s54, 42240
    buffer_load_dwordx4 v4, s[80:83], s32 offen lds
    s_add_u32 m0, s48, 86592
    s_add_u32 s32, s54, 43520
    buffer_load_dwordx4 v4, s[80:83], s32 offen lds
    s_add_u32 m0, s48, 87648
    s_add_u32 s32, s54, 44800
    buffer_load_dwordx4 v4, s[80:83], s32 offen lds
    s_add_u32 m0, s48, 88704
    s_add_u32 s32, s54, 51200
    buffer_load_dwordx4 v4, s[80:83], s32 offen lds
    s_add_u32 m0, s48, 89760
    s_add_u32 s32, s54, 52480
    buffer_load_dwordx4 v4, s[80:83], s32 offen lds
    s_add_u32 m0, s48, 90816
    s_add_u32 s32, s54, 53760
    buffer_load_dwordx4 v4, s[80:83], s32 offen lds
    s_add_u32 m0, s48, 91872
    s_add_u32 s32, s54, 55040
    buffer_load_dwordx4 v4, s[80:83], s32 offen lds
    s_waitcnt vmcnt(16)
    s_branch TLw_83
TLs_82:
    s_waitcnt vmcnt(0)
TLw_83:
    s_barrier
    s_cmp_ge_u32 s46, 16
    s_cbranch_scc1 TLs_84
    s_add_u32 s32, s46, s55
    s_and_b32 s32, s32, 7
    s_lshl_b32 s32, s32, 1
    s_lshr_b32 s33, s46, 3
    s_add_u32 s32, s32, s33
    s_add_u32 s32, s32, s47
    s_mul_i32 s54, s32, 163840
    s_add_u32 s54, s54, s50
    s_add_u32 s46, s46, 1
    s_add_u32 m0, s48, 109824
    s_add_u32 s32, s54, 0
    buffer_load_dwordx4 v4, s[80:83], s32 offen lds
    s_add_u32 m0, s48, 110880
    s_add_u32 s32, s54, 1280
    buffer_load_dwordx4 v4, s[80:83], s32 offen lds
    s_add_u32 m0, s48, 111936
    s_add_u32 s32, s54, 2560
    buffer_load_dwordx4 v4, s[80:83], s32 offen lds
    s_add_u32 m0, s48, 112992
    s_add_u32 s32, s54, 3840
    buffer_load_dwordx4 v4, s[80:83], s32 offen lds
    s_add_u32 m0, s48, 114048
    s_add_u32 s32, s54, 10240
    buffer_load_dwordx4 v4, s[80:83], s32 offen lds
    s_add_u32 m0, s48, 115104
    s_add_u32 s32, s54, 11520
    buffer_load_dwordx4 v4, s[80:83], s32 offen lds
    s_add_u32 m0, s48, 116160
    s_add_u32 s32, s54, 12800
    buffer_load_dwordx4 v4, s[80:83], s32 offen lds
    s_add_u32 m0, s48, 117216
    s_add_u32 s32, s54, 14080
    buffer_load_dwordx4 v4, s[80:83], s32 offen lds
    s_add_u32 m0, s48, 118272
    s_add_u32 s32, s54, 40960
    buffer_load_dwordx4 v4, s[80:83], s32 offen lds
    s_add_u32 m0, s48, 119328
    s_add_u32 s32, s54, 42240
    buffer_load_dwordx4 v4, s[80:83], s32 offen lds
    s_add_u32 m0, s48, 120384
    s_add_u32 s32, s54, 43520
    buffer_load_dwordx4 v4, s[80:83], s32 offen lds
    s_add_u32 m0, s48, 121440
    s_add_u32 s32, s54, 44800
    buffer_load_dwordx4 v4, s[80:83], s32 offen lds
    s_add_u32 m0, s48, 122496
    s_add_u32 s32, s54, 51200
    buffer_load_dwordx4 v4, s[80:83], s32 offen lds
    s_add_u32 m0, s48, 123552
    s_add_u32 s32, s54, 52480
    buffer_load_dwordx4 v4, s[80:83], s32 offen lds
    s_add_u32 m0, s48, 124608
    s_add_u32 s32, s54, 53760
    buffer_load_dwordx4 v4, s[80:83], s32 offen lds
    s_add_u32 m0, s48, 125664
    s_add_u32 s32, s54, 55040
    buffer_load_dwordx4 v4, s[80:83], s32 offen lds
    s_waitcnt vmcnt(16)
    s_branch TLw_85
TLs_84:
    s_waitcnt vmcnt(0)
TLw_85:
    s_add_u32 s49, s49, 4
    s_cmp_lt_u32 s49, 16
    s_barrier
    s_cbranch_scc1 TL_loop
    s_endpgm
T_ni:
    s_waitcnt vmcnt(0)
    s_barrier
    s_cmp_lg_u32 s3, 4
    s_cbranch_scc1 pub_86
    v_mov_b32 v8, s14
    v_mov_b32 v9, 0
    s_mov_b64 exec, 1
    buffer_store_dword v8, v9, s[20:23], s57 offen offset:256 sc1
    s_mov_b64 exec, -1
pub_86:
    s_endpgm
L_end:
    s_endpgm
.section .rodata,"a"
.p2align 6
.amdhsa_kernel concat_heads__gqa_block_cached__gqa_block_cached__near_ridge_kernel
  .amdhsa_next_free_vgpr 256
  .amdhsa_next_free_sgpr 102
  .amdhsa_accum_offset 256
  .amdhsa_group_segment_fixed_size 0
  .amdhsa_kernarg_size 104
  .amdhsa_user_sgpr_count 2
  .amdhsa_user_sgpr_kernarg_segment_ptr 1
  .amdhsa_system_sgpr_workgroup_id_x 1
.end_amdhsa_kernel
```
